```python
import torch

def _softmax(x, axis=-1):
    return torch.softmax(x, dim=axis)
def _gelu(x):
    return torch.nn.functional.gelu(x, approximate="tanh")
def _silu(x):
    return torch.nn.functional.silu(x)
def _sigmoid(x):
    return torch.sigmoid(x)
def _layernorm(x, axis=-1, eps=1e-5):
    m = x.mean(dim=axis, keepdim=True)
    v = x.var(dim=axis, keepdim=True, unbiased=False)
    return (x - m) / torch.sqrt(v + eps)
def _scatter_add(tgt, idx, src, axis=0):
    return tgt.clone().index_add_(axis, idx, src)
def _segment_sum(src, seg, n):
    out = torch.zeros((n,) + src.shape[1:], dtype=src.dtype)
    return out.index_add_(0, seg, src)
def _pad(x, pw):
    flat = tuple(v for pair in reversed(pw) for v in pair)
    return torch.nn.functional.pad(x, flat)

kernel_name = 'sequential_preLN__compressed_kv_cla__dense_activation_squared_relu__prompt'

def setup_inputs():

    _w = (lambda a: (lambda t: t.to(torch.bfloat16) if t.is_floating_point() else t)(torch.as_tensor(a)))
    def _A_setup():
        B, H, Sq, Sk, D, M = 1, 32, 2048, 2048, 128, 512
        Dc = 4 * D
        return {
            "x": _w((lambda *s: torch.randn(*s, dtype=torch.bfloat16) * 0.05)(B, Sq, M)),
            "c_kv": _w((lambda *s: torch.randn(*s, dtype=torch.bfloat16) * 0.4)(B, Sk, Dc)),
            "w_q": _w((lambda *s: torch.randn(*s, dtype=torch.bfloat16) * 3.2)(M, H, D) * (M ** -0.5)),
            "w_uk": _w((lambda *s: torch.randn(*s, dtype=torch.bfloat16) * 3.2)(Dc, H, D) * (Dc ** -0.5)),
            "w_uv": _w((lambda *s: torch.randn(*s, dtype=torch.bfloat16) * 0.4)(Dc, H, D) * (Dc ** -0.5)),
            "w_o": _w((lambda *s: torch.randn(*s, dtype=torch.bfloat16) * 0.4)(H, D, M) * ((H * D) ** -0.5)),
        }
    _A_in = _A_setup()

    def _B_setup():
        B, S, D, F = 1, 2048, 512, 1792
        return {
            "x": _w((lambda *s: torch.randn(*s, dtype=torch.bfloat16) * 0.05)(B, S, D)),
            "w1": _w((lambda *s: torch.randn(*s, dtype=torch.bfloat16) * 0.05)(D, F)),
            "b1": _w((lambda *s: torch.randn(*s, dtype=torch.bfloat16) * 0.4)(F)),
            "w2": _w((lambda *s: torch.randn(*s, dtype=torch.bfloat16) * 0.05)(F, D)),
            "b2": _w((lambda *s: torch.randn(*s, dtype=torch.bfloat16) * 1.6)(D)),
        }
    _B_in = _B_setup()

    return {
        "A_x": _A_in["x"],
        "A_c_kv": _A_in["c_kv"],
        "A_w_q": _A_in["w_q"],
        "A_w_uk": _A_in["w_uk"],
        "A_w_uv": _A_in["w_uv"],
        "A_w_o": _A_in["w_o"],
        "B_x": _B_in["x"],
        "B_w1": _B_in["w1"],
        "B_b1": _B_in["b1"],
        "B_w2": _B_in["w2"],
        "B_b2": _B_in["b2"],
    }

def reference(A_x, A_c_kv, A_w_q, A_w_uk, A_w_uv, A_w_o, B_x, B_w1, B_b1, B_w2, B_b2):
    def _A_ref(x, c_kv, w_q, w_uk, w_uv, w_o):
        B, Sq, M = x.shape[0], x.shape[1], x.shape[2]
        Sk = c_kv.shape[1]
        H, D = w_q.shape[1], w_q.shape[2]
        q = torch.einsum("bqm,mhd->bhqd", x, w_q)
        k = torch.einsum("bkc,chd->bhkd", c_kv, w_uk)
        v = torch.einsum("bkc,chd->bhkd", c_kv, w_uv)
        scores = torch.einsum("bhqd,bhkd->bhqk", q, k) * (D ** -0.5)
        off = Sk - Sq
        qi = torch.arange(Sq)[:, None]
        kj = torch.arange(Sk)[None, :]
        cmask = kj <= (qi + off)
        scores = torch.where(cmask[None, None], scores, -1e9)
        p = _softmax(scores, axis=-1)
        ctx = torch.einsum("bhqk,bhkd->bhqd", p, v)
        return torch.einsum("bhqd,hdm->bqm", ctx, w_o)

    def _B_ref(x, w1, b1, w2, b2):
        h = torch.einsum("bsd,df->bsf", x, w1) + b1
        zero = torch.zeros_like(h)
        r = torch.where(h > zero, h, zero)
        h = r * r
        out = torch.einsum("bsf,fd->bsd", h, w2) + b2
        return out

    x = A_x
    h = x + _A_ref(_layernorm(x, axis=-1), A_c_kv, A_w_q, A_w_uk, A_w_uv, A_w_o)
    h2 = h + _B_ref(_layernorm(h, axis=-1), B_w1, B_b1, B_w2, B_b2)
    return h2
```

```asm
; @launch kernel=ka_attn_kernel grid=(256,1,1) block=(256,1,1) lds=163840
; @launch kernel=kc_tail_kernel grid=(256,1,1) block=(256,1,1) lds=163840
.amdgcn_target "amdgcn-amd-amdhsa--gfx950"
.text
.globl ka_attn_kernel
.p2align 8
.type ka_attn_kernel,@function
ka_attn_kernel:
KA_PRO:
    s_cmp_ge_u32 s2, 256
    s_cbranch_scc1 KA_EXIT
    s_getpc_b64 s[68:69]
KA_PC:
    s_sub_u32 s68, s68, KA_PC-ka_attn_kernel
    s_subb_u32 s69, s69, 0
    s_mov_b32 s70, CODE_END-ka_attn_kernel
    s_mov_b32 s71, 0x20000
    s_lshr_b32 s64, s2, 3
    s_lshl_b32 s64, s64, 12
    v_lshlrev_b32 v4, 4, v0
    buffer_load_dwordx4 a[176:179], v4, s[68:71], s64 offen
    s_load_dwordx4 s[72:75], s[0:1], 0
    s_load_dwordx4 s[4:7], s[0:1], 16
    s_load_dwordx2 s[62:63], s[0:1], 32
    s_load_dwordx4 s[76:79], s[0:1], 96
    s_and_b32 s44, s2, 31
    s_lshr_b32 s45, s2, 5
    v_lshrrev_b32 v1, 6, v0
    v_and_b32 v2, 63, v0
    v_lshlrev_b32 v5, 4, v2
    v_readfirstlane_b32 s46, v1
    v_lshrrev_b32 v1, 4, v2
    v_bfe_u32 v3, v2, 2, 2
    v_xor_b32 v3, v3, v1
    v_and_b32 v4, 3, v2
    v_lshl_add_u32 v3, v3, 2, v4
    v_lshlrev_b32 v3, 4, v3
    v_lshl_add_u32 v3, v1, 13, v3
    s_lshl_b32 s64, s46, 16
    v_add_u32 v32, s64, v3
    v_add_u32 v33, 31744, v32
    s_lshl_b32 s64, s46, 17
    v_add_u32 v3, s64, v3
    v_lshrrev_b32 v1, 3, v2
    v_and_b32 v6, 7, v2
    v_lshrrev_b32 v4, 1, v1
    v_add_u32 v7, 0, v4
    v_and_b32 v7, 7, v7
    v_xor_b32 v7, v7, v6
    v_lshlrev_b32 v7, 4, v7
    v_lshl_add_u32 v7, v1, 10, v7
    v_add_u32 v24, 0, v7
    v_add_u32 v26, 14336, v7
    v_add_u32 v28, 32768, v7
    v_add_u32 v30, 47104, v7
    v_add_u32 v7, 4, v4
    v_and_b32 v7, 7, v7
    v_xor_b32 v7, v7, v6
    v_lshlrev_b32 v7, 4, v7
    v_lshl_add_u32 v7, v1, 10, v7
    v_add_u32 v25, 7168, v7
    v_add_u32 v27, 21504, v7
    v_add_u32 v29, 39936, v7
    v_add_u32 v31, 54272, v7
    s_lshl_b32 s57, s46, 11
    s_add_u32 s57, s57, 65536
    s_mul_i32 s58, s46, 16384
    s_lshl_b32 s59, s45, 18
    s_lshl_b32 s60, s46, 16
    s_add_u32 s59, s59, s60
    s_lshl_b32 s60, s44, 8
    s_mov_b32 s51, 0
    s_add_u32 s51, s51, s45
    s_and_b32 s51, s51, 3
    s_mul_i32 s51, s51, 2
    s_lshl_b32 s52, s51, 19
    s_lshl_b32 s51, s51, 7
    s_waitcnt lgkmcnt(0)
    s_mov_b32 s8, s6
    s_mov_b32 s9, s7
    s_mov_b32 s10, 4194304
    s_mov_b32 s11, 0x20000
    s_mov_b32 s16, s4
    s_mov_b32 s17, s5
    s_mov_b32 s18, 4194304
    s_mov_b32 s19, 0x20000
    s_mov_b32 s4, s74
    s_mov_b32 s5, s75
    s_mov_b32 s6, 2097152
    s_mov_b32 s7, 0x20000
    s_mov_b32 s12, s62
    s_mov_b32 s13, s63
    s_mov_b32 s14, 4194304
    s_mov_b32 s15, 0x20000
    s_mov_b32 s32, s72
    s_mov_b32 s33, s73
    s_mov_b32 s34, 2097152
    s_mov_b32 s35, 0x20000
    s_add_u32 m0, s57, 0
    s_add_u32 s64, s52, 0
    s_and_b32 s64, s64, 0x3fffff
    s_add_u32 s64, s64, s60
    buffer_load_dwordx4 v32, s[8:11], s64 offen lds
    buffer_load_dwordx4 v33, s[8:11], s64 offen offset:1024 lds
    s_add_u32 m0, s57, 8192
    s_add_u32 s64, s52, 0
    s_and_b32 s64, s64, 0x3fffff
    s_add_u32 s64, s64, s60
    buffer_load_dwordx4 v32, s[12:15], s64 offen lds
    buffer_load_dwordx4 v33, s[12:15], s64 offen offset:1024 lds
    s_add_u32 m0, s58, 0
    s_add_u32 s65, s51, 0
    s_and_b32 s65, s65, 0x3ff
    s_add_u32 s65, s65, s59
    buffer_load_dwordx4 v24, s[4:7], s65 offen lds
    buffer_load_dwordx4 v25, s[4:7], s65 offen offset:1024 lds
    buffer_load_dwordx4 v26, s[4:7], s65 offen offset:2048 lds
    buffer_load_dwordx4 v27, s[4:7], s65 offen offset:3072 lds
    s_add_u32 m0, s58, 4096
    s_add_u32 s65, s51, 0
    s_and_b32 s65, s65, 0x3ff
    s_add_u32 s65, s65, s59
    buffer_load_dwordx4 v28, s[4:7], s65 offen lds
    buffer_load_dwordx4 v29, s[4:7], s65 offen offset:1024 lds
    buffer_load_dwordx4 v30, s[4:7], s65 offen offset:2048 lds
    buffer_load_dwordx4 v31, s[4:7], s65 offen offset:3072 lds
    v_lshrrev_b32 v1, 5, v0
    v_and_b32 v4, 31, v0
    s_lshl_b32 s66, s2, 13
    v_lshlrev_b32 v1, 10, v1
    v_lshl_add_u32 v4, v4, 5, v1
    s_add_u32 m0, s57, 16384
    s_add_u32 s64, s52, 262144
    s_and_b32 s64, s64, 0x3fffff
    s_add_u32 s64, s64, s60
    buffer_load_dwordx4 v32, s[8:11], s64 offen lds
    buffer_load_dwordx4 v33, s[8:11], s64 offen offset:1024 lds
    s_add_u32 m0, s57, 24576
    s_add_u32 s64, s52, 262144
    s_and_b32 s64, s64, 0x3fffff
    s_add_u32 s64, s64, s60
    buffer_load_dwordx4 v32, s[12:15], s64 offen lds
    buffer_load_dwordx4 v33, s[12:15], s64 offen offset:1024 lds
    buffer_load_dwordx4 v[112:115], v4, s[32:35], s66 offen
    buffer_load_dwordx4 v[116:119], v4, s[32:35], s66 offen offset:16
    v_add_u32 v36, 0, v3
    v_add_u32 v37, 31744, v3
    v_add_u32 v38, 63488, v3
    v_add_u32 v39, 95232, v3
    s_mov_b32 s40, s76
    s_mov_b32 s41, s77
    s_mov_b32 s42, 256
    s_mov_b32 s43, 0x20000
    s_add_u32 s32, s78, 54919168
    s_addc_u32 s33, s79, 0
    s_mov_b32 s34, 22656
    s_mov_b32 s35, 0x20000
    v_mov_b32 v56, 0
    v_mov_b32 v57, 0
    v_mov_b32 v58, 0
    v_mov_b32 v59, 0
    s_cmp_lg_u32 s46, 0
    s_cbranch_scc1 KA_Z1
    s_cmp_lg_u32 s2, 0
    s_cbranch_scc1 KA_Z1
    v_lshlrev_b32 v56, 7, v2
    v_mov_b32 v208, 0
    v_mov_b32 v209, 0
    v_mov_b32 v210, 0
    v_mov_b32 v211, 0
    s_mov_b32 s69, 0
    buffer_store_dwordx4 v[208:211], v56, s[32:35], s69 offen sc1
    buffer_store_dwordx4 v[208:211], v56, s[32:35], s69 offen offset:16 sc1
    buffer_store_dwordx4 v[208:211], v56, s[32:35], s69 offen offset:32 sc1
    buffer_store_dwordx4 v[208:211], v56, s[32:35], s69 offen offset:48 sc1
    s_mov_b32 s69, 8192
    buffer_store_dwordx4 v[208:211], v56, s[32:35], s69 offen sc1
    buffer_store_dwordx4 v[208:211], v56, s[32:35], s69 offen offset:16 sc1
    buffer_store_dwordx4 v[208:211], v56, s[32:35], s69 offen offset:32 sc1
    buffer_store_dwordx4 v[208:211], v56, s[32:35], s69 offen offset:48 sc1
    s_mov_b32 s69, 16384
    buffer_store_dwordx4 v[208:211], v56, s[32:35], s69 offen sc1
    buffer_store_dwordx4 v[208:211], v56, s[32:35], s69 offen offset:16 sc1
    buffer_store_dwordx4 v[208:211], v56, s[32:35], s69 offen offset:32 sc1
    buffer_store_dwordx4 v[208:211], v56, s[32:35], s69 offen offset:48 sc1
KA_Z1:
    s_getreg_b32 s64, hwreg(HW_REG_XCC_ID, 0, 4)
    s_mul_i32 s65, s64, s64
    s_lshl_b32 s65, s65, 8
    s_add_u32 s65, s65, s64
    s_add_u32 s3, s65, 0x1000000
    s_lshl_b32 s63, s3, 3
    s_lshl_b32 s64, s44, 20
    s_add_u32 s64, s64, 2097152
    s_mov_b32 s48, s45
    s_sub_u32 s47, 15, s45
    s_add_u32 s65, s47, 1
    s_lshl_b32 s65, s65, 16
    s_add_u32 s20, s78, s64
    s_addc_u32 s21, s79, 0
    s_mov_b32 s22, 1048576
    s_mov_b32 s23, 0x20000
    s_add_u32 s24, s78, s64
    s_addc_u32 s25, s79, 0
    s_mov_b32 s26, s65
    s_mov_b32 s27, 0x20000
    s_add_u32 s28, s78, 0
    s_addc_u32 s29, s79, 0
    s_mov_b32 s30, 2097152
    s_mov_b32 s31, 0x20000
    s_add_u32 s36, s78, 35651584
    s_addc_u32 s37, s79, 0
    s_mov_b32 s38, 16777216
    s_mov_b32 s39, 0x20000
    v_and_b32 v3, 15, v2
    v_lshrrev_b32 v4, 2, v3
    v_and_b32 v6, 3, v3
    v_bfe_u32 v7, v2, 4, 1
    v_lshrrev_b32 v1, 5, v2
    v_lshl_add_u32 v3, v1, 3, v4
    v_lshlrev_b32 v3, 8, v3
    v_lshl_add_u32 v3, v7, 5, v3
    v_lshl_add_u32 v3, v6, 3, v3
    v_xor_b32 v6, 0, v4
    v_lshl_add_u32 v6, v6, 6, v3
    v_add_u32 v16, 0x20000, v6
    v_add_u32 v60, 0x10000, v6
    v_mov_b32 v12, v6
    v_xor_b32 v6, 1, v4
    v_lshl_add_u32 v6, v6, 6, v3
    v_add_u32 v17, 0x20000, v6
    v_add_u32 v61, 0x10000, v6
    v_mov_b32 v13, v6
    v_xor_b32 v6, 2, v4
    v_lshl_add_u32 v6, v6, 6, v3
    v_add_u32 v18, 0x20000, v6
    v_add_u32 v62, 0x10000, v6
    v_mov_b32 v14, v6
    v_xor_b32 v6, 3, v4
    v_lshl_add_u32 v6, v6, 6, v3
    v_add_u32 v19, 0x20000, v6
    v_add_u32 v63, 0x10000, v6
    v_mov_b32 v15, v6
    v_and_b32 v3, 31, v2
    v_lshrrev_b32 v4, 1, v3
    v_and_b32 v4, 7, v4
    v_xor_b32 v4, v4, v1
    v_lshlrev_b32 v4, 4, v4
    v_lshl_add_u32 v4, v3, 7, v4
    v_add_u32 v4, s58, v4
    v_xor_b32 v20, 0, v4
    v_xor_b32 v21, 32, v4
    v_xor_b32 v22, 64, v4
    v_xor_b32 v23, 96, v4
    s_lshl_b32 s64, s46, 13
    v_add_u32 v10, s64, v5
    v_add_u32 v11, 4096, v10
    s_mov_b32 s49, 0
    s_mov_b32 s50, s64
    v_mov_b32 v8, v5
    v_add_u32 v9, 0x8000, v5
    s_mov_b32 s53, 0x4e800000
    s_lshl_b32 s54, s46, 12
    s_lshl_b32 s55, s47, 2
    s_add_u32 s55, s55, s46
    s_lshl_b32 s55, s55, 15
    s_lshl_b32 s56, s48, 2
    s_add_u32 s56, s56, s46
    s_lshl_b32 s56, s56, 15
    s_lshl_b32 s61, s45, 17
    s_lshl_b32 s64, s46, 15
    s_add_u32 s61, s61, s64
    s_waitcnt vmcnt(6)
    s_barrier
    ds_read_b64_tr_b16 v[64:65], v60 offset:0
    ds_read_b64_tr_b16 v[66:67], v60 offset:1024
    ds_read_b64_tr_b16 v[80:81], v60 offset:8192
    ds_read_b64_tr_b16 v[82:83], v60 offset:9216
    ds_read_b64_tr_b16 v[68:69], v61 offset:0
    ds_read_b64_tr_b16 v[70:71], v61 offset:1024
    ds_read_b64_tr_b16 v[84:85], v61 offset:8192
    ds_read_b64_tr_b16 v[86:87], v61 offset:9216
    ds_read_b64_tr_b16 v[72:73], v62 offset:0
    ds_read_b64_tr_b16 v[74:75], v62 offset:1024
    ds_read_b64_tr_b16 v[88:89], v62 offset:8192
    ds_read_b64_tr_b16 v[90:91], v62 offset:9216
    ds_read_b64_tr_b16 v[76:77], v63 offset:0
    ds_read_b64_tr_b16 v[78:79], v63 offset:1024
    ds_read_b64_tr_b16 v[92:93], v63 offset:8192
    ds_read_b64_tr_b16 v[94:95], v63 offset:9216
    ds_read_b128 v[96:99], v20
    ds_read_b128 v[100:103], v20 offset:4096
    s_waitcnt lgkmcnt(1)
    v_mfma_f32_32x32x16_bf16 v[128:143], v[64:67], v[96:99], 0
    ds_read_b128 v[104:107], v21
    s_add_u32 m0, s57, 32768
    s_add_u32 s64, s52, 524288
    s_and_b32 s64, s64, 0x3fffff
    s_add_u32 s64, s64, s60
    s_waitcnt lgkmcnt(1)
    v_mfma_f32_32x32x16_bf16 v[144:159], v[64:67], v[100:103], 0
    ds_read_b64_tr_b16 v[64:65], v60 offset:4096
    ds_read_b64_tr_b16 v[66:67], v60 offset:5120
    buffer_load_dwordx4 v32, s[8:11], s64 offen lds
    s_waitcnt vmcnt(2)
    v_lshlrev_b32 v40, 16, v112
    v_mfma_f32_32x32x16_bf16 a[0:15], v[96:99], v[80:83], 0
    ds_read_b128 v[108:111], v21 offset:4096
    buffer_load_dwordx4 v33, s[8:11], s64 offen offset:1024 lds
    v_and_b32 v41, 0xffff0000, v112
    v_lshlrev_b32 v42, 16, v113
    v_mfma_f32_32x32x16_bf16 a[16:31], v[100:103], v[80:83], 0
    ds_read_b64_tr_b16 v[80:81], v60 offset:12288
    ds_read_b64_tr_b16 v[82:83], v60 offset:13312
    s_add_u32 m0, s57, 40960
    s_add_u32 s64, s52, 524288
    s_and_b32 s64, s64, 0x3fffff
    s_add_u32 s64, s64, s60
    v_mfma_f32_32x32x16_bf16 v[160:175], v[68:71], v[96:99], 0
    buffer_load_dwordx4 v32, s[12:15], s64 offen lds
    v_and_b32 v43, 0xffff0000, v113
    v_lshlrev_b32 v44, 16, v114
    v_and_b32 v45, 0xffff0000, v114
    v_mfma_f32_32x32x16_bf16 v[176:191], v[68:71], v[100:103], 0
    ds_read_b64_tr_b16 v[68:69], v61 offset:4096
    ds_read_b64_tr_b16 v[70:71], v61 offset:5120
    buffer_load_dwordx4 v33, s[12:15], s64 offen offset:1024 lds
    v_lshlrev_b32 v46, 16, v115
    v_mfma_f32_32x32x16_bf16 a[32:47], v[96:99], v[84:87], 0
    s_add_u32 m0, s58, 8192
    s_add_u32 s65, s51, 128
    s_and_b32 s65, s65, 0x3ff
    s_add_u32 s65, s65, s59
    v_and_b32 v47, 0xffff0000, v115
    v_mfma_f32_32x32x16_bf16 a[48:63], v[100:103], v[84:87], 0
    ds_read_b64_tr_b16 v[84:85], v61 offset:12288
    ds_read_b64_tr_b16 v[86:87], v61 offset:13312
    buffer_load_dwordx4 v24, s[4:7], s65 offen lds
    s_waitcnt vmcnt(5)
    v_lshlrev_b32 v48, 16, v116
    v_and_b32 v49, 0xffff0000, v116
    v_mfma_f32_32x32x16_bf16 v[192:207], v[72:75], v[96:99], 0
    buffer_load_dwordx4 v25, s[4:7], s65 offen offset:1024 lds
    v_lshlrev_b32 v50, 16, v117
    v_and_b32 v51, 0xffff0000, v117
    v_lshlrev_b32 v52, 16, v118
    v_and_b32 v53, 0xffff0000, v118
    v_mfma_f32_32x32x16_bf16 v[208:223], v[72:75], v[100:103], 0
    ds_read_b64_tr_b16 v[72:73], v62 offset:4096
    ds_read_b64_tr_b16 v[74:75], v62 offset:5120
    buffer_load_dwordx4 v26, s[4:7], s65 offen offset:2048 lds
    v_lshlrev_b32 v54, 16, v119
    v_and_b32 v55, 0xffff0000, v119
    v_mfma_f32_32x32x16_bf16 a[64:79], v[96:99], v[88:91], 0
    buffer_load_dwordx4 v27, s[4:7], s65 offen offset:3072 lds
    v_add_f32 v120, v40, v41
    v_add_f32 v120, v120, v42
    v_add_f32 v120, v120, v43
    v_add_f32 v120, v120, v44
    v_mfma_f32_32x32x16_bf16 a[80:95], v[100:103], v[88:91], 0
    ds_read_b64_tr_b16 v[88:89], v62 offset:12288
    ds_read_b64_tr_b16 v[90:91], v62 offset:13312
    s_add_u32 m0, s58, 12288
    s_add_u32 s65, s51, 128
    s_and_b32 s65, s65, 0x3ff
    s_add_u32 s65, s65, s59
    v_mfma_f32_32x32x16_bf16 v[224:239], v[76:79], v[96:99], 0
    buffer_load_dwordx4 v28, s[4:7], s65 offen lds
    v_add_f32 v120, v120, v45
    v_add_f32 v120, v120, v46
    v_add_f32 v120, v120, v47
    v_add_f32 v120, v120, v48
    v_mfma_f32_32x32x16_bf16 v[240:255], v[76:79], v[100:103], 0
    ds_read_b64_tr_b16 v[76:77], v63 offset:4096
    ds_read_b64_tr_b16 v[78:79], v63 offset:5120
    buffer_load_dwordx4 v29, s[4:7], s65 offen offset:1024 lds
    v_add_f32 v120, v120, v49
    v_add_f32 v120, v120, v50
    v_mfma_f32_32x32x16_bf16 a[96:111], v[96:99], v[92:95], 0
    buffer_load_dwordx4 v30, s[4:7], s65 offen offset:2048 lds
    v_add_f32 v120, v120, v51
    v_add_f32 v120, v120, v52
    v_add_f32 v120, v120, v53
    v_add_f32 v120, v120, v54
    v_mfma_f32_32x32x16_bf16 a[112:127], v[100:103], v[92:95], 0
    ds_read_b64_tr_b16 v[92:93], v63 offset:12288
    ds_read_b64_tr_b16 v[94:95], v63 offset:13312
    buffer_load_dwordx4 v31, s[4:7], s65 offen offset:3072 lds
    v_add_f32 v120, v120, v55
    ds_swizzle_b32 v121, v120 offset:1055
    s_waitcnt lgkmcnt(15)
    v_mfma_f32_32x32x16_bf16 v[128:143], v[64:67], v[104:107], v[128:143]
    s_waitcnt vmcnt(14)
    s_barrier
    s_cmp_lg_u32 s46, 0
    s_cbranch_scc1 KA_ZS
    s_cmp_lg_u32 s2, 0
    s_cbranch_scc1 KA_ZS
    s_waitcnt vmcnt(12)
    v_mov_b32 v57, 1
    v_mov_b32 v58, 0
    s_mov_b64 exec, 1
    buffer_store_dword v57, v58, s[40:43], 0 offen sc1
    s_mov_b64 exec, -1
KA_ZS:
    ds_read_b128 v[96:99], v22
    s_add_u32 m0, s57, 49152
    s_add_u32 s64, s52, 786432
    s_and_b32 s64, s64, 0x3fffff
    s_add_u32 s64, s64, s60
    v_mfma_f32_32x32x16_bf16 v[144:159], v[64:67], v[108:111], v[144:159]
    ds_read_b64_tr_b16 v[64:65], v60 offset:16384
    ds_read_b64_tr_b16 v[66:67], v60 offset:17408
    buffer_load_dwordx4 v32, s[8:11], s64 offen lds
    s_waitcnt lgkmcnt(15)
    v_mfma_f32_32x32x16_bf16 a[0:15], v[104:107], v[80:83], a[0:15]
    ds_read_b128 v[100:103], v22 offset:4096
    buffer_load_dwordx4 v33, s[8:11], s64 offen offset:1024 lds
    v_mfma_f32_32x32x16_bf16 a[16:31], v[108:111], v[80:83], a[16:31]
    ds_read_b64_tr_b16 v[80:81], v60 offset:24576
    ds_read_b64_tr_b16 v[82:83], v60 offset:25600
    s_add_u32 m0, s57, 57344
    s_add_u32 s64, s52, 786432
    s_and_b32 s64, s64, 0x3fffff
    s_add_u32 s64, s64, s60
    s_waitcnt lgkmcnt(15)
    v_mfma_f32_32x32x16_bf16 v[160:175], v[68:71], v[104:107], v[160:175]
    buffer_load_dwordx4 v32, s[12:15], s64 offen lds
    v_mfma_f32_32x32x16_bf16 v[176:191], v[68:71], v[108:111], v[176:191]
    ds_read_b64_tr_b16 v[68:69], v61 offset:16384
    ds_read_b64_tr_b16 v[70:71], v61 offset:17408
    buffer_load_dwordx4 v33, s[12:15], s64 offen offset:1024 lds
    v_mfma_f32_32x32x16_bf16 a[32:47], v[104:107], v[84:87], a[32:47]
    s_add_u32 m0, s57, 65536
    s_add_u32 s64, s52, 1048576
    s_and_b32 s64, s64, 0x3fffff
    s_add_u32 s64, s64, s60
    v_mfma_f32_32x32x16_bf16 a[48:63], v[108:111], v[84:87], a[48:63]
    ds_read_b64_tr_b16 v[84:85], v61 offset:24576
    ds_read_b64_tr_b16 v[86:87], v61 offset:25600
    buffer_load_dwordx4 v32, s[8:11], s64 offen lds
    s_waitcnt lgkmcnt(15)
    v_mfma_f32_32x32x16_bf16 v[192:207], v[72:75], v[104:107], v[192:207]
    buffer_load_dwordx4 v33, s[8:11], s64 offen offset:1024 lds
    s_waitcnt lgkmcnt(10)
    v_add_f32 v120, v120, v121
    ds_swizzle_b32 v121, v120 offset:2079
    v_mfma_f32_32x32x16_bf16 v[208:223], v[72:75], v[108:111], v[208:223]
    ds_read_b64_tr_b16 v[72:73], v62 offset:16384
    ds_read_b64_tr_b16 v[74:75], v62 offset:17408
    s_add_u32 m0, s57, 73728
    s_add_u32 s64, s52, 1048576
    s_and_b32 s64, s64, 0x3fffff
    s_add_u32 s64, s64, s60
    v_mfma_f32_32x32x16_bf16 a[64:79], v[104:107], v[88:91], a[64:79]
    buffer_load_dwordx4 v32, s[12:15], s64 offen lds
    v_mfma_f32_32x32x16_bf16 a[80:95], v[108:111], v[88:91], a[80:95]
    ds_read_b64_tr_b16 v[88:89], v62 offset:24576
    ds_read_b64_tr_b16 v[90:91], v62 offset:25600
    buffer_load_dwordx4 v33, s[12:15], s64 offen offset:1024 lds
    v_mfma_f32_32x32x16_bf16 v[224:239], v[76:79], v[104:107], v[224:239]
    s_add_u32 m0, s57, 81920
    s_add_u32 s64, s52, 1310720
    s_and_b32 s64, s64, 0x3fffff
    s_add_u32 s64, s64, s60
    v_mfma_f32_32x32x16_bf16 v[240:255], v[76:79], v[108:111], v[240:255]
    ds_read_b64_tr_b16 v[76:77], v63 offset:16384
    ds_read_b64_tr_b16 v[78:79], v63 offset:17408
    buffer_load_dwordx4 v32, s[8:11], s64 offen lds
    v_mfma_f32_32x32x16_bf16 a[96:111], v[104:107], v[92:95], a[96:111]
    buffer_load_dwordx4 v33, s[8:11], s64 offen offset:1024 lds
    v_mfma_f32_32x32x16_bf16 a[112:127], v[108:111], v[92:95], a[112:127]
    ds_read_b64_tr_b16 v[92:93], v63 offset:24576
    ds_read_b64_tr_b16 v[94:95], v63 offset:25600
    s_add_u32 m0, s57, 90112
    s_add_u32 s64, s52, 1310720
    s_and_b32 s64, s64, 0x3fffff
    s_add_u32 s64, s64, s60
    s_waitcnt lgkmcnt(15)
    v_mfma_f32_32x32x16_bf16 v[128:143], v[64:67], v[96:99], v[128:143]
    ds_read_b128 v[104:107], v23
    buffer_load_dwordx4 v32, s[12:15], s64 offen lds
    v_mfma_f32_32x32x16_bf16 v[144:159], v[64:67], v[100:103], v[144:159]
    ds_read_b64_tr_b16 v[64:65], v60 offset:20480
    ds_read_b64_tr_b16 v[66:67], v60 offset:21504
    buffer_load_dwordx4 v33, s[12:15], s64 offen offset:1024 lds
    s_waitcnt lgkmcnt(15)
    v_mfma_f32_32x32x16_bf16 a[0:15], v[96:99], v[80:83], a[0:15]
    ds_read_b128 v[108:111], v23 offset:4096
    s_waitcnt lgkmcnt(12)
    v_add_f32 v120, v120, v121
    v_mfma_f32_32x32x16_bf16 a[16:31], v[100:103], v[80:83], a[16:31]
    ds_read_b64_tr_b16 v[80:81], v60 offset:28672
    ds_read_b64_tr_b16 v[82:83], v60 offset:29696
    ds_swizzle_b32 v121, v120 offset:4127
    v_mfma_f32_32x32x16_bf16 v[160:175], v[68:71], v[96:99], v[160:175]
    v_mfma_f32_32x32x16_bf16 v[176:191], v[68:71], v[100:103], v[176:191]
    ds_read_b64_tr_b16 v[68:69], v61 offset:20480
    ds_read_b64_tr_b16 v[70:71], v61 offset:21504
    v_mfma_f32_32x32x16_bf16 a[32:47], v[96:99], v[84:87], a[32:47]
    v_mfma_f32_32x32x16_bf16 a[48:63], v[100:103], v[84:87], a[48:63]
    ds_read_b64_tr_b16 v[84:85], v61 offset:28672
    ds_read_b64_tr_b16 v[86:87], v61 offset:29696
    s_waitcnt lgkmcnt(15)
    v_mfma_f32_32x32x16_bf16 v[192:207], v[72:75], v[96:99], v[192:207]
    v_mfma_f32_32x32x16_bf16 v[208:223], v[72:75], v[100:103], v[208:223]
    ds_read_b64_tr_b16 v[72:73], v62 offset:20480
    ds_read_b64_tr_b16 v[74:75], v62 offset:21504
    v_mfma_f32_32x32x16_bf16 a[64:79], v[96:99], v[88:91], a[64:79]
    v_mfma_f32_32x32x16_bf16 a[80:95], v[100:103], v[88:91], a[80:95]
    ds_read_b64_tr_b16 v[88:89], v62 offset:28672
    ds_read_b64_tr_b16 v[90:91], v62 offset:29696
    s_waitcnt lgkmcnt(15)
    v_mfma_f32_32x32x16_bf16 v[224:239], v[76:79], v[96:99], v[224:239]
    s_waitcnt lgkmcnt(8)
    v_add_f32 v120, v120, v121
    ds_swizzle_b32 v121, v120 offset:8223
    v_mfma_f32_32x32x16_bf16 v[240:255], v[76:79], v[100:103], v[240:255]
    ds_read_b64_tr_b16 v[76:77], v63 offset:20480
    ds_read_b64_tr_b16 v[78:79], v63 offset:21504
    v_mfma_f32_32x32x16_bf16 a[96:111], v[96:99], v[92:95], a[96:111]
    v_mfma_f32_32x32x16_bf16 a[112:127], v[100:103], v[92:95], a[112:127]
    ds_read_b64_tr_b16 v[92:93], v63 offset:28672
    ds_read_b64_tr_b16 v[94:95], v63 offset:29696
    v_mfma_f32_32x32x16_bf16 v[128:143], v[64:67], v[104:107], v[128:143]
    s_waitcnt vmcnt(12)
    s_barrier
    ds_read_b128 v[96:99], v20 offset:8192
    v_mfma_f32_32x32x16_bf16 v[144:159], v[64:67], v[108:111], v[144:159]
    ds_read_b64_tr_b16 v[64:65], v60 offset:32768
    ds_read_b64_tr_b16 v[66:67], v60 offset:33792
    v_mfma_f32_32x32x16_bf16 a[0:15], v[104:107], v[80:83], a[0:15]
    ds_read_b128 v[100:103], v20 offset:12288
    s_add_u32 m0, s57, 0
    s_add_u32 s64, s52, 1572864
    s_and_b32 s64, s64, 0x3fffff
    s_add_u32 s64, s64, s60
    v_mfma_f32_32x32x16_bf16 a[16:31], v[108:111], v[80:83], a[16:31]
    ds_read_b64_tr_b16 v[80:81], v60 offset:40960
    ds_read_b64_tr_b16 v[82:83], v60 offset:41984
    s_waitcnt lgkmcnt(15)
    v_mfma_f32_32x32x16_bf16 v[160:175], v[68:71], v[104:107], v[160:175]
    buffer_load_dwordx4 v32, s[8:11], s64 offen lds
    v_mfma_f32_32x32x16_bf16 v[176:191], v[68:71], v[108:111], v[176:191]
    ds_read_b64_tr_b16 v[68:69], v61 offset:32768
    ds_read_b64_tr_b16 v[70:71], v61 offset:33792
    v_mfma_f32_32x32x16_bf16 a[32:47], v[104:107], v[84:87], a[32:47]
    buffer_load_dwordx4 v33, s[8:11], s64 offen offset:1024 lds
    s_waitcnt lgkmcnt(12)
    v_add_f32 v120, v120, v121
    v_mfma_f32_32x32x16_bf16 a[48:63], v[108:111], v[84:87], a[48:63]
    ds_read_b64_tr_b16 v[84:85], v61 offset:40960
    ds_read_b64_tr_b16 v[86:87], v61 offset:41984
    ds_swizzle_b32 v121, v120 offset:16415
    v_mfma_f32_32x32x16_bf16 v[192:207], v[72:75], v[104:107], v[192:207]
    s_add_u32 m0, s57, 8192
    s_add_u32 s64, s52, 1572864
    s_and_b32 s64, s64, 0x3fffff
    s_add_u32 s64, s64, s60
    v_mfma_f32_32x32x16_bf16 v[208:223], v[72:75], v[108:111], v[208:223]
    ds_read_b64_tr_b16 v[72:73], v62 offset:32768
    ds_read_b64_tr_b16 v[74:75], v62 offset:33792
    v_mfma_f32_32x32x16_bf16 a[64:79], v[104:107], v[88:91], a[64:79]
    buffer_load_dwordx4 v32, s[12:15], s64 offen lds
    v_mfma_f32_32x32x16_bf16 a[80:95], v[108:111], v[88:91], a[80:95]
    ds_read_b64_tr_b16 v[88:89], v62 offset:40960
    ds_read_b64_tr_b16 v[90:91], v62 offset:41984
    s_waitcnt lgkmcnt(15)
    v_mfma_f32_32x32x16_bf16 v[224:239], v[76:79], v[104:107], v[224:239]
    buffer_load_dwordx4 v33, s[12:15], s64 offen offset:1024 lds
    v_mfma_f32_32x32x16_bf16 v[240:255], v[76:79], v[108:111], v[240:255]
    ds_read_b64_tr_b16 v[76:77], v63 offset:32768
    ds_read_b64_tr_b16 v[78:79], v63 offset:33792
    v_mfma_f32_32x32x16_bf16 a[96:111], v[104:107], v[92:95], a[96:111]
    v_mfma_f32_32x32x16_bf16 a[112:127], v[108:111], v[92:95], a[112:127]
    ds_read_b64_tr_b16 v[92:93], v63 offset:40960
    ds_read_b64_tr_b16 v[94:95], v63 offset:41984
    s_waitcnt lgkmcnt(15)
    v_mfma_f32_32x32x16_bf16 v[128:143], v[64:67], v[96:99], v[128:143]
    ds_read_b128 v[104:107], v21 offset:8192
    s_waitcnt lgkmcnt(9)
    v_add_f32 v120, v120, v121
    v_mul_f32 v120, 0x3b000000, v120
    v_sub_f32 v40, v40, v120
    v_mfma_f32_32x32x16_bf16 v[144:159], v[64:67], v[100:103], v[144:159]
    ds_read_b64_tr_b16 v[64:65], v60 offset:36864
    ds_read_b64_tr_b16 v[66:67], v60 offset:37888
    s_add_u32 m0, s58, 0
    s_add_u32 s65, s51, 256
    s_and_b32 s65, s65, 0x3ff
    s_add_u32 s65, s65, s59
    v_mfma_f32_32x32x16_bf16 a[0:15], v[96:99], v[80:83], a[0:15]
    ds_read_b128 v[108:111], v21 offset:12288
    buffer_load_dwordx4 v24, s[4:7], s65 offen lds
    v_sub_f32 v41, v41, v120
    v_sub_f32 v42, v42, v120
    v_mfma_f32_32x32x16_bf16 a[16:31], v[100:103], v[80:83], a[16:31]
    ds_read_b64_tr_b16 v[80:81], v60 offset:45056
    ds_read_b64_tr_b16 v[82:83], v60 offset:46080
    buffer_load_dwordx4 v25, s[4:7], s65 offen offset:1024 lds
    v_sub_f32 v43, v43, v120
    v_mfma_f32_32x32x16_bf16 v[160:175], v[68:71], v[96:99], v[160:175]
    buffer_load_dwordx4 v26, s[4:7], s65 offen offset:2048 lds
    v_sub_f32 v44, v44, v120
    v_sub_f32 v45, v45, v120
    v_sub_f32 v46, v46, v120
    v_mfma_f32_32x32x16_bf16 v[176:191], v[68:71], v[100:103], v[176:191]
    ds_read_b64_tr_b16 v[68:69], v61 offset:36864
    ds_read_b64_tr_b16 v[70:71], v61 offset:37888
    buffer_load_dwordx4 v27, s[4:7], s65 offen offset:3072 lds
    v_sub_f32 v47, v47, v120
    v_mfma_f32_32x32x16_bf16 a[32:47], v[96:99], v[84:87], a[32:47]
    v_sub_f32 v48, v48, v120
    v_sub_f32 v49, v49, v120
    v_sub_f32 v50, v50, v120
    v_sub_f32 v51, v51, v120
    v_mfma_f32_32x32x16_bf16 a[48:63], v[100:103], v[84:87], a[48:63]
    ds_read_b64_tr_b16 v[84:85], v61 offset:45056
    ds_read_b64_tr_b16 v[86:87], v61 offset:46080
    s_add_u32 m0, s58, 4096
    s_add_u32 s65, s51, 256
    s_and_b32 s65, s65, 0x3ff
    s_add_u32 s65, s65, s59
    s_waitcnt lgkmcnt(15)
    v_mfma_f32_32x32x16_bf16 v[192:207], v[72:75], v[96:99], v[192:207]
    buffer_load_dwordx4 v28, s[4:7], s65 offen lds
    v_sub_f32 v52, v52, v120
    v_sub_f32 v53, v53, v120
    v_sub_f32 v54, v54, v120
    v_mfma_f32_32x32x16_bf16 v[208:223], v[72:75], v[100:103], v[208:223]
    ds_read_b64_tr_b16 v[72:73], v62 offset:36864
    ds_read_b64_tr_b16 v[74:75], v62 offset:37888
    buffer_load_dwordx4 v29, s[4:7], s65 offen offset:1024 lds
    v_sub_f32 v55, v55, v120
    s_waitcnt lgkmcnt(15)
    v_mfma_f32_32x32x16_bf16 a[64:79], v[96:99], v[88:91], a[64:79]
    buffer_load_dwordx4 v30, s[4:7], s65 offen offset:2048 lds
    v_mul_f32 v122, v40, v40
    v_fmac_f32 v122, v41, v41
    v_fmac_f32 v122, v42, v42
    v_mfma_f32_32x32x16_bf16 a[80:95], v[100:103], v[88:91], a[80:95]
    ds_read_b64_tr_b16 v[88:89], v62 offset:45056
    ds_read_b64_tr_b16 v[90:91], v62 offset:46080
    buffer_load_dwordx4 v31, s[4:7], s65 offen offset:3072 lds
    v_fmac_f32 v122, v43, v43
    s_waitcnt lgkmcnt(15)
    v_mfma_f32_32x32x16_bf16 v[224:239], v[76:79], v[96:99], v[224:239]
    v_fmac_f32 v122, v44, v44
    v_fmac_f32 v122, v45, v45
    v_fmac_f32 v122, v46, v46
    v_fmac_f32 v122, v47, v47
    v_mfma_f32_32x32x16_bf16 v[240:255], v[76:79], v[100:103], v[240:255]
    ds_read_b64_tr_b16 v[76:77], v63 offset:36864
    ds_read_b64_tr_b16 v[78:79], v63 offset:37888
    v_fmac_f32 v122, v48, v48
    v_fmac_f32 v122, v49, v49
    s_waitcnt lgkmcnt(15)
    v_mfma_f32_32x32x16_bf16 a[96:111], v[96:99], v[92:95], a[96:111]
    v_fmac_f32 v122, v50, v50
    v_fmac_f32 v122, v51, v51
    v_fmac_f32 v122, v52, v52
    v_fmac_f32 v122, v53, v53
    v_mfma_f32_32x32x16_bf16 a[112:127], v[100:103], v[92:95], a[112:127]
    ds_read_b64_tr_b16 v[92:93], v63 offset:45056
    ds_read_b64_tr_b16 v[94:95], v63 offset:46080
    v_fmac_f32 v122, v54, v54
    v_fmac_f32 v122, v55, v55
    ds_swizzle_b32 v121, v122 offset:1055
    s_waitcnt lgkmcnt(15)
    v_mfma_f32_32x32x16_bf16 v[128:143], v[64:67], v[104:107], v[128:143]
    s_waitcnt vmcnt(20)
    s_barrier
    s_cmp_lg_u32 s46, 0
    s_cbranch_scc1 KA_ZP
    v_mov_b32 v58, 0
    buffer_load_dword v57, v58, s[40:43], 0 offen sc1
KA_ZP:
    ds_read_b128 v[96:99], v22 offset:8192
    v_mfma_f32_32x32x16_bf16 v[144:159], v[64:67], v[108:111], v[144:159]
    ds_read_b64_tr_b16 v[64:65], v60 offset:49152
    ds_read_b64_tr_b16 v[66:67], v60 offset:50176
    s_waitcnt lgkmcnt(15)
    v_mfma_f32_32x32x16_bf16 a[0:15], v[104:107], v[80:83], a[0:15]
    ds_read_b128 v[100:103], v22 offset:12288
    s_add_u32 m0, s57, 16384
    s_add_u32 s64, s52, 1835008
    s_and_b32 s64, s64, 0x3fffff
    s_add_u32 s64, s64, s60
    v_mfma_f32_32x32x16_bf16 a[16:31], v[108:111], v[80:83], a[16:31]
    ds_read_b64_tr_b16 v[80:81], v60 offset:57344
    ds_read_b64_tr_b16 v[82:83], v60 offset:58368
    s_waitcnt lgkmcnt(15)
    v_mfma_f32_32x32x16_bf16 v[160:175], v[68:71], v[104:107], v[160:175]
    buffer_load_dwordx4 v32, s[8:11], s64 offen lds
    v_mfma_f32_32x32x16_bf16 v[176:191], v[68:71], v[108:111], v[176:191]
    ds_read_b64_tr_b16 v[68:69], v61 offset:49152
    ds_read_b64_tr_b16 v[70:71], v61 offset:50176
    v_mfma_f32_32x32x16_bf16 a[32:47], v[104:107], v[84:87], a[32:47]
    buffer_load_dwordx4 v33, s[8:11], s64 offen offset:1024 lds
    v_mfma_f32_32x32x16_bf16 a[48:63], v[108:111], v[84:87], a[48:63]
    ds_read_b64_tr_b16 v[84:85], v61 offset:57344
    ds_read_b64_tr_b16 v[86:87], v61 offset:58368
    s_waitcnt lgkmcnt(15)
    v_mfma_f32_32x32x16_bf16 v[192:207], v[72:75], v[104:107], v[192:207]
    s_add_u32 m0, s57, 24576
    s_add_u32 s64, s52, 1835008
    s_and_b32 s64, s64, 0x3fffff
    s_add_u32 s64, s64, s60
    v_mfma_f32_32x32x16_bf16 v[208:223], v[72:75], v[108:111], v[208:223]
    ds_read_b64_tr_b16 v[72:73], v62 offset:49152
    ds_read_b64_tr_b16 v[74:75], v62 offset:50176
    s_waitcnt lgkmcnt(12)
    v_add_f32 v122, v122, v121
    ds_swizzle_b32 v121, v122 offset:2079
    v_mfma_f32_32x32x16_bf16 a[64:79], v[104:107], v[88:91], a[64:79]
    buffer_load_dwordx4 v32, s[12:15], s64 offen lds
    v_mfma_f32_32x32x16_bf16 a[80:95], v[108:111], v[88:91], a[80:95]
    ds_read_b64_tr_b16 v[88:89], v62 offset:57344
    ds_read_b64_tr_b16 v[90:91], v62 offset:58368
    v_mfma_f32_32x32x16_bf16 v[224:239], v[76:79], v[104:107], v[224:239]
    buffer_load_dwordx4 v33, s[12:15], s64 offen offset:1024 lds
    v_mfma_f32_32x32x16_bf16 v[240:255], v[76:79], v[108:111], v[240:255]
    ds_read_b64_tr_b16 v[76:77], v63 offset:49152
    ds_read_b64_tr_b16 v[78:79], v63 offset:50176
    v_mfma_f32_32x32x16_bf16 a[96:111], v[104:107], v[92:95], a[96:111]
    v_mfma_f32_32x32x16_bf16 a[112:127], v[108:111], v[92:95], a[112:127]
    ds_read_b64_tr_b16 v[92:93], v63 offset:57344
    ds_read_b64_tr_b16 v[94:95], v63 offset:58368
    s_waitcnt lgkmcnt(15)
    v_mfma_f32_32x32x16_bf16 v[128:143], v[64:67], v[96:99], v[128:143]
    ds_read_b128 v[104:107], v23 offset:8192
    v_mfma_f32_32x32x16_bf16 v[144:159], v[64:67], v[100:103], v[144:159]
    ds_read_b64_tr_b16 v[64:65], v60 offset:53248
    ds_read_b64_tr_b16 v[66:67], v60 offset:54272
    s_waitcnt lgkmcnt(15)
    v_mfma_f32_32x32x16_bf16 a[0:15], v[96:99], v[80:83], a[0:15]
    ds_read_b128 v[108:111], v23 offset:12288
    s_waitcnt lgkmcnt(10)
    v_add_f32 v122, v122, v121
    v_mfma_f32_32x32x16_bf16 a[16:31], v[100:103], v[80:83], a[16:31]
    ds_read_b64_tr_b16 v[80:81], v60 offset:61440
    ds_read_b64_tr_b16 v[82:83], v60 offset:62464
    ds_swizzle_b32 v121, v122 offset:4127
    v_mfma_f32_32x32x16_bf16 v[160:175], v[68:71], v[96:99], v[160:175]
    v_mfma_f32_32x32x16_bf16 v[176:191], v[68:71], v[100:103], v[176:191]
    ds_read_b64_tr_b16 v[68:69], v61 offset:53248
    ds_read_b64_tr_b16 v[70:71], v61 offset:54272
    v_mfma_f32_32x32x16_bf16 a[32:47], v[96:99], v[84:87], a[32:47]
    v_mfma_f32_32x32x16_bf16 a[48:63], v[100:103], v[84:87], a[48:63]
    ds_read_b64_tr_b16 v[84:85], v61 offset:61440
    ds_read_b64_tr_b16 v[86:87], v61 offset:62464
    v_mfma_f32_32x32x16_bf16 v[192:207], v[72:75], v[96:99], v[192:207]
    v_mfma_f32_32x32x16_bf16 v[208:223], v[72:75], v[100:103], v[208:223]
    ds_read_b64_tr_b16 v[72:73], v62 offset:53248
    ds_read_b64_tr_b16 v[74:75], v62 offset:54272
    s_waitcnt lgkmcnt(15)
    v_mfma_f32_32x32x16_bf16 a[64:79], v[96:99], v[88:91], a[64:79]
    v_mfma_f32_32x32x16_bf16 a[80:95], v[100:103], v[88:91], a[80:95]
    ds_read_b64_tr_b16 v[88:89], v62 offset:61440
    ds_read_b64_tr_b16 v[90:91], v62 offset:62464
    v_mfma_f32_32x32x16_bf16 v[224:239], v[76:79], v[96:99], v[224:239]
    s_waitcnt lgkmcnt(8)
    v_add_f32 v122, v122, v121
    ds_swizzle_b32 v121, v122 offset:8223
    v_mfma_f32_32x32x16_bf16 v[240:255], v[76:79], v[100:103], v[240:255]
    ds_read_b64_tr_b16 v[76:77], v63 offset:53248
    ds_read_b64_tr_b16 v[78:79], v63 offset:54272
    v_mfma_f32_32x32x16_bf16 a[96:111], v[96:99], v[92:95], a[96:111]
    v_mfma_f32_32x32x16_bf16 a[112:127], v[100:103], v[92:95], a[112:127]
    ds_read_b64_tr_b16 v[92:93], v63 offset:61440
    ds_read_b64_tr_b16 v[94:95], v63 offset:62464
    v_mfma_f32_32x32x16_bf16 v[128:143], v[64:67], v[104:107], v[128:143]
    s_waitcnt vmcnt(4)
    s_barrier
    ds_read_b128 v[96:99], v20
    v_mfma_f32_32x32x16_bf16 v[144:159], v[64:67], v[108:111], v[144:159]
    ds_read_b64_tr_b16 v[64:65], v16 offset:0
    ds_read_b64_tr_b16 v[66:67], v16 offset:1024
    v_mfma_f32_32x32x16_bf16 a[0:15], v[104:107], v[80:83], a[0:15]
    ds_read_b128 v[100:103], v20 offset:4096
    s_add_u32 m0, s57, 32768
    s_add_u32 s64, s52, 2097152
    s_and_b32 s64, s64, 0x3fffff
    s_add_u32 s64, s64, s60
    v_mfma_f32_32x32x16_bf16 a[16:31], v[108:111], v[80:83], a[16:31]
    ds_read_b64_tr_b16 v[80:81], v16 offset:8192
    ds_read_b64_tr_b16 v[82:83], v16 offset:9216
    s_waitcnt lgkmcnt(15)
    v_mfma_f32_32x32x16_bf16 v[160:175], v[68:71], v[104:107], v[160:175]
    buffer_load_dwordx4 v32, s[8:11], s64 offen lds
    v_mfma_f32_32x32x16_bf16 v[176:191], v[68:71], v[108:111], v[176:191]
    ds_read_b64_tr_b16 v[68:69], v17 offset:0
    ds_read_b64_tr_b16 v[70:71], v17 offset:1024
    v_mfma_f32_32x32x16_bf16 a[32:47], v[104:107], v[84:87], a[32:47]
    buffer_load_dwordx4 v33, s[8:11], s64 offen offset:1024 lds
    s_waitcnt lgkmcnt(12)
    v_add_f32 v122, v122, v121
    v_mfma_f32_32x32x16_bf16 a[48:63], v[108:111], v[84:87], a[48:63]
    ds_read_b64_tr_b16 v[84:85], v17 offset:8192
    ds_read_b64_tr_b16 v[86:87], v17 offset:9216
    ds_swizzle_b32 v121, v122 offset:16415
    v_mfma_f32_32x32x16_bf16 v[192:207], v[72:75], v[104:107], v[192:207]
    s_add_u32 m0, s57, 40960
    s_add_u32 s64, s52, 2097152
    s_and_b32 s64, s64, 0x3fffff
    s_add_u32 s64, s64, s60
    v_mfma_f32_32x32x16_bf16 v[208:223], v[72:75], v[108:111], v[208:223]
    ds_read_b64_tr_b16 v[72:73], v18 offset:0
    ds_read_b64_tr_b16 v[74:75], v18 offset:1024
    v_mfma_f32_32x32x16_bf16 a[64:79], v[104:107], v[88:91], a[64:79]
    buffer_load_dwordx4 v32, s[12:15], s64 offen lds
    v_mfma_f32_32x32x16_bf16 a[80:95], v[108:111], v[88:91], a[80:95]
    ds_read_b64_tr_b16 v[88:89], v18 offset:8192
    ds_read_b64_tr_b16 v[90:91], v18 offset:9216
    s_waitcnt lgkmcnt(15)
    v_mfma_f32_32x32x16_bf16 v[224:239], v[76:79], v[104:107], v[224:239]
    buffer_load_dwordx4 v33, s[12:15], s64 offen offset:1024 lds
    v_mfma_f32_32x32x16_bf16 v[240:255], v[76:79], v[108:111], v[240:255]
    ds_read_b64_tr_b16 v[76:77], v19 offset:0
    ds_read_b64_tr_b16 v[78:79], v19 offset:1024
    v_mfma_f32_32x32x16_bf16 a[96:111], v[104:107], v[92:95], a[96:111]
    v_mfma_f32_32x32x16_bf16 a[112:127], v[108:111], v[92:95], a[112:127]
    ds_read_b64_tr_b16 v[92:93], v19 offset:8192
    ds_read_b64_tr_b16 v[94:95], v19 offset:9216
    s_waitcnt lgkmcnt(15)
    v_mfma_f32_32x32x16_bf16 v[128:143], v[64:67], v[96:99], v[128:143]
    ds_read_b128 v[104:107], v21
    s_waitcnt lgkmcnt(9)
    v_add_f32 v122, v122, v121
    v_mov_b32 v123, 0x3727c5ac
    v_mov_b32 v124, 0x3b000000
    v_mfma_f32_32x32x16_bf16 v[144:159], v[64:67], v[100:103], v[144:159]
    ds_read_b64_tr_b16 v[64:65], v16 offset:4096
    ds_read_b64_tr_b16 v[66:67], v16 offset:5120
    s_add_u32 m0, s58, 8192
    s_add_u32 s65, s51, 384
    s_and_b32 s65, s65, 0x3ff
    s_add_u32 s65, s65, s59
    v_mfma_f32_32x32x16_bf16 a[0:15], v[96:99], v[80:83], a[0:15]
    ds_read_b128 v[108:111], v21 offset:4096
    buffer_load_dwordx4 v24, s[4:7], s65 offen lds
    v_fma_f32 v122, v122, v124, v123
    v_rsq_f32 v122, v122
    v_mfma_f32_32x32x16_bf16 a[16:31], v[100:103], v[80:83], a[16:31]
    ds_read_b64_tr_b16 v[80:81], v16 offset:12288
    ds_read_b64_tr_b16 v[82:83], v16 offset:13312
    buffer_load_dwordx4 v25, s[4:7], s65 offen offset:1024 lds
    v_lshrrev_b32 v125, 5, v0
    v_mfma_f32_32x32x16_bf16 v[160:175], v[68:71], v[96:99], v[160:175]
    buffer_load_dwordx4 v26, s[4:7], s65 offen offset:2048 lds
    v_mul_f32 v122, 0x3e0293ee, v122
    v_mul_f32 v40, v40, v122
    v_mul_f32 v41, v41, v122
    v_mfma_f32_32x32x16_bf16 v[176:191], v[68:71], v[100:103], v[176:191]
    ds_read_b64_tr_b16 v[68:69], v17 offset:4096
    ds_read_b64_tr_b16 v[70:71], v17 offset:5120
    buffer_load_dwordx4 v27, s[4:7], s65 offen offset:3072 lds
    v_mul_f32 v42, v42, v122
    v_mul_f32 v43, v43, v122
    v_mfma_f32_32x32x16_bf16 a[32:47], v[96:99], v[84:87], a[32:47]
    v_mul_f32 v44, v44, v122
    v_mul_f32 v45, v45, v122
    v_mul_f32 v46, v46, v122
    v_mul_f32 v47, v47, v122
    v_mul_f32 v48, v48, v122
    v_mfma_f32_32x32x16_bf16 a[48:63], v[100:103], v[84:87], a[48:63]
    ds_read_b64_tr_b16 v[84:85], v17 offset:12288
    ds_read_b64_tr_b16 v[86:87], v17 offset:13312
    s_add_u32 m0, s58, 12288
    s_add_u32 s65, s51, 384
    s_and_b32 s65, s65, 0x3ff
    s_add_u32 s65, s65, s59
    s_waitcnt lgkmcnt(15)
    v_mfma_f32_32x32x16_bf16 v[192:207], v[72:75], v[96:99], v[192:207]
    buffer_load_dwordx4 v28, s[4:7], s65 offen lds
    v_mul_f32 v49, v49, v122
    v_mul_f32 v50, v50, v122
    v_mul_f32 v51, v51, v122
    v_mul_f32 v52, v52, v122
    v_mfma_f32_32x32x16_bf16 v[208:223], v[72:75], v[100:103], v[208:223]
    ds_read_b64_tr_b16 v[72:73], v18 offset:4096
    ds_read_b64_tr_b16 v[74:75], v18 offset:5120
    buffer_load_dwordx4 v29, s[4:7], s65 offen offset:1024 lds
    v_mul_f32 v53, v53, v122
    v_mul_f32 v54, v54, v122
    s_waitcnt lgkmcnt(15)
    v_mfma_f32_32x32x16_bf16 a[64:79], v[96:99], v[88:91], a[64:79]
    buffer_load_dwordx4 v30, s[4:7], s65 offen offset:2048 lds
    v_mul_f32 v55, v55, v122
    v_cvt_pk_bf16_f32 v112, v40, v41
    v_cvt_pk_bf16_f32 v113, v42, v43
    v_cvt_pk_bf16_f32 v114, v44, v45
    v_mfma_f32_32x32x16_bf16 a[80:95], v[100:103], v[88:91], a[80:95]
    ds_read_b64_tr_b16 v[88:89], v18 offset:12288
    ds_read_b64_tr_b16 v[90:91], v18 offset:13312
    buffer_load_dwordx4 v31, s[4:7], s65 offen offset:3072 lds
    v_cvt_pk_bf16_f32 v115, v46, v47
    v_cvt_pk_bf16_f32 v116, v48, v49
    s_waitcnt lgkmcnt(15)
    v_mfma_f32_32x32x16_bf16 v[224:239], v[76:79], v[96:99], v[224:239]
    v_cvt_pk_bf16_f32 v117, v50, v51
    v_cvt_pk_bf16_f32 v118, v52, v53
    v_cvt_pk_bf16_f32 v119, v54, v55
    v_and_b32 v126, 31, v0
    s_lshl_b32 s67, s2, 3
    v_mfma_f32_32x32x16_bf16 v[240:255], v[76:79], v[100:103], v[240:255]
    ds_read_b64_tr_b16 v[76:77], v19 offset:4096
    ds_read_b64_tr_b16 v[78:79], v19 offset:5120
    v_add_u32 v125, s67, v125
    v_lshrrev_b32 v127, 5, v125
    v_and_b32 v125, 31, v125
    s_waitcnt lgkmcnt(15)
    v_mfma_f32_32x32x16_bf16 a[96:111], v[96:99], v[92:95], a[96:111]
    v_lshlrev_b32 v127, 15, v127
    v_lshl_add_u32 v127, v126, 10, v127
    v_lshl_add_u32 v127, v125, 4, v127
    buffer_store_dwordx4 v[112:115], v127, s[28:31], 0 offen sc1
    buffer_store_dwordx4 v[116:119], v127, s[28:31], 0 offen offset:512 sc1
    v_mfma_f32_32x32x16_bf16 a[112:127], v[100:103], v[92:95], a[112:127]
    ds_read_b64_tr_b16 v[92:93], v19 offset:12288
    ds_read_b64_tr_b16 v[94:95], v19 offset:13312
    s_waitcnt lgkmcnt(15)
    v_mfma_f32_32x32x16_bf16 v[128:143], v[64:67], v[104:107], v[128:143]
    s_waitcnt vmcnt(30)
    s_barrier
    s_cmp_lg_u32 s46, 0
    s_cbranch_scc1 KA_Z2
    s_waitcnt vmcnt(18)
    v_cmp_gt_u32 vcc, 1, v57
    s_nop 0
    s_cbranch_vccnz KA_SP0
KA_SP0_R:
    s_lshl_b32 s69, s44, 7
    s_add_u32 s69, s69, 4
    v_mov_b32 v56, s3
    v_mov_b32 v58, s69
    s_mov_b64 exec, 1
    buffer_atomic_add v56, v58, s[32:35], 0 offen
    s_mov_b64 exec, -1
KA_Z2:
    ds_read_b128 v[96:99], v22
    s_waitcnt lgkmcnt(15)
    v_mfma_f32_32x32x16_bf16 v[144:159], v[64:67], v[108:111], v[144:159]
    ds_read_b64_tr_b16 v[64:65], v16 offset:16384
    ds_read_b64_tr_b16 v[66:67], v16 offset:17408
    s_waitcnt lgkmcnt(15)
    v_mfma_f32_32x32x16_bf16 a[0:15], v[104:107], v[80:83], a[0:15]
    ds_read_b128 v[100:103], v22 offset:4096
    s_add_u32 m0, s57, 49152
    s_add_u32 s64, s52, 2359296
    s_and_b32 s64, s64, 0x3fffff
    s_add_u32 s64, s64, s60
    v_mfma_f32_32x32x16_bf16 a[16:31], v[108:111], v[80:83], a[16:31]
    ds_read_b64_tr_b16 v[80:81], v16 offset:24576
    ds_read_b64_tr_b16 v[82:83], v16 offset:25600
    s_waitcnt lgkmcnt(15)
    v_mfma_f32_32x32x16_bf16 v[160:175], v[68:71], v[104:107], v[160:175]
    buffer_load_dwordx4 v32, s[8:11], s64 offen lds
    v_mfma_f32_32x32x16_bf16 v[176:191], v[68:71], v[108:111], v[176:191]
    ds_read_b64_tr_b16 v[68:69], v17 offset:16384
    ds_read_b64_tr_b16 v[70:71], v17 offset:17408
    s_waitcnt lgkmcnt(15)
    v_mfma_f32_32x32x16_bf16 a[32:47], v[104:107], v[84:87], a[32:47]
    buffer_load_dwordx4 v33, s[8:11], s64 offen offset:1024 lds
    v_mfma_f32_32x32x16_bf16 a[48:63], v[108:111], v[84:87], a[48:63]
    ds_read_b64_tr_b16 v[84:85], v17 offset:24576
    ds_read_b64_tr_b16 v[86:87], v17 offset:25600
    s_waitcnt lgkmcnt(15)
    v_mfma_f32_32x32x16_bf16 v[192:207], v[72:75], v[104:107], v[192:207]
    s_add_u32 m0, s57, 57344
    s_add_u32 s64, s52, 2359296
    s_and_b32 s64, s64, 0x3fffff
    s_add_u32 s64, s64, s60
    v_mfma_f32_32x32x16_bf16 v[208:223], v[72:75], v[108:111], v[208:223]
    ds_read_b64_tr_b16 v[72:73], v18 offset:16384
    ds_read_b64_tr_b16 v[74:75], v18 offset:17408
    s_waitcnt lgkmcnt(15)
    v_mfma_f32_32x32x16_bf16 a[64:79], v[104:107], v[88:91], a[64:79]
    buffer_load_dwordx4 v32, s[12:15], s64 offen lds
    v_mfma_f32_32x32x16_bf16 a[80:95], v[108:111], v[88:91], a[80:95]
    ds_read_b64_tr_b16 v[88:89], v18 offset:24576
    ds_read_b64_tr_b16 v[90:91], v18 offset:25600
    s_waitcnt lgkmcnt(15)
    v_mfma_f32_32x32x16_bf16 v[224:239], v[76:79], v[104:107], v[224:239]
    buffer_load_dwordx4 v33, s[12:15], s64 offen offset:1024 lds
    v_mfma_f32_32x32x16_bf16 v[240:255], v[76:79], v[108:111], v[240:255]
    ds_read_b64_tr_b16 v[76:77], v19 offset:16384
    ds_read_b64_tr_b16 v[78:79], v19 offset:17408
    s_waitcnt lgkmcnt(15)
    v_mfma_f32_32x32x16_bf16 a[96:111], v[104:107], v[92:95], a[96:111]
    v_mfma_f32_32x32x16_bf16 a[112:127], v[108:111], v[92:95], a[112:127]
    ds_read_b64_tr_b16 v[92:93], v19 offset:24576
    ds_read_b64_tr_b16 v[94:95], v19 offset:25600
    s_waitcnt lgkmcnt(15)
    v_mfma_f32_32x32x16_bf16 v[128:143], v[64:67], v[96:99], v[128:143]
    ds_read_b128 v[104:107], v23
    s_waitcnt lgkmcnt(15)
    v_mfma_f32_32x32x16_bf16 v[144:159], v[64:67], v[100:103], v[144:159]
    ds_read_b64_tr_b16 v[64:65], v16 offset:20480
    ds_read_b64_tr_b16 v[66:67], v16 offset:21504
    s_waitcnt lgkmcnt(15)
    v_mfma_f32_32x32x16_bf16 a[0:15], v[96:99], v[80:83], a[0:15]
    ds_read_b128 v[108:111], v23 offset:4096
    v_mfma_f32_32x32x16_bf16 a[16:31], v[100:103], v[80:83], a[16:31]
    ds_read_b64_tr_b16 v[80:81], v16 offset:28672
    ds_read_b64_tr_b16 v[82:83], v16 offset:29696
    s_waitcnt lgkmcnt(15)
    v_mfma_f32_32x32x16_bf16 v[160:175], v[68:71], v[96:99], v[160:175]
    v_mfma_f32_32x32x16_bf16 v[176:191], v[68:71], v[100:103], v[176:191]
    ds_read_b64_tr_b16 v[68:69], v17 offset:20480
    ds_read_b64_tr_b16 v[70:71], v17 offset:21504
    s_waitcnt lgkmcnt(15)
    v_mfma_f32_32x32x16_bf16 a[32:47], v[96:99], v[84:87], a[32:47]
    v_mfma_f32_32x32x16_bf16 a[48:63], v[100:103], v[84:87], a[48:63]
    ds_read_b64_tr_b16 v[84:85], v17 offset:28672
    ds_read_b64_tr_b16 v[86:87], v17 offset:29696
    s_waitcnt lgkmcnt(15)
    v_mfma_f32_32x32x16_bf16 v[192:207], v[72:75], v[96:99], v[192:207]
    v_mfma_f32_32x32x16_bf16 v[208:223], v[72:75], v[100:103], v[208:223]
    ds_read_b64_tr_b16 v[72:73], v18 offset:20480
    ds_read_b64_tr_b16 v[74:75], v18 offset:21504
    s_waitcnt lgkmcnt(15)
    v_mfma_f32_32x32x16_bf16 a[64:79], v[96:99], v[88:91], a[64:79]
    v_mfma_f32_32x32x16_bf16 a[80:95], v[100:103], v[88:91], a[80:95]
    ds_read_b64_tr_b16 v[88:89], v18 offset:28672
    ds_read_b64_tr_b16 v[90:91], v18 offset:29696
    s_waitcnt lgkmcnt(15)
    v_mfma_f32_32x32x16_bf16 v[224:239], v[76:79], v[96:99], v[224:239]
    v_mfma_f32_32x32x16_bf16 v[240:255], v[76:79], v[100:103], v[240:255]
    ds_read_b64_tr_b16 v[76:77], v19 offset:20480
    ds_read_b64_tr_b16 v[78:79], v19 offset:21504
    s_waitcnt lgkmcnt(15)
    v_mfma_f32_32x32x16_bf16 a[96:111], v[96:99], v[92:95], a[96:111]
    v_mfma_f32_32x32x16_bf16 a[112:127], v[100:103], v[92:95], a[112:127]
    ds_read_b64_tr_b16 v[92:93], v19 offset:28672
    ds_read_b64_tr_b16 v[94:95], v19 offset:29696
    s_waitcnt lgkmcnt(15)
    v_mfma_f32_32x32x16_bf16 v[128:143], v[64:67], v[104:107], v[128:143]
    s_waitcnt vmcnt(6)
    s_barrier
    ds_read_b128 v[96:99], v20 offset:8192
    s_waitcnt lgkmcnt(15)
    v_mfma_f32_32x32x16_bf16 v[144:159], v[64:67], v[108:111], v[144:159]
    ds_read_b64_tr_b16 v[64:65], v60 offset:0
    ds_read_b64_tr_b16 v[66:67], v60 offset:1024
    s_waitcnt lgkmcnt(15)
    v_mfma_f32_32x32x16_bf16 a[0:15], v[104:107], v[80:83], a[0:15]
    ds_read_b128 v[100:103], v20 offset:12288
    s_add_u32 m0, s57, 65536
    s_add_u32 s64, s52, 2621440
    s_and_b32 s64, s64, 0x3fffff
    s_add_u32 s64, s64, s60
    v_mfma_f32_32x32x16_bf16 a[16:31], v[108:111], v[80:83], a[16:31]
    ds_read_b64_tr_b16 v[80:81], v60 offset:8192
    ds_read_b64_tr_b16 v[82:83], v60 offset:9216
    s_waitcnt lgkmcnt(15)
    v_mfma_f32_32x32x16_bf16 v[160:175], v[68:71], v[104:107], v[160:175]
    buffer_load_dwordx4 v32, s[8:11], s64 offen lds
    v_mfma_f32_32x32x16_bf16 v[176:191], v[68:71], v[108:111], v[176:191]
    ds_read_b64_tr_b16 v[68:69], v61 offset:0
    ds_read_b64_tr_b16 v[70:71], v61 offset:1024
    s_waitcnt lgkmcnt(15)
    v_mfma_f32_32x32x16_bf16 a[32:47], v[104:107], v[84:87], a[32:47]
    buffer_load_dwordx4 v33, s[8:11], s64 offen offset:1024 lds
    v_mfma_f32_32x32x16_bf16 a[48:63], v[108:111], v[84:87], a[48:63]
    ds_read_b64_tr_b16 v[84:85], v61 offset:8192
    ds_read_b64_tr_b16 v[86:87], v61 offset:9216
    s_waitcnt lgkmcnt(15)
    v_mfma_f32_32x32x16_bf16 v[192:207], v[72:75], v[104:107], v[192:207]
    s_add_u32 m0, s57, 73728
    s_add_u32 s64, s52, 2621440
    s_and_b32 s64, s64, 0x3fffff
    s_add_u32 s64, s64, s60
    v_mfma_f32_32x32x16_bf16 v[208:223], v[72:75], v[108:111], v[208:223]
    ds_read_b64_tr_b16 v[72:73], v62 offset:0
    ds_read_b64_tr_b16 v[74:75], v62 offset:1024
    s_waitcnt lgkmcnt(15)
    v_mfma_f32_32x32x16_bf16 a[64:79], v[104:107], v[88:91], a[64:79]
    buffer_load_dwordx4 v32, s[12:15], s64 offen lds
    v_mfma_f32_32x32x16_bf16 a[80:95], v[108:111], v[88:91], a[80:95]
    ds_read_b64_tr_b16 v[88:89], v62 offset:8192
    ds_read_b64_tr_b16 v[90:91], v62 offset:9216
    s_waitcnt lgkmcnt(15)
    v_mfma_f32_32x32x16_bf16 v[224:239], v[76:79], v[104:107], v[224:239]
    buffer_load_dwordx4 v33, s[12:15], s64 offen offset:1024 lds
    v_mfma_f32_32x32x16_bf16 v[240:255], v[76:79], v[108:111], v[240:255]
    ds_read_b64_tr_b16 v[76:77], v63 offset:0
    ds_read_b64_tr_b16 v[78:79], v63 offset:1024
    s_waitcnt lgkmcnt(15)
    v_mfma_f32_32x32x16_bf16 a[96:111], v[104:107], v[92:95], a[96:111]
    v_mfma_f32_32x32x16_bf16 a[112:127], v[108:111], v[92:95], a[112:127]
    ds_read_b64_tr_b16 v[92:93], v63 offset:8192
    ds_read_b64_tr_b16 v[94:95], v63 offset:9216
    s_waitcnt lgkmcnt(15)
    v_mfma_f32_32x32x16_bf16 v[128:143], v[64:67], v[96:99], v[128:143]
    ds_read_b128 v[104:107], v21 offset:8192
    s_waitcnt lgkmcnt(15)
    v_mfma_f32_32x32x16_bf16 v[144:159], v[64:67], v[100:103], v[144:159]
    ds_read_b64_tr_b16 v[64:65], v60 offset:4096
    ds_read_b64_tr_b16 v[66:67], v60 offset:5120
    s_add_u32 m0, s58, 0
    s_add_u32 s65, s51, 512
    s_and_b32 s65, s65, 0x3ff
    s_add_u32 s65, s65, s59
    s_waitcnt lgkmcnt(15)
    v_mfma_f32_32x32x16_bf16 a[0:15], v[96:99], v[80:83], a[0:15]
    ds_read_b128 v[108:111], v21 offset:12288
    buffer_load_dwordx4 v24, s[4:7], s65 offen lds
    v_mfma_f32_32x32x16_bf16 a[16:31], v[100:103], v[80:83], a[16:31]
    ds_read_b64_tr_b16 v[80:81], v60 offset:12288
    ds_read_b64_tr_b16 v[82:83], v60 offset:13312
    buffer_load_dwordx4 v25, s[4:7], s65 offen offset:1024 lds
    s_waitcnt lgkmcnt(15)
    v_mfma_f32_32x32x16_bf16 v[160:175], v[68:71], v[96:99], v[160:175]
    buffer_load_dwordx4 v26, s[4:7], s65 offen offset:2048 lds
    v_mfma_f32_32x32x16_bf16 v[176:191], v[68:71], v[100:103], v[176:191]
    ds_read_b64_tr_b16 v[68:69], v61 offset:4096
    ds_read_b64_tr_b16 v[70:71], v61 offset:5120
    buffer_load_dwordx4 v27, s[4:7], s65 offen offset:3072 lds
    s_waitcnt lgkmcnt(15)
    v_mfma_f32_32x32x16_bf16 a[32:47], v[96:99], v[84:87], a[32:47]
    v_mfma_f32_32x32x16_bf16 a[48:63], v[100:103], v[84:87], a[48:63]
    ds_read_b64_tr_b16 v[84:85], v61 offset:12288
    ds_read_b64_tr_b16 v[86:87], v61 offset:13312
    s_add_u32 m0, s58, 4096
    s_add_u32 s65, s51, 512
    s_and_b32 s65, s65, 0x3ff
    s_add_u32 s65, s65, s59
    s_waitcnt lgkmcnt(15)
    v_mfma_f32_32x32x16_bf16 v[192:207], v[72:75], v[96:99], v[192:207]
    buffer_load_dwordx4 v28, s[4:7], s65 offen lds
    v_mfma_f32_32x32x16_bf16 v[208:223], v[72:75], v[100:103], v[208:223]
    ds_read_b64_tr_b16 v[72:73], v62 offset:4096
    ds_read_b64_tr_b16 v[74:75], v62 offset:5120
    buffer_load_dwordx4 v29, s[4:7], s65 offen offset:1024 lds
    s_waitcnt lgkmcnt(15)
    v_mfma_f32_32x32x16_bf16 a[64:79], v[96:99], v[88:91], a[64:79]
    buffer_load_dwordx4 v30, s[4:7], s65 offen offset:2048 lds
    v_mfma_f32_32x32x16_bf16 a[80:95], v[100:103], v[88:91], a[80:95]
    ds_read_b64_tr_b16 v[88:89], v62 offset:12288
    ds_read_b64_tr_b16 v[90:91], v62 offset:13312
    buffer_load_dwordx4 v31, s[4:7], s65 offen offset:3072 lds
    s_waitcnt lgkmcnt(15)
    v_mfma_f32_32x32x16_bf16 v[224:239], v[76:79], v[96:99], v[224:239]
    v_mfma_f32_32x32x16_bf16 v[240:255], v[76:79], v[100:103], v[240:255]
    ds_read_b64_tr_b16 v[76:77], v63 offset:4096
    ds_read_b64_tr_b16 v[78:79], v63 offset:5120
    s_waitcnt lgkmcnt(15)
    v_mfma_f32_32x32x16_bf16 a[96:111], v[96:99], v[92:95], a[96:111]
    v_mfma_f32_32x32x16_bf16 a[112:127], v[100:103], v[92:95], a[112:127]
    ds_read_b64_tr_b16 v[92:93], v63 offset:12288
    ds_read_b64_tr_b16 v[94:95], v63 offset:13312
    s_waitcnt lgkmcnt(15)
    v_mfma_f32_32x32x16_bf16 v[128:143], v[64:67], v[104:107], v[128:143]
    s_waitcnt vmcnt(16)
    s_barrier
    s_cmp_lg_u32 s46, 0
    s_cbranch_scc1 KA_SIG1
    s_lshr_b32 s69, s2, 4
    s_add_u32 s69, s69, 32
    s_lshl_b32 s69, s69, 7
    v_mov_b32 v56, 1
    v_mov_b32 v58, s69
    s_mov_b64 exec, 1
    buffer_atomic_add v56, v58, s[32:35], 0 offen
    s_mov_b64 exec, -1
KA_SIG1:
    ds_read_b128 v[96:99], v22 offset:8192
    s_waitcnt lgkmcnt(15)
    v_mfma_f32_32x32x16_bf16 v[144:159], v[64:67], v[108:111], v[144:159]
    ds_read_b64_tr_b16 v[64:65], v60 offset:16384
    ds_read_b64_tr_b16 v[66:67], v60 offset:17408
    s_waitcnt lgkmcnt(15)
    v_mfma_f32_32x32x16_bf16 a[0:15], v[104:107], v[80:83], a[0:15]
    ds_read_b128 v[100:103], v22 offset:12288
    s_add_u32 m0, s57, 81920
    s_add_u32 s64, s52, 2883584
    s_and_b32 s64, s64, 0x3fffff
    s_add_u32 s64, s64, s60
    v_mfma_f32_32x32x16_bf16 a[16:31], v[108:111], v[80:83], a[16:31]
    ds_read_b64_tr_b16 v[80:81], v60 offset:24576
    ds_read_b64_tr_b16 v[82:83], v60 offset:25600
    s_waitcnt lgkmcnt(15)
    v_mfma_f32_32x32x16_bf16 v[160:175], v[68:71], v[104:107], v[160:175]
    buffer_load_dwordx4 v32, s[8:11], s64 offen lds
    v_mfma_f32_32x32x16_bf16 v[176:191], v[68:71], v[108:111], v[176:191]
    ds_read_b64_tr_b16 v[68:69], v61 offset:16384
    ds_read_b64_tr_b16 v[70:71], v61 offset:17408
    s_waitcnt lgkmcnt(15)
    v_mfma_f32_32x32x16_bf16 a[32:47], v[104:107], v[84:87], a[32:47]
    buffer_load_dwordx4 v33, s[8:11], s64 offen offset:1024 lds
    v_mfma_f32_32x32x16_bf16 a[48:63], v[108:111], v[84:87], a[48:63]
    ds_read_b64_tr_b16 v[84:85], v61 offset:24576
    ds_read_b64_tr_b16 v[86:87], v61 offset:25600
    s_waitcnt lgkmcnt(15)
    v_mfma_f32_32x32x16_bf16 v[192:207], v[72:75], v[104:107], v[192:207]
    s_add_u32 m0, s57, 90112
    s_add_u32 s64, s52, 2883584
    s_and_b32 s64, s64, 0x3fffff
    s_add_u32 s64, s64, s60
    v_mfma_f32_32x32x16_bf16 v[208:223], v[72:75], v[108:111], v[208:223]
    ds_read_b64_tr_b16 v[72:73], v62 offset:16384
    ds_read_b64_tr_b16 v[74:75], v62 offset:17408
    s_waitcnt lgkmcnt(15)
    v_mfma_f32_32x32x16_bf16 a[64:79], v[104:107], v[88:91], a[64:79]
    buffer_load_dwordx4 v32, s[12:15], s64 offen lds
    v_mfma_f32_32x32x16_bf16 a[80:95], v[108:111], v[88:91], a[80:95]
    ds_read_b64_tr_b16 v[88:89], v62 offset:24576
    ds_read_b64_tr_b16 v[90:91], v62 offset:25600
    s_waitcnt lgkmcnt(15)
    v_mfma_f32_32x32x16_bf16 v[224:239], v[76:79], v[104:107], v[224:239]
    buffer_load_dwordx4 v33, s[12:15], s64 offen offset:1024 lds
    v_mfma_f32_32x32x16_bf16 v[240:255], v[76:79], v[108:111], v[240:255]
    ds_read_b64_tr_b16 v[76:77], v63 offset:16384
    ds_read_b64_tr_b16 v[78:79], v63 offset:17408
    s_waitcnt lgkmcnt(15)
    v_mfma_f32_32x32x16_bf16 a[96:111], v[104:107], v[92:95], a[96:111]
    v_mfma_f32_32x32x16_bf16 a[112:127], v[108:111], v[92:95], a[112:127]
    ds_read_b64_tr_b16 v[92:93], v63 offset:24576
    ds_read_b64_tr_b16 v[94:95], v63 offset:25600
    s_waitcnt lgkmcnt(15)
    v_mfma_f32_32x32x16_bf16 v[128:143], v[64:67], v[96:99], v[128:143]
    ds_read_b128 v[104:107], v23 offset:8192
    v_lshrrev_b32 v1, 4, v0
    v_and_b32 v3, 15, v0
    s_waitcnt lgkmcnt(15)
    v_mfma_f32_32x32x16_bf16 v[144:159], v[64:67], v[100:103], v[144:159]
    ds_read_b64_tr_b16 v[64:65], v60 offset:20480
    ds_read_b64_tr_b16 v[66:67], v60 offset:21504
    s_waitcnt lgkmcnt(15)
    v_mfma_f32_32x32x16_bf16 a[0:15], v[96:99], v[80:83], a[0:15]
    ds_read_b128 v[108:111], v23 offset:12288
    v_lshlrev_b32 v1, 13, v1
    v_lshl_add_u32 v1, v3, 4, v1
    v_mfma_f32_32x32x16_bf16 a[16:31], v[100:103], v[80:83], a[16:31]
    ds_read_b64_tr_b16 v[80:81], v60 offset:28672
    ds_read_b64_tr_b16 v[82:83], v60 offset:29696
    s_waitcnt lgkmcnt(15)
    v_mfma_f32_32x32x16_bf16 v[160:175], v[68:71], v[96:99], v[160:175]
    s_lshl_b32 s68, s45, 19
    s_add_u32 s68, s68, s60
    v_mfma_f32_32x32x16_bf16 v[176:191], v[68:71], v[100:103], v[176:191]
    ds_read_b64_tr_b16 v[68:69], v61 offset:20480
    ds_read_b64_tr_b16 v[70:71], v61 offset:21504
    s_waitcnt lgkmcnt(15)
    v_mfma_f32_32x32x16_bf16 a[32:47], v[96:99], v[84:87], a[32:47]
    s_add_u32 s69, s68, 0
    buffer_load_dwordx4 a[160:163], v1, s[16:19], s69 offen
    v_mfma_f32_32x32x16_bf16 a[48:63], v[100:103], v[84:87], a[48:63]
    ds_read_b64_tr_b16 v[84:85], v61 offset:28672
    ds_read_b64_tr_b16 v[86:87], v61 offset:29696
    s_waitcnt lgkmcnt(15)
    v_mfma_f32_32x32x16_bf16 v[192:207], v[72:75], v[96:99], v[192:207]
    s_add_u32 s69, s68, 131072
    buffer_load_dwordx4 a[164:167], v1, s[16:19], s69 offen
    v_mfma_f32_32x32x16_bf16 v[208:223], v[72:75], v[100:103], v[208:223]
    ds_read_b64_tr_b16 v[72:73], v62 offset:20480
    ds_read_b64_tr_b16 v[74:75], v62 offset:21504
    s_waitcnt lgkmcnt(15)
    v_mfma_f32_32x32x16_bf16 a[64:79], v[96:99], v[88:91], a[64:79]
    s_add_u32 s69, s68, 262144
    buffer_load_dwordx4 a[168:171], v1, s[16:19], s69 offen
    v_mfma_f32_32x32x16_bf16 a[80:95], v[100:103], v[88:91], a[80:95]
    ds_read_b64_tr_b16 v[88:89], v62 offset:28672
    ds_read_b64_tr_b16 v[90:91], v62 offset:29696
    s_waitcnt lgkmcnt(15)
    v_mfma_f32_32x32x16_bf16 v[224:239], v[76:79], v[96:99], v[224:239]
    s_add_u32 s69, s68, 393216
    buffer_load_dwordx4 a[172:175], v1, s[16:19], s69 offen
    v_mfma_f32_32x32x16_bf16 v[240:255], v[76:79], v[100:103], v[240:255]
    ds_read_b64_tr_b16 v[76:77], v63 offset:20480
    ds_read_b64_tr_b16 v[78:79], v63 offset:21504
    s_waitcnt lgkmcnt(15)
    v_mfma_f32_32x32x16_bf16 a[96:111], v[96:99], v[92:95], a[96:111]
    v_mfma_f32_32x32x16_bf16 a[112:127], v[100:103], v[92:95], a[112:127]
    ds_read_b64_tr_b16 v[92:93], v63 offset:28672
    ds_read_b64_tr_b16 v[94:95], v63 offset:29696
    s_waitcnt lgkmcnt(15)
    v_mfma_f32_32x32x16_bf16 v[128:143], v[64:67], v[104:107], v[128:143]
    s_waitcnt vmcnt(8)
    s_barrier
    ds_read_b128 v[96:99], v20
    s_waitcnt lgkmcnt(15)
    v_mfma_f32_32x32x16_bf16 v[144:159], v[64:67], v[108:111], v[144:159]
    ds_read_b64_tr_b16 v[64:65], v60 offset:32768
    ds_read_b64_tr_b16 v[66:67], v60 offset:33792
    s_waitcnt lgkmcnt(15)
    v_mfma_f32_32x32x16_bf16 a[0:15], v[104:107], v[80:83], a[0:15]
    ds_read_b128 v[100:103], v20 offset:4096
    s_add_u32 m0, s57, 0
    s_add_u32 s64, s52, 3145728
    s_and_b32 s64, s64, 0x3fffff
    s_add_u32 s64, s64, s60
    v_mfma_f32_32x32x16_bf16 a[16:31], v[108:111], v[80:83], a[16:31]
    ds_read_b64_tr_b16 v[80:81], v60 offset:40960
    ds_read_b64_tr_b16 v[82:83], v60 offset:41984
    s_waitcnt lgkmcnt(15)
    v_mfma_f32_32x32x16_bf16 v[160:175], v[68:71], v[104:107], v[160:175]
    buffer_load_dwordx4 v32, s[8:11], s64 offen lds
    v_mfma_f32_32x32x16_bf16 v[176:191], v[68:71], v[108:111], v[176:191]
    ds_read_b64_tr_b16 v[68:69], v61 offset:32768
    ds_read_b64_tr_b16 v[70:71], v61 offset:33792
    s_waitcnt lgkmcnt(15)
    v_mfma_f32_32x32x16_bf16 a[32:47], v[104:107], v[84:87], a[32:47]
    buffer_load_dwordx4 v33, s[8:11], s64 offen offset:1024 lds
    v_mfma_f32_32x32x16_bf16 a[48:63], v[108:111], v[84:87], a[48:63]
    ds_read_b64_tr_b16 v[84:85], v61 offset:40960
    ds_read_b64_tr_b16 v[86:87], v61 offset:41984
    s_waitcnt lgkmcnt(15)
    v_mfma_f32_32x32x16_bf16 v[192:207], v[72:75], v[104:107], v[192:207]
    s_add_u32 m0, s57, 8192
    s_add_u32 s64, s52, 3145728
    s_and_b32 s64, s64, 0x3fffff
    s_add_u32 s64, s64, s60
    v_mfma_f32_32x32x16_bf16 v[208:223], v[72:75], v[108:111], v[208:223]
    ds_read_b64_tr_b16 v[72:73], v62 offset:32768
    ds_read_b64_tr_b16 v[74:75], v62 offset:33792
    s_waitcnt lgkmcnt(15)
    v_mfma_f32_32x32x16_bf16 a[64:79], v[104:107], v[88:91], a[64:79]
    buffer_load_dwordx4 v32, s[12:15], s64 offen lds
    v_mfma_f32_32x32x16_bf16 a[80:95], v[108:111], v[88:91], a[80:95]
    ds_read_b64_tr_b16 v[88:89], v62 offset:40960
    ds_read_b64_tr_b16 v[90:91], v62 offset:41984
    s_waitcnt lgkmcnt(15)
    v_mfma_f32_32x32x16_bf16 v[224:239], v[76:79], v[104:107], v[224:239]
    buffer_load_dwordx4 v33, s[12:15], s64 offen offset:1024 lds
    v_mfma_f32_32x32x16_bf16 v[240:255], v[76:79], v[108:111], v[240:255]
    ds_read_b64_tr_b16 v[76:77], v63 offset:32768
    ds_read_b64_tr_b16 v[78:79], v63 offset:33792
    s_waitcnt lgkmcnt(15)
    v_mfma_f32_32x32x16_bf16 a[96:111], v[104:107], v[92:95], a[96:111]
    v_mfma_f32_32x32x16_bf16 a[112:127], v[108:111], v[92:95], a[112:127]
    ds_read_b64_tr_b16 v[92:93], v63 offset:40960
    ds_read_b64_tr_b16 v[94:95], v63 offset:41984
    s_waitcnt lgkmcnt(15)
    v_mfma_f32_32x32x16_bf16 v[128:143], v[64:67], v[96:99], v[128:143]
    ds_read_b128 v[104:107], v21
    s_waitcnt lgkmcnt(15)
    v_mfma_f32_32x32x16_bf16 v[144:159], v[64:67], v[100:103], v[144:159]
    ds_read_b64_tr_b16 v[64:65], v60 offset:36864
    ds_read_b64_tr_b16 v[66:67], v60 offset:37888
    s_add_u32 m0, s58, 8192
    s_add_u32 s65, s51, 640
    s_and_b32 s65, s65, 0x3ff
    s_add_u32 s65, s65, s59
    s_waitcnt lgkmcnt(15)
    v_mfma_f32_32x32x16_bf16 a[0:15], v[96:99], v[80:83], a[0:15]
    ds_read_b128 v[108:111], v21 offset:4096
    buffer_load_dwordx4 v24, s[4:7], s65 offen lds
    v_mfma_f32_32x32x16_bf16 a[16:31], v[100:103], v[80:83], a[16:31]
    ds_read_b64_tr_b16 v[80:81], v60 offset:45056
    ds_read_b64_tr_b16 v[82:83], v60 offset:46080
    buffer_load_dwordx4 v25, s[4:7], s65 offen offset:1024 lds
    s_waitcnt lgkmcnt(15)
    v_mfma_f32_32x32x16_bf16 v[160:175], v[68:71], v[96:99], v[160:175]
    buffer_load_dwordx4 v26, s[4:7], s65 offen offset:2048 lds
    v_mfma_f32_32x32x16_bf16 v[176:191], v[68:71], v[100:103], v[176:191]
    ds_read_b64_tr_b16 v[68:69], v61 offset:36864
    ds_read_b64_tr_b16 v[70:71], v61 offset:37888
    buffer_load_dwordx4 v27, s[4:7], s65 offen offset:3072 lds
    s_waitcnt lgkmcnt(15)
    v_mfma_f32_32x32x16_bf16 a[32:47], v[96:99], v[84:87], a[32:47]
    v_mfma_f32_32x32x16_bf16 a[48:63], v[100:103], v[84:87], a[48:63]
    ds_read_b64_tr_b16 v[84:85], v61 offset:45056
    ds_read_b64_tr_b16 v[86:87], v61 offset:46080
    s_add_u32 m0, s58, 12288
    s_add_u32 s65, s51, 640
    s_and_b32 s65, s65, 0x3ff
    s_add_u32 s65, s65, s59
    s_waitcnt lgkmcnt(15)
    v_mfma_f32_32x32x16_bf16 v[192:207], v[72:75], v[96:99], v[192:207]
    buffer_load_dwordx4 v28, s[4:7], s65 offen lds
    v_mfma_f32_32x32x16_bf16 v[208:223], v[72:75], v[100:103], v[208:223]
    ds_read_b64_tr_b16 v[72:73], v62 offset:36864
    ds_read_b64_tr_b16 v[74:75], v62 offset:37888
    buffer_load_dwordx4 v29, s[4:7], s65 offen offset:1024 lds
    s_waitcnt lgkmcnt(15)
    v_mfma_f32_32x32x16_bf16 a[64:79], v[96:99], v[88:91], a[64:79]
    buffer_load_dwordx4 v30, s[4:7], s65 offen offset:2048 lds
    v_mfma_f32_32x32x16_bf16 a[80:95], v[100:103], v[88:91], a[80:95]
    ds_read_b64_tr_b16 v[88:89], v62 offset:45056
    ds_read_b64_tr_b16 v[90:91], v62 offset:46080
    buffer_load_dwordx4 v31, s[4:7], s65 offen offset:3072 lds
    s_waitcnt lgkmcnt(15)
    v_mfma_f32_32x32x16_bf16 v[224:239], v[76:79], v[96:99], v[224:239]
    v_mfma_f32_32x32x16_bf16 v[240:255], v[76:79], v[100:103], v[240:255]
    ds_read_b64_tr_b16 v[76:77], v63 offset:36864
    ds_read_b64_tr_b16 v[78:79], v63 offset:37888
    s_waitcnt lgkmcnt(15)
    v_mfma_f32_32x32x16_bf16 a[96:111], v[96:99], v[92:95], a[96:111]
    v_mfma_f32_32x32x16_bf16 a[112:127], v[100:103], v[92:95], a[112:127]
    ds_read_b64_tr_b16 v[92:93], v63 offset:45056
    ds_read_b64_tr_b16 v[94:95], v63 offset:46080
    s_waitcnt lgkmcnt(15)
    v_mfma_f32_32x32x16_bf16 v[128:143], v[64:67], v[104:107], v[128:143]
    s_waitcnt vmcnt(32)
    s_barrier
    ds_read_b128 v[96:99], v22
    s_waitcnt lgkmcnt(15)
    v_mfma_f32_32x32x16_bf16 v[144:159], v[64:67], v[108:111], v[144:159]
    ds_read_b64_tr_b16 v[64:65], v60 offset:49152
    ds_read_b64_tr_b16 v[66:67], v60 offset:50176
    s_waitcnt lgkmcnt(15)
    v_mfma_f32_32x32x16_bf16 a[0:15], v[104:107], v[80:83], a[0:15]
    ds_read_b128 v[100:103], v22 offset:4096
    s_add_u32 m0, s57, 16384
    s_add_u32 s64, s52, 3407872
    s_and_b32 s64, s64, 0x3fffff
    s_add_u32 s64, s64, s60
    v_mfma_f32_32x32x16_bf16 a[16:31], v[108:111], v[80:83], a[16:31]
    ds_read_b64_tr_b16 v[80:81], v60 offset:57344
    ds_read_b64_tr_b16 v[82:83], v60 offset:58368
    s_waitcnt lgkmcnt(15)
    v_mfma_f32_32x32x16_bf16 v[160:175], v[68:71], v[104:107], v[160:175]
    buffer_load_dwordx4 v32, s[8:11], s64 offen lds
    v_mfma_f32_32x32x16_bf16 v[176:191], v[68:71], v[108:111], v[176:191]
    ds_read_b64_tr_b16 v[68:69], v61 offset:49152
    ds_read_b64_tr_b16 v[70:71], v61 offset:50176
    s_waitcnt lgkmcnt(15)
    v_mfma_f32_32x32x16_bf16 a[32:47], v[104:107], v[84:87], a[32:47]
    buffer_load_dwordx4 v33, s[8:11], s64 offen offset:1024 lds
    v_mfma_f32_32x32x16_bf16 a[48:63], v[108:111], v[84:87], a[48:63]
    ds_read_b64_tr_b16 v[84:85], v61 offset:57344
    ds_read_b64_tr_b16 v[86:87], v61 offset:58368
    s_waitcnt lgkmcnt(15)
    v_mfma_f32_32x32x16_bf16 v[192:207], v[72:75], v[104:107], v[192:207]
    s_add_u32 m0, s57, 24576
    s_add_u32 s64, s52, 3407872
    s_and_b32 s64, s64, 0x3fffff
    s_add_u32 s64, s64, s60
    v_mfma_f32_32x32x16_bf16 v[208:223], v[72:75], v[108:111], v[208:223]
    ds_read_b64_tr_b16 v[72:73], v62 offset:49152
    ds_read_b64_tr_b16 v[74:75], v62 offset:50176
    s_waitcnt lgkmcnt(15)
    v_mfma_f32_32x32x16_bf16 a[64:79], v[104:107], v[88:91], a[64:79]
    buffer_load_dwordx4 v32, s[12:15], s64 offen lds
    v_mfma_f32_32x32x16_bf16 a[80:95], v[108:111], v[88:91], a[80:95]
    ds_read_b64_tr_b16 v[88:89], v62 offset:57344
    ds_read_b64_tr_b16 v[90:91], v62 offset:58368
    s_waitcnt lgkmcnt(15)
    v_mfma_f32_32x32x16_bf16 v[224:239], v[76:79], v[104:107], v[224:239]
    buffer_load_dwordx4 v33, s[12:15], s64 offen offset:1024 lds
    v_mfma_f32_32x32x16_bf16 v[240:255], v[76:79], v[108:111], v[240:255]
    ds_read_b64_tr_b16 v[76:77], v63 offset:49152
    ds_read_b64_tr_b16 v[78:79], v63 offset:50176
    s_waitcnt lgkmcnt(15)
    v_mfma_f32_32x32x16_bf16 a[96:111], v[104:107], v[92:95], a[96:111]
    v_mfma_f32_32x32x16_bf16 a[112:127], v[108:111], v[92:95], a[112:127]
    ds_read_b64_tr_b16 v[92:93], v63 offset:57344
    ds_read_b64_tr_b16 v[94:95], v63 offset:58368
    s_waitcnt lgkmcnt(15)
    v_mfma_f32_32x32x16_bf16 v[128:143], v[64:67], v[96:99], v[128:143]
    ds_read_b128 v[104:107], v23
    s_waitcnt lgkmcnt(15)
    v_mfma_f32_32x32x16_bf16 v[144:159], v[64:67], v[100:103], v[144:159]
    ds_read_b64_tr_b16 v[64:65], v60 offset:53248
    ds_read_b64_tr_b16 v[66:67], v60 offset:54272
    s_add_u32 s69, s47, 32
    s_lshl_b32 s69, s69, 7
    v_mov_b32 v58, s69
    s_add_u32 s69, s48, 32
    s_lshl_b32 s69, s69, 7
    s_waitcnt lgkmcnt(15)
    v_mfma_f32_32x32x16_bf16 a[0:15], v[96:99], v[80:83], a[0:15]
    ds_read_b128 v[108:111], v23 offset:4096
    v_mfma_f32_32x32x16_bf16 a[16:31], v[100:103], v[80:83], a[16:31]
    ds_read_b64_tr_b16 v[80:81], v60 offset:61440
    ds_read_b64_tr_b16 v[82:83], v60 offset:62464
    v_mov_b32 v59, s69
    v_cmp_gt_u32 vcc, 32, v2
    v_mov_b32 v1, 16
    s_waitcnt lgkmcnt(15)
    v_mfma_f32_32x32x16_bf16 v[160:175], v[68:71], v[96:99], v[160:175]
    v_mfma_f32_32x32x16_bf16 v[176:191], v[68:71], v[100:103], v[176:191]
    ds_read_b64_tr_b16 v[68:69], v61 offset:53248
    ds_read_b64_tr_b16 v[70:71], v61 offset:54272
    v_cndmask_b32 v58, v59, v58, vcc
    s_lshl_b32 s69, s44, 7
    s_add_u32 s69, s69, 4
    v_mov_b32 v59, s69
    v_cmp_gt_u32 vcc, 48, v2
    s_waitcnt lgkmcnt(15)
    v_mfma_f32_32x32x16_bf16 a[32:47], v[96:99], v[84:87], a[32:47]
    v_mfma_f32_32x32x16_bf16 a[48:63], v[100:103], v[84:87], a[48:63]
    ds_read_b64_tr_b16 v[84:85], v61 offset:61440
    ds_read_b64_tr_b16 v[86:87], v61 offset:62464
    v_mov_b32 v6, 0x8000000
    s_waitcnt lgkmcnt(15)
    v_mfma_f32_32x32x16_bf16 v[192:207], v[72:75], v[96:99], v[192:207]
    v_mfma_f32_32x32x16_bf16 v[208:223], v[72:75], v[100:103], v[208:223]
    ds_read_b64_tr_b16 v[72:73], v62 offset:53248
    ds_read_b64_tr_b16 v[74:75], v62 offset:54272
    v_cndmask_b32 v58, v59, v58, vcc
    v_cndmask_b32 v1, v6, v1, vcc
    s_waitcnt lgkmcnt(15)
    v_mfma_f32_32x32x16_bf16 a[64:79], v[96:99], v[88:91], a[64:79]
    v_mfma_f32_32x32x16_bf16 a[80:95], v[100:103], v[88:91], a[80:95]
    ds_read_b64_tr_b16 v[88:89], v62 offset:61440
    ds_read_b64_tr_b16 v[90:91], v62 offset:62464
    s_waitcnt lgkmcnt(15)
    v_mfma_f32_32x32x16_bf16 v[224:239], v[76:79], v[96:99], v[224:239]
    v_mfma_f32_32x32x16_bf16 v[240:255], v[76:79], v[100:103], v[240:255]
    ds_read_b64_tr_b16 v[76:77], v63 offset:53248
    ds_read_b64_tr_b16 v[78:79], v63 offset:54272
    s_waitcnt lgkmcnt(15)
    v_mfma_f32_32x32x16_bf16 a[96:111], v[96:99], v[92:95], a[96:111]
    s_cmp_lg_u32 s46, 0
    s_cbranch_scc1 KA_PL1
    buffer_load_dword v57, v58, s[32:35], 0 offen sc1
KA_PL1:
    v_mfma_f32_32x32x16_bf16 a[112:127], v[100:103], v[92:95], a[112:127]
    ds_read_b64_tr_b16 v[92:93], v63 offset:61440
    ds_read_b64_tr_b16 v[94:95], v63 offset:62464
    s_waitcnt lgkmcnt(15)
    v_mfma_f32_32x32x16_bf16 v[128:143], v[64:67], v[104:107], v[128:143]
    s_waitcnt vmcnt(4)
    s_barrier
    ds_read_b128 v[96:99], v20 offset:8192
    s_waitcnt lgkmcnt(15)
    v_mfma_f32_32x32x16_bf16 v[144:159], v[64:67], v[108:111], v[144:159]
    ds_read_b64_tr_b16 v[64:65], v16 offset:0
    ds_read_b64_tr_b16 v[66:67], v16 offset:1024
    s_waitcnt lgkmcnt(15)
    v_mfma_f32_32x32x16_bf16 a[0:15], v[104:107], v[80:83], a[0:15]
    ds_read_b128 v[100:103], v20 offset:12288
    s_add_u32 m0, s57, 32768
    s_add_u32 s64, s52, 3670016
    s_and_b32 s64, s64, 0x3fffff
    s_add_u32 s64, s64, s60
    v_mfma_f32_32x32x16_bf16 a[16:31], v[108:111], v[80:83], a[16:31]
    ds_read_b64_tr_b16 v[80:81], v16 offset:8192
    ds_read_b64_tr_b16 v[82:83], v16 offset:9216
    s_waitcnt lgkmcnt(15)
    v_mfma_f32_32x32x16_bf16 v[160:175], v[68:71], v[104:107], v[160:175]
    buffer_load_dwordx4 v32, s[8:11], s64 offen lds
    v_mfma_f32_32x32x16_bf16 v[176:191], v[68:71], v[108:111], v[176:191]
    ds_read_b64_tr_b16 v[68:69], v17 offset:0
    ds_read_b64_tr_b16 v[70:71], v17 offset:1024
    s_waitcnt lgkmcnt(15)
    v_mfma_f32_32x32x16_bf16 a[32:47], v[104:107], v[84:87], a[32:47]
    buffer_load_dwordx4 v33, s[8:11], s64 offen offset:1024 lds
    v_mfma_f32_32x32x16_bf16 a[48:63], v[108:111], v[84:87], a[48:63]
    ds_read_b64_tr_b16 v[84:85], v17 offset:8192
    ds_read_b64_tr_b16 v[86:87], v17 offset:9216
    s_waitcnt lgkmcnt(15)
    v_mfma_f32_32x32x16_bf16 v[192:207], v[72:75], v[104:107], v[192:207]
    s_add_u32 m0, s57, 40960
    s_add_u32 s64, s52, 3670016
    s_and_b32 s64, s64, 0x3fffff
    s_add_u32 s64, s64, s60
    v_mfma_f32_32x32x16_bf16 v[208:223], v[72:75], v[108:111], v[208:223]
    ds_read_b64_tr_b16 v[72:73], v18 offset:0
    ds_read_b64_tr_b16 v[74:75], v18 offset:1024
    s_waitcnt lgkmcnt(15)
    v_mfma_f32_32x32x16_bf16 a[64:79], v[104:107], v[88:91], a[64:79]
    buffer_load_dwordx4 v32, s[12:15], s64 offen lds
    v_mfma_f32_32x32x16_bf16 a[80:95], v[108:111], v[88:91], a[80:95]
    ds_read_b64_tr_b16 v[88:89], v18 offset:8192
    ds_read_b64_tr_b16 v[90:91], v18 offset:9216
    s_waitcnt lgkmcnt(15)
    v_mfma_f32_32x32x16_bf16 v[224:239], v[76:79], v[104:107], v[224:239]
    buffer_load_dwordx4 v33, s[12:15], s64 offen offset:1024 lds
    v_mfma_f32_32x32x16_bf16 v[240:255], v[76:79], v[108:111], v[240:255]
    ds_read_b64_tr_b16 v[76:77], v19 offset:0
    ds_read_b64_tr_b16 v[78:79], v19 offset:1024
    s_waitcnt lgkmcnt(15)
    v_mfma_f32_32x32x16_bf16 a[96:111], v[104:107], v[92:95], a[96:111]
    v_mfma_f32_32x32x16_bf16 a[112:127], v[108:111], v[92:95], a[112:127]
    ds_read_b64_tr_b16 v[92:93], v19 offset:8192
    ds_read_b64_tr_b16 v[94:95], v19 offset:9216
    s_waitcnt lgkmcnt(15)
    v_mfma_f32_32x32x16_bf16 v[128:143], v[64:67], v[96:99], v[128:143]
    ds_read_b128 v[104:107], v21 offset:8192
    s_waitcnt lgkmcnt(15)
    v_mfma_f32_32x32x16_bf16 v[144:159], v[64:67], v[100:103], v[144:159]
    ds_read_b64_tr_b16 v[64:65], v16 offset:4096
    ds_read_b64_tr_b16 v[66:67], v16 offset:5120
    s_add_u32 m0, s58, 0
    s_add_u32 s65, s51, 768
    s_and_b32 s65, s65, 0x3ff
    s_add_u32 s65, s65, s59
    s_waitcnt lgkmcnt(15)
    v_mfma_f32_32x32x16_bf16 a[0:15], v[96:99], v[80:83], a[0:15]
    ds_read_b128 v[108:111], v21 offset:12288
    buffer_load_dwordx4 v24, s[4:7], s65 offen lds
    v_mfma_f32_32x32x16_bf16 a[16:31], v[100:103], v[80:83], a[16:31]
    ds_read_b64_tr_b16 v[80:81], v16 offset:12288
    ds_read_b64_tr_b16 v[82:83], v16 offset:13312
    buffer_load_dwordx4 v25, s[4:7], s65 offen offset:1024 lds
    s_waitcnt lgkmcnt(15)
    v_mfma_f32_32x32x16_bf16 v[160:175], v[68:71], v[96:99], v[160:175]
    buffer_load_dwordx4 v26, s[4:7], s65 offen offset:2048 lds
    v_mfma_f32_32x32x16_bf16 v[176:191], v[68:71], v[100:103], v[176:191]
    ds_read_b64_tr_b16 v[68:69], v17 offset:4096
    ds_read_b64_tr_b16 v[70:71], v17 offset:5120
    buffer_load_dwordx4 v27, s[4:7], s65 offen offset:3072 lds
    s_waitcnt lgkmcnt(15)
    v_mfma_f32_32x32x16_bf16 a[32:47], v[96:99], v[84:87], a[32:47]
    v_mfma_f32_32x32x16_bf16 a[48:63], v[100:103], v[84:87], a[48:63]
    ds_read_b64_tr_b16 v[84:85], v17 offset:12288
    ds_read_b64_tr_b16 v[86:87], v17 offset:13312
    s_add_u32 m0, s58, 4096
    s_add_u32 s65, s51, 768
    s_and_b32 s65, s65, 0x3ff
    s_add_u32 s65, s65, s59
    s_waitcnt lgkmcnt(15)
    v_mfma_f32_32x32x16_bf16 v[192:207], v[72:75], v[96:99], v[192:207]
    buffer_load_dwordx4 v28, s[4:7], s65 offen lds
    v_mfma_f32_32x32x16_bf16 v[208:223], v[72:75], v[100:103], v[208:223]
    ds_read_b64_tr_b16 v[72:73], v18 offset:4096
    ds_read_b64_tr_b16 v[74:75], v18 offset:5120
    buffer_load_dwordx4 v29, s[4:7], s65 offen offset:1024 lds
    s_waitcnt lgkmcnt(15)
    v_mfma_f32_32x32x16_bf16 a[64:79], v[96:99], v[88:91], a[64:79]
    buffer_load_dwordx4 v30, s[4:7], s65 offen offset:2048 lds
    v_mfma_f32_32x32x16_bf16 a[80:95], v[100:103], v[88:91], a[80:95]
    ds_read_b64_tr_b16 v[88:89], v18 offset:12288
    ds_read_b64_tr_b16 v[90:91], v18 offset:13312
    buffer_load_dwordx4 v31, s[4:7], s65 offen offset:3072 lds
    s_waitcnt lgkmcnt(15)
    v_mfma_f32_32x32x16_bf16 v[224:239], v[76:79], v[96:99], v[224:239]
    v_mfma_f32_32x32x16_bf16 v[240:255], v[76:79], v[100:103], v[240:255]
    ds_read_b64_tr_b16 v[76:77], v19 offset:4096
    ds_read_b64_tr_b16 v[78:79], v19 offset:5120
    s_waitcnt lgkmcnt(15)
    v_mfma_f32_32x32x16_bf16 a[96:111], v[96:99], v[92:95], a[96:111]
    v_mfma_f32_32x32x16_bf16 a[112:127], v[100:103], v[92:95], a[112:127]
    ds_read_b64_tr_b16 v[92:93], v19 offset:12288
    ds_read_b64_tr_b16 v[94:95], v19 offset:13312
    s_waitcnt lgkmcnt(15)
    v_mfma_f32_32x32x16_bf16 v[128:143], v[64:67], v[104:107], v[128:143]
    s_waitcnt vmcnt(32)
    s_cmp_lg_u32 s46, 0
    s_cbranch_scc1 KA_CK1
    s_waitcnt vmcnt(12)
    v_cmp_gt_u32 vcc, v1, v57
    s_nop 0
    s_cbranch_vccnz KA_SP1
KA_SP1_R:
    v_readlane_b32 s69, v57, 63
    s_nop 0
    s_cmp_eq_u32 s69, s63
    s_cselect_b32 s63, 1, 0
KA_CK1:
    s_barrier
    ds_read_b128 v[96:99], v22 offset:8192
    s_waitcnt lgkmcnt(15)
    v_mfma_f32_32x32x16_bf16 v[144:159], v[64:67], v[108:111], v[144:159]
    ds_read_b64_tr_b16 v[64:65], v16 offset:16384
    ds_read_b64_tr_b16 v[66:67], v16 offset:17408
    s_waitcnt lgkmcnt(15)
    v_mfma_f32_32x32x16_bf16 a[0:15], v[104:107], v[80:83], a[0:15]
    ds_read_b128 v[100:103], v22 offset:12288
    s_add_u32 m0, s57, 49152
    s_add_u32 s64, s52, 3932160
    s_and_b32 s64, s64, 0x3fffff
    s_add_u32 s64, s64, s60
    v_mfma_f32_32x32x16_bf16 a[16:31], v[108:111], v[80:83], a[16:31]
    ds_read_b64_tr_b16 v[80:81], v16 offset:24576
    ds_read_b64_tr_b16 v[82:83], v16 offset:25600
    s_waitcnt lgkmcnt(15)
    v_mfma_f32_32x32x16_bf16 v[160:175], v[68:71], v[104:107], v[160:175]
    buffer_load_dwordx4 v32, s[8:11], s64 offen lds
    v_mfma_f32_32x32x16_bf16 v[176:191], v[68:71], v[108:111], v[176:191]
    ds_read_b64_tr_b16 v[68:69], v17 offset:16384
    ds_read_b64_tr_b16 v[70:71], v17 offset:17408
    s_add_u32 s70, s55, 0
    buffer_load_dwordx4 a[128:131], v5, s[28:31], s70 offen sc1
    s_waitcnt lgkmcnt(15)
    v_mfma_f32_32x32x16_bf16 a[32:47], v[104:107], v[84:87], a[32:47]
    buffer_load_dwordx4 v33, s[8:11], s64 offen offset:1024 lds
    v_mfma_f32_32x32x16_bf16 a[48:63], v[108:111], v[84:87], a[48:63]
    ds_read_b64_tr_b16 v[84:85], v17 offset:24576
    ds_read_b64_tr_b16 v[86:87], v17 offset:25600
    s_add_u32 s71, s56, 0
    buffer_load_dwordx4 a[132:135], v5, s[28:31], s71 offen sc1
    s_waitcnt lgkmcnt(15)
    v_mfma_f32_32x32x16_bf16 v[192:207], v[72:75], v[104:107], v[192:207]
    s_add_u32 m0, s57, 57344
    s_add_u32 s64, s52, 3932160
    s_and_b32 s64, s64, 0x3fffff
    s_add_u32 s64, s64, s60
    v_mfma_f32_32x32x16_bf16 v[208:223], v[72:75], v[108:111], v[208:223]
    ds_read_b64_tr_b16 v[72:73], v18 offset:16384
    ds_read_b64_tr_b16 v[74:75], v18 offset:17408
    s_add_u32 s70, s55, 0
    buffer_load_dwordx4 a[136:139], v5, s[28:31], s70 offen offset:1024 sc1
    s_waitcnt lgkmcnt(15)
    v_mfma_f32_32x32x16_bf16 a[64:79], v[104:107], v[88:91], a[64:79]
    buffer_load_dwordx4 v32, s[12:15], s64 offen lds
    v_mfma_f32_32x32x16_bf16 a[80:95], v[108:111], v[88:91], a[80:95]
    ds_read_b64_tr_b16 v[88:89], v18 offset:24576
    ds_read_b64_tr_b16 v[90:91], v18 offset:25600
    s_add_u32 s71, s56, 0
    buffer_load_dwordx4 a[140:143], v5, s[28:31], s71 offen offset:1024 sc1
    s_waitcnt lgkmcnt(15)
    v_mfma_f32_32x32x16_bf16 v[224:239], v[76:79], v[104:107], v[224:239]
    buffer_load_dwordx4 v33, s[12:15], s64 offen offset:1024 lds
    v_mfma_f32_32x32x16_bf16 v[240:255], v[76:79], v[108:111], v[240:255]
    ds_read_b64_tr_b16 v[76:77], v19 offset:16384
    ds_read_b64_tr_b16 v[78:79], v19 offset:17408
    s_waitcnt lgkmcnt(15)
    v_mfma_f32_32x32x16_bf16 a[96:111], v[104:107], v[92:95], a[96:111]
    v_mfma_f32_32x32x16_bf16 a[112:127], v[108:111], v[92:95], a[112:127]
    ds_read_b64_tr_b16 v[92:93], v19 offset:24576
    ds_read_b64_tr_b16 v[94:95], v19 offset:25600
    s_waitcnt lgkmcnt(15)
    v_mfma_f32_32x32x16_bf16 v[128:143], v[64:67], v[96:99], v[128:143]
    ds_read_b128 v[104:107], v23 offset:8192
    s_waitcnt lgkmcnt(15)
    v_mfma_f32_32x32x16_bf16 v[144:159], v[64:67], v[100:103], v[144:159]
    ds_read_b64_tr_b16 v[64:65], v16 offset:20480
    ds_read_b64_tr_b16 v[66:67], v16 offset:21504
    s_waitcnt lgkmcnt(15)
    v_mfma_f32_32x32x16_bf16 a[0:15], v[96:99], v[80:83], a[0:15]
    ds_read_b128 v[108:111], v23 offset:12288
    v_mfma_f32_32x32x16_bf16 a[16:31], v[100:103], v[80:83], a[16:31]
    ds_read_b64_tr_b16 v[80:81], v16 offset:28672
    ds_read_b64_tr_b16 v[82:83], v16 offset:29696
    s_waitcnt lgkmcnt(15)
    v_mfma_f32_32x32x16_bf16 v[160:175], v[68:71], v[96:99], v[160:175]
    v_mfma_f32_32x32x16_bf16 v[176:191], v[68:71], v[100:103], v[176:191]
    ds_read_b64_tr_b16 v[68:69], v17 offset:20480
    ds_read_b64_tr_b16 v[70:71], v17 offset:21504
    s_add_u32 s70, s55, 0
    buffer_load_dwordx4 a[144:147], v5, s[28:31], s70 offen offset:2048 sc1
    s_waitcnt lgkmcnt(15)
    v_mfma_f32_32x32x16_bf16 a[32:47], v[96:99], v[84:87], a[32:47]
    v_mfma_f32_32x32x16_bf16 a[48:63], v[100:103], v[84:87], a[48:63]
    ds_read_b64_tr_b16 v[84:85], v17 offset:28672
    ds_read_b64_tr_b16 v[86:87], v17 offset:29696
    s_add_u32 s71, s56, 0
    buffer_load_dwordx4 a[148:151], v5, s[28:31], s71 offen offset:2048 sc1
    s_waitcnt lgkmcnt(15)
    v_mfma_f32_32x32x16_bf16 v[192:207], v[72:75], v[96:99], v[192:207]
    v_mfma_f32_32x32x16_bf16 v[208:223], v[72:75], v[100:103], v[208:223]
    ds_read_b64_tr_b16 v[72:73], v18 offset:20480
    ds_read_b64_tr_b16 v[74:75], v18 offset:21504
    s_add_u32 s70, s55, 0
    buffer_load_dwordx4 a[152:155], v5, s[28:31], s70 offen offset:3072 sc1
    s_waitcnt lgkmcnt(15)
    v_mfma_f32_32x32x16_bf16 a[64:79], v[96:99], v[88:91], a[64:79]
    v_mfma_f32_32x32x16_bf16 a[80:95], v[100:103], v[88:91], a[80:95]
    ds_read_b64_tr_b16 v[88:89], v18 offset:28672
    ds_read_b64_tr_b16 v[90:91], v18 offset:29696
    s_add_u32 s71, s56, 0
    buffer_load_dwordx4 a[156:159], v5, s[28:31], s71 offen offset:3072 sc1
    s_waitcnt lgkmcnt(15)
    v_mfma_f32_32x32x16_bf16 v[224:239], v[76:79], v[96:99], v[224:239]
    v_mfma_f32_32x32x16_bf16 v[240:255], v[76:79], v[100:103], v[240:255]
    ds_read_b64_tr_b16 v[76:77], v19 offset:20480
    ds_read_b64_tr_b16 v[78:79], v19 offset:21504
    s_waitcnt lgkmcnt(15)
    v_mfma_f32_32x32x16_bf16 a[96:111], v[96:99], v[92:95], a[96:111]
    v_mfma_f32_32x32x16_bf16 a[112:127], v[100:103], v[92:95], a[112:127]
    ds_read_b64_tr_b16 v[92:93], v19 offset:28672
    ds_read_b64_tr_b16 v[94:95], v19 offset:29696
    s_waitcnt lgkmcnt(15)
    v_mfma_f32_32x32x16_bf16 v[128:143], v[64:67], v[104:107], v[128:143]
    s_waitcnt vmcnt(12)
    s_barrier
    ds_read_b128 v[96:99], v20
    s_waitcnt lgkmcnt(15)
    v_mfma_f32_32x32x16_bf16 v[144:159], v[64:67], v[108:111], v[144:159]
    ds_read_b64_tr_b16 v[64:65], v60 offset:0
    ds_read_b64_tr_b16 v[66:67], v60 offset:1024
    s_waitcnt lgkmcnt(15)
    v_mfma_f32_32x32x16_bf16 a[0:15], v[104:107], v[80:83], a[0:15]
    ds_read_b128 v[100:103], v20 offset:4096
    s_add_u32 m0, s54, 131072
    s_add_u32 s64, s60, 0
    v_mfma_f32_32x32x16_bf16 a[16:31], v[108:111], v[80:83], a[16:31]
    ds_read_b64_tr_b16 v[80:81], v60 offset:8192
    ds_read_b64_tr_b16 v[82:83], v60 offset:9216
    s_waitcnt lgkmcnt(15)
    v_mfma_f32_32x32x16_bf16 v[160:175], v[68:71], v[104:107], v[160:175]
    buffer_load_dwordx4 v36, s[16:19], s64 offen lds
    v_mfma_f32_32x32x16_bf16 v[176:191], v[68:71], v[108:111], v[176:191]
    ds_read_b64_tr_b16 v[68:69], v61 offset:0
    ds_read_b64_tr_b16 v[70:71], v61 offset:1024
    s_add_u32 s70, s55, 4096
    buffer_load_dwordx4 a[160:163], v5, s[28:31], s70 offen sc1
    s_waitcnt lgkmcnt(15)
    v_mfma_f32_32x32x16_bf16 a[32:47], v[104:107], v[84:87], a[32:47]
    buffer_load_dwordx4 v37, s[16:19], s64 offen offset:1024 lds
    v_mfma_f32_32x32x16_bf16 a[48:63], v[108:111], v[84:87], a[48:63]
    ds_read_b64_tr_b16 v[84:85], v61 offset:8192
    ds_read_b64_tr_b16 v[86:87], v61 offset:9216
    s_add_u32 s71, s56, 4096
    buffer_load_dwordx4 a[164:167], v5, s[28:31], s71 offen sc1
    s_waitcnt lgkmcnt(15)
    v_mfma_f32_32x32x16_bf16 v[192:207], v[72:75], v[104:107], v[192:207]
    buffer_load_dwordx4 v38, s[16:19], s64 offen offset:2048 lds
    v_mfma_f32_32x32x16_bf16 v[208:223], v[72:75], v[108:111], v[208:223]
    ds_read_b64_tr_b16 v[72:73], v62 offset:0
    ds_read_b64_tr_b16 v[74:75], v62 offset:1024
    s_waitcnt lgkmcnt(15)
    v_mfma_f32_32x32x16_bf16 a[64:79], v[104:107], v[88:91], a[64:79]
    buffer_load_dwordx4 v39, s[16:19], s64 offen offset:3072 lds
    v_mfma_f32_32x32x16_bf16 a[80:95], v[108:111], v[88:91], a[80:95]
    ds_read_b64_tr_b16 v[88:89], v62 offset:8192
    ds_read_b64_tr_b16 v[90:91], v62 offset:9216
    s_waitcnt lgkmcnt(15)
    v_mfma_f32_32x32x16_bf16 v[224:239], v[76:79], v[104:107], v[224:239]
    v_mfma_f32_32x32x16_bf16 v[240:255], v[76:79], v[108:111], v[240:255]
    ds_read_b64_tr_b16 v[76:77], v63 offset:0
    ds_read_b64_tr_b16 v[78:79], v63 offset:1024
    s_waitcnt lgkmcnt(15)
    v_mfma_f32_32x32x16_bf16 a[96:111], v[104:107], v[92:95], a[96:111]
    v_mfma_f32_32x32x16_bf16 a[112:127], v[108:111], v[92:95], a[112:127]
    ds_read_b64_tr_b16 v[92:93], v63 offset:8192
    ds_read_b64_tr_b16 v[94:95], v63 offset:9216
    s_waitcnt lgkmcnt(15)
    v_mfma_f32_32x32x16_bf16 v[128:143], v[64:67], v[96:99], v[128:143]
    ds_read_b128 v[104:107], v21
    s_waitcnt lgkmcnt(15)
    v_mfma_f32_32x32x16_bf16 v[144:159], v[64:67], v[100:103], v[144:159]
    ds_read_b64_tr_b16 v[64:65], v60 offset:4096
    ds_read_b64_tr_b16 v[66:67], v60 offset:5120
    s_add_u32 m0, s58, 8192
    s_add_u32 s65, s51, 896
    s_and_b32 s65, s65, 0x3ff
    s_add_u32 s65, s65, s59
    s_waitcnt lgkmcnt(15)
    v_mfma_f32_32x32x16_bf16 a[0:15], v[96:99], v[80:83], a[0:15]
    ds_read_b128 v[108:111], v21 offset:4096
    buffer_load_dwordx4 v24, s[4:7], s65 offen lds
    v_mfma_f32_32x32x16_bf16 a[16:31], v[100:103], v[80:83], a[16:31]
    ds_read_b64_tr_b16 v[80:81], v60 offset:12288
    ds_read_b64_tr_b16 v[82:83], v60 offset:13312
    buffer_load_dwordx4 v25, s[4:7], s65 offen offset:1024 lds
    s_waitcnt lgkmcnt(15)
    v_mfma_f32_32x32x16_bf16 v[160:175], v[68:71], v[96:99], v[160:175]
    buffer_load_dwordx4 v26, s[4:7], s65 offen offset:2048 lds
    v_mfma_f32_32x32x16_bf16 v[176:191], v[68:71], v[100:103], v[176:191]
    ds_read_b64_tr_b16 v[68:69], v61 offset:4096
    ds_read_b64_tr_b16 v[70:71], v61 offset:5120
    buffer_load_dwordx4 v27, s[4:7], s65 offen offset:3072 lds
    s_add_u32 s70, s55, 4096
    buffer_load_dwordx4 a[168:171], v5, s[28:31], s70 offen offset:1024 sc1
    s_waitcnt lgkmcnt(15)
    v_mfma_f32_32x32x16_bf16 a[32:47], v[96:99], v[84:87], a[32:47]
    v_mfma_f32_32x32x16_bf16 a[48:63], v[100:103], v[84:87], a[48:63]
    ds_read_b64_tr_b16 v[84:85], v61 offset:12288
    ds_read_b64_tr_b16 v[86:87], v61 offset:13312
    s_add_u32 m0, s58, 12288
    s_add_u32 s65, s51, 896
    s_and_b32 s65, s65, 0x3ff
    s_add_u32 s65, s65, s59
    s_add_u32 s71, s56, 4096
    buffer_load_dwordx4 a[172:175], v5, s[28:31], s71 offen offset:1024 sc1
    s_waitcnt lgkmcnt(15)
    v_mfma_f32_32x32x16_bf16 v[192:207], v[72:75], v[96:99], v[192:207]
    buffer_load_dwordx4 v28, s[4:7], s65 offen lds
    v_mfma_f32_32x32x16_bf16 v[208:223], v[72:75], v[100:103], v[208:223]
    ds_read_b64_tr_b16 v[72:73], v62 offset:4096
    ds_read_b64_tr_b16 v[74:75], v62 offset:5120
    buffer_load_dwordx4 v29, s[4:7], s65 offen offset:1024 lds
    s_add_u32 s70, s55, 4096
    buffer_load_dwordx4 a[176:179], v5, s[28:31], s70 offen offset:2048 sc1
    s_waitcnt lgkmcnt(15)
    v_mfma_f32_32x32x16_bf16 a[64:79], v[96:99], v[88:91], a[64:79]
    buffer_load_dwordx4 v30, s[4:7], s65 offen offset:2048 lds
    v_mfma_f32_32x32x16_bf16 a[80:95], v[100:103], v[88:91], a[80:95]
    ds_read_b64_tr_b16 v[88:89], v62 offset:12288
    ds_read_b64_tr_b16 v[90:91], v62 offset:13312
    buffer_load_dwordx4 v31, s[4:7], s65 offen offset:3072 lds
    s_add_u32 s71, s56, 4096
    buffer_load_dwordx4 a[180:183], v5, s[28:31], s71 offen offset:2048 sc1
    s_waitcnt lgkmcnt(15)
    v_mfma_f32_32x32x16_bf16 v[224:239], v[76:79], v[96:99], v[224:239]
    v_mfma_f32_32x32x16_bf16 v[240:255], v[76:79], v[100:103], v[240:255]
    ds_read_b64_tr_b16 v[76:77], v63 offset:4096
    ds_read_b64_tr_b16 v[78:79], v63 offset:5120
    s_waitcnt lgkmcnt(15)
    v_mfma_f32_32x32x16_bf16 a[96:111], v[96:99], v[92:95], a[96:111]
    v_mfma_f32_32x32x16_bf16 a[112:127], v[100:103], v[92:95], a[112:127]
    ds_read_b64_tr_b16 v[92:93], v63 offset:12288
    ds_read_b64_tr_b16 v[94:95], v63 offset:13312
    s_waitcnt lgkmcnt(15)
    v_mfma_f32_32x32x16_bf16 v[128:143], v[64:67], v[104:107], v[128:143]
    s_waitcnt vmcnt(42)
    s_barrier
    ds_read_b128 v[96:99], v22
    s_waitcnt lgkmcnt(15)
    v_mfma_f32_32x32x16_bf16 v[144:159], v[64:67], v[108:111], v[144:159]
    ds_read_b64_tr_b16 v[64:65], v60 offset:16384
    ds_read_b64_tr_b16 v[66:67], v60 offset:17408
    s_waitcnt lgkmcnt(15)
    v_mfma_f32_32x32x16_bf16 a[0:15], v[104:107], v[80:83], a[0:15]
    ds_read_b128 v[100:103], v22 offset:4096
    s_add_u32 m0, s54, 147456
    s_add_u32 s64, s60, 524288
    v_mfma_f32_32x32x16_bf16 a[16:31], v[108:111], v[80:83], a[16:31]
    ds_read_b64_tr_b16 v[80:81], v60 offset:24576
    ds_read_b64_tr_b16 v[82:83], v60 offset:25600
    s_waitcnt lgkmcnt(15)
    v_mfma_f32_32x32x16_bf16 v[160:175], v[68:71], v[104:107], v[160:175]
    buffer_load_dwordx4 v36, s[16:19], s64 offen lds
    v_mfma_f32_32x32x16_bf16 v[176:191], v[68:71], v[108:111], v[176:191]
    ds_read_b64_tr_b16 v[68:69], v61 offset:16384
    ds_read_b64_tr_b16 v[70:71], v61 offset:17408
    s_add_u32 s70, s55, 4096
    buffer_load_dwordx4 a[184:187], v5, s[28:31], s70 offen offset:3072 sc1
    s_waitcnt lgkmcnt(15)
    v_mfma_f32_32x32x16_bf16 a[32:47], v[104:107], v[84:87], a[32:47]
    buffer_load_dwordx4 v37, s[16:19], s64 offen offset:1024 lds
    v_mfma_f32_32x32x16_bf16 a[48:63], v[108:111], v[84:87], a[48:63]
    ds_read_b64_tr_b16 v[84:85], v61 offset:24576
    ds_read_b64_tr_b16 v[86:87], v61 offset:25600
    s_add_u32 s71, s56, 4096
    buffer_load_dwordx4 a[188:191], v5, s[28:31], s71 offen offset:3072 sc1
    s_waitcnt lgkmcnt(15)
    v_mfma_f32_32x32x16_bf16 v[192:207], v[72:75], v[104:107], v[192:207]
    buffer_load_dwordx4 v38, s[16:19], s64 offen offset:2048 lds
    v_mfma_f32_32x32x16_bf16 v[208:223], v[72:75], v[108:111], v[208:223]
    ds_read_b64_tr_b16 v[72:73], v62 offset:16384
    ds_read_b64_tr_b16 v[74:75], v62 offset:17408
    s_waitcnt lgkmcnt(15)
    v_mfma_f32_32x32x16_bf16 a[64:79], v[104:107], v[88:91], a[64:79]
    buffer_load_dwordx4 v39, s[16:19], s64 offen offset:3072 lds
    v_mfma_f32_32x32x16_bf16 a[80:95], v[108:111], v[88:91], a[80:95]
    ds_read_b64_tr_b16 v[88:89], v62 offset:24576
    ds_read_b64_tr_b16 v[90:91], v62 offset:25600
    s_waitcnt lgkmcnt(15)
    v_mfma_f32_32x32x16_bf16 v[224:239], v[76:79], v[104:107], v[224:239]
    v_mfma_f32_32x32x16_bf16 v[240:255], v[76:79], v[108:111], v[240:255]
    ds_read_b64_tr_b16 v[76:77], v63 offset:16384
    ds_read_b64_tr_b16 v[78:79], v63 offset:17408
    s_waitcnt lgkmcnt(15)
    v_mfma_f32_32x32x16_bf16 a[96:111], v[104:107], v[92:95], a[96:111]
    v_mfma_f32_32x32x16_bf16 a[112:127], v[108:111], v[92:95], a[112:127]
    ds_read_b64_tr_b16 v[92:93], v63 offset:24576
    ds_read_b64_tr_b16 v[94:95], v63 offset:25600
    s_waitcnt lgkmcnt(15)
    v_mfma_f32_32x32x16_bf16 v[128:143], v[64:67], v[96:99], v[128:143]
    ds_read_b128 v[104:107], v23
    s_waitcnt lgkmcnt(15)
    v_mfma_f32_32x32x16_bf16 v[144:159], v[64:67], v[100:103], v[144:159]
    ds_read_b64_tr_b16 v[64:65], v60 offset:20480
    ds_read_b64_tr_b16 v[66:67], v60 offset:21504
    s_waitcnt lgkmcnt(15)
    v_mfma_f32_32x32x16_bf16 a[0:15], v[96:99], v[80:83], a[0:15]
    ds_read_b128 v[108:111], v23 offset:4096
    v_mfma_f32_32x32x16_bf16 a[16:31], v[100:103], v[80:83], a[16:31]
    ds_read_b64_tr_b16 v[80:81], v60 offset:28672
    ds_read_b64_tr_b16 v[82:83], v60 offset:29696
    s_waitcnt lgkmcnt(15)
    v_mfma_f32_32x32x16_bf16 v[160:175], v[68:71], v[96:99], v[160:175]
    v_mfma_f32_32x32x16_bf16 v[176:191], v[68:71], v[100:103], v[176:191]
    ds_read_b64_tr_b16 v[68:69], v61 offset:20480
    ds_read_b64_tr_b16 v[70:71], v61 offset:21504
    s_add_u32 s70, s55, 8192
    buffer_load_dwordx4 a[192:195], v5, s[28:31], s70 offen sc1
    s_waitcnt lgkmcnt(15)
    v_mfma_f32_32x32x16_bf16 a[32:47], v[96:99], v[84:87], a[32:47]
    v_mfma_f32_32x32x16_bf16 a[48:63], v[100:103], v[84:87], a[48:63]
    ds_read_b64_tr_b16 v[84:85], v61 offset:28672
    ds_read_b64_tr_b16 v[86:87], v61 offset:29696
    s_add_u32 s71, s56, 8192
    buffer_load_dwordx4 a[196:199], v5, s[28:31], s71 offen sc1
    s_waitcnt lgkmcnt(15)
    v_mfma_f32_32x32x16_bf16 v[192:207], v[72:75], v[96:99], v[192:207]
    v_mfma_f32_32x32x16_bf16 v[208:223], v[72:75], v[100:103], v[208:223]
    ds_read_b64_tr_b16 v[72:73], v62 offset:20480
    ds_read_b64_tr_b16 v[74:75], v62 offset:21504
    s_add_u32 s70, s55, 8192
    buffer_load_dwordx4 a[200:203], v5, s[28:31], s70 offen offset:1024 sc1
    s_waitcnt lgkmcnt(15)
    v_mfma_f32_32x32x16_bf16 a[64:79], v[96:99], v[88:91], a[64:79]
    v_mfma_f32_32x32x16_bf16 a[80:95], v[100:103], v[88:91], a[80:95]
    ds_read_b64_tr_b16 v[88:89], v62 offset:28672
    ds_read_b64_tr_b16 v[90:91], v62 offset:29696
    s_add_u32 s71, s56, 8192
    buffer_load_dwordx4 a[204:207], v5, s[28:31], s71 offen offset:1024 sc1
    s_waitcnt lgkmcnt(15)
    v_mfma_f32_32x32x16_bf16 v[224:239], v[76:79], v[96:99], v[224:239]
    v_mfma_f32_32x32x16_bf16 v[240:255], v[76:79], v[100:103], v[240:255]
    ds_read_b64_tr_b16 v[76:77], v63 offset:20480
    ds_read_b64_tr_b16 v[78:79], v63 offset:21504
    s_waitcnt lgkmcnt(15)
    v_mfma_f32_32x32x16_bf16 a[96:111], v[96:99], v[92:95], a[96:111]
    v_mfma_f32_32x32x16_bf16 a[112:127], v[100:103], v[92:95], a[112:127]
    ds_read_b64_tr_b16 v[92:93], v63 offset:28672
    ds_read_b64_tr_b16 v[94:95], v63 offset:29696
    s_waitcnt lgkmcnt(15)
    v_mfma_f32_32x32x16_bf16 v[128:143], v[64:67], v[104:107], v[128:143]
    s_waitcnt vmcnt(11)
    s_barrier
    ds_read_b128 v[96:99], v20 offset:8192
    s_waitcnt lgkmcnt(15)
    v_mfma_f32_32x32x16_bf16 v[144:159], v[64:67], v[108:111], v[144:159]
    ds_read_b64_tr_b16 v[64:65], v60 offset:32768
    ds_read_b64_tr_b16 v[66:67], v60 offset:33792
    s_waitcnt lgkmcnt(15)
    v_mfma_f32_32x32x16_bf16 a[0:15], v[104:107], v[80:83], a[0:15]
    ds_read_b128 v[100:103], v20 offset:12288
    s_add_u32 m0, s54, 65536
    s_add_u32 s64, s60, 1048576
    v_mfma_f32_32x32x16_bf16 a[16:31], v[108:111], v[80:83], a[16:31]
    ds_read_b64_tr_b16 v[80:81], v60 offset:40960
    ds_read_b64_tr_b16 v[82:83], v60 offset:41984
    s_waitcnt lgkmcnt(15)
    v_mfma_f32_32x32x16_bf16 v[160:175], v[68:71], v[104:107], v[160:175]
    buffer_load_dwordx4 v36, s[16:19], s64 offen lds
    v_mfma_f32_32x32x16_bf16 v[176:191], v[68:71], v[108:111], v[176:191]
    ds_read_b64_tr_b16 v[68:69], v61 offset:32768
    ds_read_b64_tr_b16 v[70:71], v61 offset:33792
    s_add_u32 s70, s55, 8192
    buffer_load_dwordx4 a[208:211], v5, s[28:31], s70 offen offset:2048 sc1
    s_waitcnt lgkmcnt(15)
    v_mfma_f32_32x32x16_bf16 a[32:47], v[104:107], v[84:87], a[32:47]
    buffer_load_dwordx4 v37, s[16:19], s64 offen offset:1024 lds
    v_mfma_f32_32x32x16_bf16 a[48:63], v[108:111], v[84:87], a[48:63]
    ds_read_b64_tr_b16 v[84:85], v61 offset:40960
    ds_read_b64_tr_b16 v[86:87], v61 offset:41984
    s_add_u32 s71, s56, 8192
    buffer_load_dwordx4 a[212:215], v5, s[28:31], s71 offen offset:2048 sc1
    s_waitcnt lgkmcnt(15)
    v_mfma_f32_32x32x16_bf16 v[192:207], v[72:75], v[104:107], v[192:207]
    buffer_load_dwordx4 v38, s[16:19], s64 offen offset:2048 lds
    v_mfma_f32_32x32x16_bf16 v[208:223], v[72:75], v[108:111], v[208:223]
    ds_read_b64_tr_b16 v[72:73], v62 offset:32768
    ds_read_b64_tr_b16 v[74:75], v62 offset:33792
    s_add_u32 s70, s55, 8192
    buffer_load_dwordx4 a[216:219], v5, s[28:31], s70 offen offset:3072 sc1
    s_waitcnt lgkmcnt(15)
    v_mfma_f32_32x32x16_bf16 a[64:79], v[104:107], v[88:91], a[64:79]
    buffer_load_dwordx4 v39, s[16:19], s64 offen offset:3072 lds
    v_mfma_f32_32x32x16_bf16 a[80:95], v[108:111], v[88:91], a[80:95]
    ds_read_b64_tr_b16 v[88:89], v62 offset:40960
    ds_read_b64_tr_b16 v[90:91], v62 offset:41984
    s_add_u32 s71, s56, 8192
    buffer_load_dwordx4 a[220:223], v5, s[28:31], s71 offen offset:3072 sc1
    s_waitcnt lgkmcnt(15)
    v_mfma_f32_32x32x16_bf16 v[224:239], v[76:79], v[104:107], v[224:239]
    v_mfma_f32_32x32x16_bf16 v[240:255], v[76:79], v[108:111], v[240:255]
    ds_read_b64_tr_b16 v[76:77], v63 offset:32768
    ds_read_b64_tr_b16 v[78:79], v63 offset:33792
    s_waitcnt lgkmcnt(15)
    v_mfma_f32_32x32x16_bf16 a[96:111], v[104:107], v[92:95], a[96:111]
    v_mfma_f32_32x32x16_bf16 a[112:127], v[108:111], v[92:95], a[112:127]
    ds_read_b64_tr_b16 v[92:93], v63 offset:40960
    ds_read_b64_tr_b16 v[94:95], v63 offset:41984
    s_waitcnt lgkmcnt(15)
    v_mfma_f32_32x32x16_bf16 v[128:143], v[64:67], v[96:99], v[128:143]
    ds_read_b128 v[104:107], v21 offset:8192
    s_waitcnt lgkmcnt(15)
    v_mfma_f32_32x32x16_bf16 v[144:159], v[64:67], v[100:103], v[144:159]
    ds_read_b64_tr_b16 v[64:65], v60 offset:36864
    ds_read_b64_tr_b16 v[66:67], v60 offset:37888
    s_waitcnt lgkmcnt(15)
    v_mfma_f32_32x32x16_bf16 a[0:15], v[96:99], v[80:83], a[0:15]
    ds_read_b128 v[108:111], v21 offset:12288
    v_mfma_f32_32x32x16_bf16 a[16:31], v[100:103], v[80:83], a[16:31]
    ds_read_b64_tr_b16 v[80:81], v60 offset:45056
    ds_read_b64_tr_b16 v[82:83], v60 offset:46080
    s_waitcnt lgkmcnt(15)
    v_mfma_f32_32x32x16_bf16 v[160:175], v[68:71], v[96:99], v[160:175]
    v_mfma_f32_32x32x16_bf16 v[176:191], v[68:71], v[100:103], v[176:191]
    ds_read_b64_tr_b16 v[68:69], v61 offset:36864
    ds_read_b64_tr_b16 v[70:71], v61 offset:37888
    s_add_u32 s70, s55, 12288
    buffer_load_dwordx4 a[224:227], v5, s[28:31], s70 offen sc1
    s_waitcnt lgkmcnt(15)
    v_mfma_f32_32x32x16_bf16 a[32:47], v[96:99], v[84:87], a[32:47]
    v_mfma_f32_32x32x16_bf16 a[48:63], v[100:103], v[84:87], a[48:63]
    ds_read_b64_tr_b16 v[84:85], v61 offset:45056
    ds_read_b64_tr_b16 v[86:87], v61 offset:46080
    s_add_u32 s71, s56, 12288
    buffer_load_dwordx4 a[228:231], v5, s[28:31], s71 offen sc1
    s_waitcnt lgkmcnt(15)
    v_mfma_f32_32x32x16_bf16 v[192:207], v[72:75], v[96:99], v[192:207]
    v_mfma_f32_32x32x16_bf16 v[208:223], v[72:75], v[100:103], v[208:223]
    ds_read_b64_tr_b16 v[72:73], v62 offset:36864
    ds_read_b64_tr_b16 v[74:75], v62 offset:37888
    s_waitcnt lgkmcnt(15)
    v_mfma_f32_32x32x16_bf16 a[64:79], v[96:99], v[88:91], a[64:79]
    v_mfma_f32_32x32x16_bf16 a[80:95], v[100:103], v[88:91], a[80:95]
    ds_read_b64_tr_b16 v[88:89], v62 offset:45056
    ds_read_b64_tr_b16 v[90:91], v62 offset:46080
    s_waitcnt lgkmcnt(15)
    v_mfma_f32_32x32x16_bf16 v[224:239], v[76:79], v[96:99], v[224:239]
    v_mfma_f32_32x32x16_bf16 v[240:255], v[76:79], v[100:103], v[240:255]
    ds_read_b64_tr_b16 v[76:77], v63 offset:36864
    ds_read_b64_tr_b16 v[78:79], v63 offset:37888
    s_waitcnt lgkmcnt(15)
    v_mfma_f32_32x32x16_bf16 a[96:111], v[96:99], v[92:95], a[96:111]
    v_mfma_f32_32x32x16_bf16 a[112:127], v[100:103], v[92:95], a[112:127]
    ds_read_b64_tr_b16 v[92:93], v63 offset:45056
    ds_read_b64_tr_b16 v[94:95], v63 offset:46080
    s_waitcnt lgkmcnt(15)
    v_mfma_f32_32x32x16_bf16 v[128:143], v[64:67], v[104:107], v[128:143]
    s_waitcnt vmcnt(42)
    s_barrier
    ds_read_b128 v[96:99], v22 offset:8192
    s_waitcnt lgkmcnt(15)
    v_mfma_f32_32x32x16_bf16 v[144:159], v[64:67], v[108:111], v[144:159]
    ds_read_b64_tr_b16 v[64:65], v60 offset:49152
    ds_read_b64_tr_b16 v[66:67], v60 offset:50176
    s_waitcnt lgkmcnt(15)
    v_mfma_f32_32x32x16_bf16 a[0:15], v[104:107], v[80:83], a[0:15]
    ds_read_b128 v[100:103], v22 offset:12288
    s_add_u32 m0, s54, 81920
    s_add_u32 s64, s60, 1572864
    v_mfma_f32_32x32x16_bf16 a[16:31], v[108:111], v[80:83], a[16:31]
    ds_read_b64_tr_b16 v[80:81], v60 offset:57344
    ds_read_b64_tr_b16 v[82:83], v60 offset:58368
    s_waitcnt lgkmcnt(15)
    v_mfma_f32_32x32x16_bf16 v[160:175], v[68:71], v[104:107], v[160:175]
    buffer_load_dwordx4 v36, s[16:19], s64 offen lds
    v_mfma_f32_32x32x16_bf16 v[176:191], v[68:71], v[108:111], v[176:191]
    ds_read_b64_tr_b16 v[68:69], v61 offset:49152
    ds_read_b64_tr_b16 v[70:71], v61 offset:50176
    s_add_u32 s70, s55, 12288
    buffer_load_dwordx4 a[232:235], v5, s[28:31], s70 offen offset:1024 sc1
    s_waitcnt lgkmcnt(15)
    v_mfma_f32_32x32x16_bf16 a[32:47], v[104:107], v[84:87], a[32:47]
    buffer_load_dwordx4 v37, s[16:19], s64 offen offset:1024 lds
    v_mfma_f32_32x32x16_bf16 a[48:63], v[108:111], v[84:87], a[48:63]
    ds_read_b64_tr_b16 v[84:85], v61 offset:57344
    ds_read_b64_tr_b16 v[86:87], v61 offset:58368
    s_add_u32 s71, s56, 12288
    buffer_load_dwordx4 a[236:239], v5, s[28:31], s71 offen offset:1024 sc1
    s_waitcnt lgkmcnt(15)
    v_mfma_f32_32x32x16_bf16 v[192:207], v[72:75], v[104:107], v[192:207]
    buffer_load_dwordx4 v38, s[16:19], s64 offen offset:2048 lds
    v_mfma_f32_32x32x16_bf16 v[208:223], v[72:75], v[108:111], v[208:223]
    ds_read_b64_tr_b16 v[72:73], v62 offset:49152
    ds_read_b64_tr_b16 v[74:75], v62 offset:50176
    s_add_u32 s70, s55, 12288
    buffer_load_dwordx4 a[240:243], v5, s[28:31], s70 offen offset:2048 sc1
    s_waitcnt lgkmcnt(15)
    v_mfma_f32_32x32x16_bf16 a[64:79], v[104:107], v[88:91], a[64:79]
    buffer_load_dwordx4 v39, s[16:19], s64 offen offset:3072 lds
    v_mfma_f32_32x32x16_bf16 a[80:95], v[108:111], v[88:91], a[80:95]
    ds_read_b64_tr_b16 v[88:89], v62 offset:57344
    ds_read_b64_tr_b16 v[90:91], v62 offset:58368
    s_add_u32 s71, s56, 12288
    buffer_load_dwordx4 a[244:247], v5, s[28:31], s71 offen offset:2048 sc1
    s_waitcnt lgkmcnt(15)
    v_mfma_f32_32x32x16_bf16 v[224:239], v[76:79], v[104:107], v[224:239]
    v_mfma_f32_32x32x16_bf16 v[240:255], v[76:79], v[108:111], v[240:255]
    ds_read_b64_tr_b16 v[76:77], v63 offset:49152
    ds_read_b64_tr_b16 v[78:79], v63 offset:50176
    s_waitcnt lgkmcnt(15)
    v_mfma_f32_32x32x16_bf16 a[96:111], v[104:107], v[92:95], a[96:111]
    v_mfma_f32_32x32x16_bf16 a[112:127], v[108:111], v[92:95], a[112:127]
    ds_read_b64_tr_b16 v[92:93], v63 offset:57344
    ds_read_b64_tr_b16 v[94:95], v63 offset:58368
    s_waitcnt lgkmcnt(15)
    v_mfma_f32_32x32x16_bf16 v[128:143], v[64:67], v[96:99], v[128:143]
    ds_read_b128 v[104:107], v23 offset:8192
    s_waitcnt lgkmcnt(15)
    v_mfma_f32_32x32x16_bf16 v[144:159], v[64:67], v[100:103], v[144:159]
    ds_read_b64_tr_b16 v[64:65], v60 offset:53248
    ds_read_b64_tr_b16 v[66:67], v60 offset:54272
    s_waitcnt lgkmcnt(15)
    v_mfma_f32_32x32x16_bf16 a[0:15], v[96:99], v[80:83], a[0:15]
    ds_read_b128 v[108:111], v23 offset:12288
    v_mfma_f32_32x32x16_bf16 a[16:31], v[100:103], v[80:83], a[16:31]
    ds_read_b64_tr_b16 v[80:81], v60 offset:61440
    ds_read_b64_tr_b16 v[82:83], v60 offset:62464
    s_waitcnt lgkmcnt(15)
    v_mfma_f32_32x32x16_bf16 v[160:175], v[68:71], v[96:99], v[160:175]
    v_mfma_f32_32x32x16_bf16 v[176:191], v[68:71], v[100:103], v[176:191]
    ds_read_b64_tr_b16 v[68:69], v61 offset:53248
    ds_read_b64_tr_b16 v[70:71], v61 offset:54272
    s_add_u32 s70, s55, 12288
    buffer_load_dwordx4 a[248:251], v5, s[28:31], s70 offen offset:3072 sc1
    s_waitcnt lgkmcnt(15)
    v_mfma_f32_32x32x16_bf16 a[32:47], v[96:99], v[84:87], a[32:47]
    v_mfma_f32_32x32x16_bf16 a[48:63], v[100:103], v[84:87], a[48:63]
    ds_read_b64_tr_b16 v[84:85], v61 offset:61440
    ds_read_b64_tr_b16 v[86:87], v61 offset:62464
    s_add_u32 s71, s56, 12288
    buffer_load_dwordx4 a[252:255], v5, s[28:31], s71 offen offset:3072 sc1
    s_waitcnt lgkmcnt(15)
    v_mfma_f32_32x32x16_bf16 v[192:207], v[72:75], v[96:99], v[192:207]
    v_mfma_f32_32x32x16_bf16 v[208:223], v[72:75], v[100:103], v[208:223]
    ds_read_b64_tr_b16 v[72:73], v62 offset:53248
    ds_read_b64_tr_b16 v[74:75], v62 offset:54272
    s_waitcnt lgkmcnt(15)
    v_mfma_f32_32x32x16_bf16 a[64:79], v[96:99], v[88:91], a[64:79]
    v_mfma_f32_32x32x16_bf16 a[80:95], v[100:103], v[88:91], a[80:95]
    ds_read_b64_tr_b16 v[88:89], v62 offset:61440
    ds_read_b64_tr_b16 v[90:91], v62 offset:62464
    s_waitcnt lgkmcnt(15)
    v_mfma_f32_32x32x16_bf16 v[224:239], v[76:79], v[96:99], v[224:239]
    v_mfma_f32_32x32x16_bf16 v[240:255], v[76:79], v[100:103], v[240:255]
    ds_read_b64_tr_b16 v[76:77], v63 offset:53248
    ds_read_b64_tr_b16 v[78:79], v63 offset:54272
    s_waitcnt lgkmcnt(15)
    v_mfma_f32_32x32x16_bf16 a[96:111], v[96:99], v[92:95], a[96:111]
    v_mfma_f32_32x32x16_bf16 a[112:127], v[100:103], v[92:95], a[112:127]
    ds_read_b64_tr_b16 v[92:93], v63 offset:61440
    ds_read_b64_tr_b16 v[94:95], v63 offset:62464
    s_waitcnt lgkmcnt(15)
    v_mfma_f32_32x32x16_bf16 v[128:143], v[64:67], v[104:107], v[128:143]
    s_waitcnt lgkmcnt(14)
    v_mfma_f32_32x32x16_bf16 v[144:159], v[64:67], v[108:111], v[144:159]
    s_waitcnt lgkmcnt(10)
    v_mfma_f32_32x32x16_bf16 v[160:175], v[68:71], v[104:107], v[160:175]
    v_mfma_f32_32x32x16_bf16 v[176:191], v[68:71], v[108:111], v[176:191]
    s_waitcnt lgkmcnt(6)
    v_mfma_f32_32x32x16_bf16 v[192:207], v[72:75], v[104:107], v[192:207]
    v_mfma_f32_32x32x16_bf16 v[208:223], v[72:75], v[108:111], v[208:223]
    s_waitcnt lgkmcnt(2)
    v_mfma_f32_32x32x16_bf16 v[224:239], v[76:79], v[104:107], v[224:239]
    v_mfma_f32_32x32x16_bf16 v[240:255], v[76:79], v[108:111], v[240:255]
    v_mfma_f32_32x32x16_bf16 a[0:15], v[104:107], v[80:83], a[0:15]
    v_cvt_pk_bf16_f32 v128, v128, v129
    v_cvt_pk_bf16_f32 v129, v130, v131
    v_cvt_pk_bf16_f32 v130, v132, v133
    v_cvt_pk_bf16_f32 v131, v134, v135
    v_cvt_pk_bf16_f32 v132, v136, v137
    v_mfma_f32_32x32x16_bf16 a[16:31], v[108:111], v[80:83], a[16:31]
    v_cvt_pk_bf16_f32 v133, v138, v139
    v_cvt_pk_bf16_f32 v134, v140, v141
    v_cvt_pk_bf16_f32 v135, v142, v143
    v_cvt_pk_bf16_f32 v136, v144, v145
    v_cvt_pk_bf16_f32 v137, v146, v147
    v_mfma_f32_32x32x16_bf16 a[32:47], v[104:107], v[84:87], a[32:47]
    v_cvt_pk_bf16_f32 v138, v148, v149
    v_cvt_pk_bf16_f32 v139, v150, v151
    v_cvt_pk_bf16_f32 v140, v152, v153
    v_cvt_pk_bf16_f32 v141, v154, v155
    v_cvt_pk_bf16_f32 v142, v156, v157
    v_mfma_f32_32x32x16_bf16 a[48:63], v[108:111], v[84:87], a[48:63]
    v_cvt_pk_bf16_f32 v143, v158, v159
    v_cvt_pk_bf16_f32 v144, v160, v161
    v_cvt_pk_bf16_f32 v145, v162, v163
    v_cvt_pk_bf16_f32 v146, v164, v165
    v_cvt_pk_bf16_f32 v147, v166, v167
    v_mfma_f32_32x32x16_bf16 a[64:79], v[104:107], v[88:91], a[64:79]
    v_cvt_pk_bf16_f32 v148, v168, v169
    v_cvt_pk_bf16_f32 v149, v170, v171
    v_cvt_pk_bf16_f32 v150, v172, v173
    v_cvt_pk_bf16_f32 v151, v174, v175
    v_cvt_pk_bf16_f32 v152, v176, v177
    v_mfma_f32_32x32x16_bf16 a[80:95], v[108:111], v[88:91], a[80:95]
    v_cvt_pk_bf16_f32 v153, v178, v179
    v_cvt_pk_bf16_f32 v154, v180, v181
    v_cvt_pk_bf16_f32 v155, v182, v183
    v_cvt_pk_bf16_f32 v156, v184, v185
    v_cvt_pk_bf16_f32 v157, v186, v187
    s_waitcnt lgkmcnt(0)
    v_mfma_f32_32x32x16_bf16 a[96:111], v[104:107], v[92:95], a[96:111]
    v_cvt_pk_bf16_f32 v158, v188, v189
    v_cvt_pk_bf16_f32 v159, v190, v191
    v_cvt_pk_bf16_f32 v160, v192, v193
    v_cvt_pk_bf16_f32 v161, v194, v195
    v_cvt_pk_bf16_f32 v162, v196, v197
    v_mfma_f32_32x32x16_bf16 a[112:127], v[108:111], v[92:95], a[112:127]
    v_cvt_pk_bf16_f32 v163, v198, v199
    v_cvt_pk_bf16_f32 v164, v200, v201
    v_cvt_pk_bf16_f32 v165, v202, v203
    v_cvt_pk_bf16_f32 v166, v204, v205
    v_cvt_pk_bf16_f32 v167, v206, v207
    s_waitcnt vmcnt(42)
    s_barrier
    ds_read_b64_tr_b16 v[40:41], v16 offset:0
    ds_read_b64_tr_b16 v[42:43], v16 offset:1024
    ds_read_b64_tr_b16 v[44:45], v17 offset:0
    ds_read_b64_tr_b16 v[46:47], v17 offset:1024
    ds_read_b64_tr_b16 v[48:49], v18 offset:0
    ds_read_b64_tr_b16 v[50:51], v18 offset:1024
    ds_read_b64_tr_b16 v[52:53], v19 offset:0
    ds_read_b64_tr_b16 v[54:55], v19 offset:1024
    v_cvt_pk_bf16_f32 v168, v208, v209
    v_cvt_pk_bf16_f32 v169, v210, v211
    s_add_u32 m0, s54, 0
    s_add_u32 s64, s60, 2097152
    v_cvt_pk_bf16_f32 v170, v212, v213
    v_cvt_pk_bf16_f32 v171, v214, v215
    buffer_load_dwordx4 v36, s[16:19], s64 offen lds
    buffer_load_dwordx4 v37, s[16:19], s64 offen offset:1024 lds
    v_cvt_pk_bf16_f32 v172, v216, v217
    v_cvt_pk_bf16_f32 v173, v218, v219
    buffer_load_dwordx4 v38, s[16:19], s64 offen offset:2048 lds
    buffer_load_dwordx4 v39, s[16:19], s64 offen offset:3072 lds
    v_cvt_pk_bf16_f32 v174, v220, v221
    v_cvt_pk_bf16_f32 v175, v222, v223
    s_add_u32 m0, s54, 16384
    s_add_u32 s64, s60, 2621440
    v_cvt_pk_bf16_f32 v176, v224, v225
    v_cvt_pk_bf16_f32 v177, v226, v227
    buffer_load_dwordx4 v36, s[16:19], s64 offen lds
    buffer_load_dwordx4 v37, s[16:19], s64 offen offset:1024 lds
    v_cvt_pk_bf16_f32 v178, v228, v229
    v_cvt_pk_bf16_f32 v179, v230, v231
    buffer_load_dwordx4 v38, s[16:19], s64 offen offset:2048 lds
    buffer_load_dwordx4 v39, s[16:19], s64 offen offset:3072 lds
    v_cvt_pk_bf16_f32 v180, v232, v233
    v_cvt_pk_bf16_f32 v181, v234, v235
    s_add_u32 m0, s54, 98304
    s_add_u32 s64, s60, 3145728
    v_cvt_pk_bf16_f32 v182, v236, v237
    v_cvt_pk_bf16_f32 v183, v238, v239
    buffer_load_dwordx4 v36, s[16:19], s64 offen lds
    buffer_load_dwordx4 v37, s[16:19], s64 offen offset:1024 lds
    v_cvt_pk_bf16_f32 v184, v240, v241
    v_cvt_pk_bf16_f32 v185, v242, v243
    buffer_load_dwordx4 v38, s[16:19], s64 offen offset:2048 lds
    buffer_load_dwordx4 v39, s[16:19], s64 offen offset:3072 lds
    v_cvt_pk_bf16_f32 v186, v244, v245
    v_cvt_pk_bf16_f32 v187, v246, v247
    s_add_u32 m0, s54, 114688
    s_add_u32 s64, s60, 3670016
    v_cvt_pk_bf16_f32 v188, v248, v249
    v_cvt_pk_bf16_f32 v189, v250, v251
    buffer_load_dwordx4 v36, s[16:19], s64 offen lds
    buffer_load_dwordx4 v37, s[16:19], s64 offen offset:1024 lds
    v_cvt_pk_bf16_f32 v190, v252, v253
    v_cvt_pk_bf16_f32 v191, v254, v255
    buffer_load_dwordx4 v38, s[16:19], s64 offen offset:2048 lds
    buffer_load_dwordx4 v39, s[16:19], s64 offen offset:3072 lds
    s_waitcnt lgkmcnt(6)
    v_mfma_f32_32x32x16_bf16 v[64:79], v[40:43], a[128:131], 0
    s_add_u32 s68, s61, 0
    v_mfma_f32_32x32x16_bf16 v[80:95], v[40:43], a[132:135], 0
    ds_read_b64_tr_b16 v[40:41], v16 offset:4096
    ds_read_b64_tr_b16 v[42:43], v16 offset:5120
    s_waitcnt lgkmcnt(6)
    v_mfma_f32_32x32x16_bf16 v[96:111], v[44:47], a[128:131], 0
    buffer_store_dwordx4 v[128:131], v5, s[20:23], s68 offen
    s_lshl_b32 s69, s44, 7
    v_mov_b32 v58, s69
    v_mfma_f32_32x32x16_bf16 v[112:127], v[44:47], a[132:135], 0
    ds_read_b64_tr_b16 v[44:45], v17 offset:4096
    ds_read_b64_tr_b16 v[46:47], v17 offset:5120
    s_waitcnt lgkmcnt(6)
    v_mfma_f32_32x32x16_bf16 v[192:207], v[48:51], a[128:131], 0
    s_add_u32 s68, s61, 0
    v_mfma_f32_32x32x16_bf16 v[208:223], v[48:51], a[132:135], 0
    ds_read_b64_tr_b16 v[48:49], v18 offset:4096
    ds_read_b64_tr_b16 v[50:51], v18 offset:5120
    s_waitcnt lgkmcnt(6)
    v_mfma_f32_32x32x16_bf16 v[224:239], v[52:55], a[128:131], 0
    buffer_store_dwordx4 v[132:135], v5, s[20:23], s68 offen offset:1024
    v_mfma_f32_32x32x16_bf16 v[240:255], v[52:55], a[132:135], 0
    ds_read_b64_tr_b16 v[52:53], v19 offset:4096
    ds_read_b64_tr_b16 v[54:55], v19 offset:5120
    s_waitcnt lgkmcnt(6)
    v_mfma_f32_32x32x16_bf16 v[64:79], v[40:43], a[136:139], v[64:79]
    s_add_u32 s68, s61, 16384
    v_mfma_f32_32x32x16_bf16 v[80:95], v[40:43], a[140:143], v[80:95]
    ds_read_b64_tr_b16 v[40:41], v16 offset:8192
    ds_read_b64_tr_b16 v[42:43], v16 offset:9216
    s_waitcnt lgkmcnt(6)
    v_mfma_f32_32x32x16_bf16 v[96:111], v[44:47], a[136:139], v[96:111]
    buffer_store_dwordx4 v[136:139], v5, s[20:23], s68 offen
    v_mfma_f32_32x32x16_bf16 v[112:127], v[44:47], a[140:143], v[112:127]
    ds_read_b64_tr_b16 v[44:45], v17 offset:8192
    ds_read_b64_tr_b16 v[46:47], v17 offset:9216
    s_waitcnt lgkmcnt(6)
    v_mfma_f32_32x32x16_bf16 v[192:207], v[48:51], a[136:139], v[192:207]
    s_add_u32 s70, s55, 16384
    buffer_load_dwordx4 a[128:131], v5, s[28:31], s70 offen sc1
    v_mfma_f32_32x32x16_bf16 v[208:223], v[48:51], a[140:143], v[208:223]
    ds_read_b64_tr_b16 v[48:49], v18 offset:8192
    ds_read_b64_tr_b16 v[50:51], v18 offset:9216
    s_waitcnt lgkmcnt(6)
    v_mfma_f32_32x32x16_bf16 v[224:239], v[52:55], a[136:139], v[224:239]
    s_add_u32 s71, s56, 16384
    buffer_load_dwordx4 a[132:135], v5, s[28:31], s71 offen sc1
    v_mfma_f32_32x32x16_bf16 v[240:255], v[52:55], a[140:143], v[240:255]
    ds_read_b64_tr_b16 v[52:53], v19 offset:8192
    ds_read_b64_tr_b16 v[54:55], v19 offset:9216
    s_waitcnt lgkmcnt(6)
    v_mfma_f32_32x32x16_bf16 v[64:79], v[40:43], a[144:147], v[64:79]
    s_add_u32 s68, s61, 16384
    v_mfma_f32_32x32x16_bf16 v[80:95], v[40:43], a[148:151], v[80:95]
    ds_read_b64_tr_b16 v[40:41], v16 offset:12288
    ds_read_b64_tr_b16 v[42:43], v16 offset:13312
    s_waitcnt lgkmcnt(6)
    v_mfma_f32_32x32x16_bf16 v[96:111], v[44:47], a[144:147], v[96:111]
    buffer_store_dwordx4 v[140:143], v5, s[20:23], s68 offen offset:1024
    v_mfma_f32_32x32x16_bf16 v[112:127], v[44:47], a[148:151], v[112:127]
    ds_read_b64_tr_b16 v[44:45], v17 offset:12288
    ds_read_b64_tr_b16 v[46:47], v17 offset:13312
    s_waitcnt lgkmcnt(6)
    v_mfma_f32_32x32x16_bf16 v[192:207], v[48:51], a[144:147], v[192:207]
    s_add_u32 s70, s55, 16384
    buffer_load_dwordx4 a[136:139], v5, s[28:31], s70 offen offset:1024 sc1
    v_mfma_f32_32x32x16_bf16 v[208:223], v[48:51], a[148:151], v[208:223]
    ds_read_b64_tr_b16 v[48:49], v18 offset:12288
    ds_read_b64_tr_b16 v[50:51], v18 offset:13312
    s_waitcnt lgkmcnt(6)
    v_mfma_f32_32x32x16_bf16 v[224:239], v[52:55], a[144:147], v[224:239]
    s_add_u32 s71, s56, 16384
    buffer_load_dwordx4 a[140:143], v5, s[28:31], s71 offen offset:1024 sc1
    v_mfma_f32_32x32x16_bf16 v[240:255], v[52:55], a[148:151], v[240:255]
    ds_read_b64_tr_b16 v[52:53], v19 offset:12288
    ds_read_b64_tr_b16 v[54:55], v19 offset:13312
    s_waitcnt lgkmcnt(6)
    v_mfma_f32_32x32x16_bf16 v[64:79], v[40:43], a[152:155], v[64:79]
    s_waitcnt vmcnt(48)
    s_barrier
    v_mfma_f32_32x32x16_bf16 v[80:95], v[40:43], a[156:159], v[80:95]
    ds_read_b64_tr_b16 v[40:41], v16 offset:16384
    ds_read_b64_tr_b16 v[42:43], v16 offset:17408
    s_waitcnt lgkmcnt(6)
    v_mfma_f32_32x32x16_bf16 v[96:111], v[44:47], a[152:155], v[96:111]
    s_add_u32 s68, s61, 0
    buffer_store_dwordx4 v[144:147], v5, s[20:23], s68 offen offset:2048
    v_mfma_f32_32x32x16_bf16 v[112:127], v[44:47], a[156:159], v[112:127]
    ds_read_b64_tr_b16 v[44:45], v17 offset:16384
    ds_read_b64_tr_b16 v[46:47], v17 offset:17408
    s_waitcnt lgkmcnt(6)
    v_mfma_f32_32x32x16_bf16 v[192:207], v[48:51], a[152:155], v[192:207]
    s_add_u32 s70, s55, 16384
    buffer_load_dwordx4 a[144:147], v5, s[28:31], s70 offen offset:2048 sc1
    v_mfma_f32_32x32x16_bf16 v[208:223], v[48:51], a[156:159], v[208:223]
    ds_read_b64_tr_b16 v[48:49], v18 offset:16384
    ds_read_b64_tr_b16 v[50:51], v18 offset:17408
    s_waitcnt lgkmcnt(6)
    v_mfma_f32_32x32x16_bf16 v[224:239], v[52:55], a[152:155], v[224:239]
    s_add_u32 s71, s56, 16384
    buffer_load_dwordx4 a[148:151], v5, s[28:31], s71 offen offset:2048 sc1
    v_mfma_f32_32x32x16_bf16 v[240:255], v[52:55], a[156:159], v[240:255]
    ds_read_b64_tr_b16 v[52:53], v19 offset:16384
    ds_read_b64_tr_b16 v[54:55], v19 offset:17408
    s_waitcnt lgkmcnt(6)
    v_mfma_f32_32x32x16_bf16 v[64:79], v[40:43], a[160:163], v[64:79]
    s_add_u32 s68, s61, 0
    buffer_store_dwordx4 v[148:151], v5, s[20:23], s68 offen offset:3072
    v_mfma_f32_32x32x16_bf16 v[80:95], v[40:43], a[164:167], v[80:95]
    ds_read_b64_tr_b16 v[40:41], v16 offset:20480
    ds_read_b64_tr_b16 v[42:43], v16 offset:21504
    s_waitcnt lgkmcnt(6)
    v_mfma_f32_32x32x16_bf16 v[96:111], v[44:47], a[160:163], v[96:111]
    s_add_u32 s68, s61, 16384
    buffer_store_dwordx4 v[152:155], v5, s[20:23], s68 offen offset:2048
    v_mfma_f32_32x32x16_bf16 v[112:127], v[44:47], a[164:167], v[112:127]
    ds_read_b64_tr_b16 v[44:45], v17 offset:20480
    ds_read_b64_tr_b16 v[46:47], v17 offset:21504
    s_waitcnt lgkmcnt(6)
    v_mfma_f32_32x32x16_bf16 v[192:207], v[48:51], a[160:163], v[192:207]
    s_add_u32 s70, s55, 16384
    buffer_load_dwordx4 a[152:155], v5, s[28:31], s70 offen offset:3072 sc1
    v_mfma_f32_32x32x16_bf16 v[208:223], v[48:51], a[164:167], v[208:223]
    ds_read_b64_tr_b16 v[48:49], v18 offset:20480
    ds_read_b64_tr_b16 v[50:51], v18 offset:21504
    s_waitcnt lgkmcnt(6)
    v_mfma_f32_32x32x16_bf16 v[224:239], v[52:55], a[160:163], v[224:239]
    s_add_u32 s71, s56, 16384
    buffer_load_dwordx4 a[156:159], v5, s[28:31], s71 offen offset:3072 sc1
    v_mfma_f32_32x32x16_bf16 v[240:255], v[52:55], a[164:167], v[240:255]
    ds_read_b64_tr_b16 v[52:53], v19 offset:20480
    ds_read_b64_tr_b16 v[54:55], v19 offset:21504
    s_waitcnt lgkmcnt(6)
    v_mfma_f32_32x32x16_bf16 v[64:79], v[40:43], a[168:171], v[64:79]
    s_add_u32 s68, s61, 16384
    buffer_store_dwordx4 v[156:159], v5, s[20:23], s68 offen offset:3072
    v_mfma_f32_32x32x16_bf16 v[80:95], v[40:43], a[172:175], v[80:95]
    ds_read_b64_tr_b16 v[40:41], v16 offset:24576
    ds_read_b64_tr_b16 v[42:43], v16 offset:25600
    s_waitcnt lgkmcnt(6)
    v_mfma_f32_32x32x16_bf16 v[96:111], v[44:47], a[168:171], v[96:111]
    s_add_u32 s68, s61, 4096
    buffer_store_dwordx4 v[160:163], v5, s[20:23], s68 offen
    v_mfma_f32_32x32x16_bf16 v[112:127], v[44:47], a[172:175], v[112:127]
    ds_read_b64_tr_b16 v[44:45], v17 offset:24576
    ds_read_b64_tr_b16 v[46:47], v17 offset:25600
    s_waitcnt lgkmcnt(6)
    v_mfma_f32_32x32x16_bf16 v[192:207], v[48:51], a[168:171], v[192:207]
    s_add_u32 s70, s55, 20480
    buffer_load_dwordx4 a[160:163], v5, s[28:31], s70 offen sc1
    v_mfma_f32_32x32x16_bf16 v[208:223], v[48:51], a[172:175], v[208:223]
    ds_read_b64_tr_b16 v[48:49], v18 offset:24576
    ds_read_b64_tr_b16 v[50:51], v18 offset:25600
    s_waitcnt lgkmcnt(6)
    v_mfma_f32_32x32x16_bf16 v[224:239], v[52:55], a[168:171], v[224:239]
    s_add_u32 s71, s56, 20480
    buffer_load_dwordx4 a[164:167], v5, s[28:31], s71 offen sc1
    v_mfma_f32_32x32x16_bf16 v[240:255], v[52:55], a[172:175], v[240:255]
    ds_read_b64_tr_b16 v[52:53], v19 offset:24576
    ds_read_b64_tr_b16 v[54:55], v19 offset:25600
    s_waitcnt lgkmcnt(6)
    v_mfma_f32_32x32x16_bf16 v[64:79], v[40:43], a[176:179], v[64:79]
    s_add_u32 s68, s61, 4096
    buffer_store_dwordx4 v[164:167], v5, s[20:23], s68 offen offset:1024
    v_mfma_f32_32x32x16_bf16 v[80:95], v[40:43], a[180:183], v[80:95]
    ds_read_b64_tr_b16 v[40:41], v16 offset:28672
    ds_read_b64_tr_b16 v[42:43], v16 offset:29696
    s_waitcnt lgkmcnt(6)
    v_mfma_f32_32x32x16_bf16 v[96:111], v[44:47], a[176:179], v[96:111]
    s_add_u32 s68, s61, 20480
    buffer_store_dwordx4 v[168:171], v5, s[20:23], s68 offen
    v_mfma_f32_32x32x16_bf16 v[112:127], v[44:47], a[180:183], v[112:127]
    ds_read_b64_tr_b16 v[44:45], v17 offset:28672
    ds_read_b64_tr_b16 v[46:47], v17 offset:29696
    s_waitcnt lgkmcnt(6)
    v_mfma_f32_32x32x16_bf16 v[192:207], v[48:51], a[176:179], v[192:207]
    s_add_u32 s70, s55, 20480
    buffer_load_dwordx4 a[168:171], v5, s[28:31], s70 offen offset:1024 sc1
    v_mfma_f32_32x32x16_bf16 v[208:223], v[48:51], a[180:183], v[208:223]
    ds_read_b64_tr_b16 v[48:49], v18 offset:28672
    ds_read_b64_tr_b16 v[50:51], v18 offset:29696
    s_waitcnt lgkmcnt(6)
    v_mfma_f32_32x32x16_bf16 v[224:239], v[52:55], a[176:179], v[224:239]
    s_add_u32 s71, s56, 20480
    buffer_load_dwordx4 a[172:175], v5, s[28:31], s71 offen offset:1024 sc1
    v_mfma_f32_32x32x16_bf16 v[240:255], v[52:55], a[180:183], v[240:255]
    ds_read_b64_tr_b16 v[52:53], v19 offset:28672
    ds_read_b64_tr_b16 v[54:55], v19 offset:29696
    s_waitcnt lgkmcnt(6)
    v_mfma_f32_32x32x16_bf16 v[64:79], v[40:43], a[184:187], v[64:79]
    s_waitcnt vmcnt(52)
    s_barrier
    v_mfma_f32_32x32x16_bf16 v[80:95], v[40:43], a[188:191], v[80:95]
    ds_read_b64_tr_b16 v[40:41], v60 offset:0
    ds_read_b64_tr_b16 v[42:43], v60 offset:1024
    s_waitcnt lgkmcnt(6)
    v_mfma_f32_32x32x16_bf16 v[96:111], v[44:47], a[184:187], v[96:111]
    s_add_u32 s68, s61, 20480
    buffer_store_dwordx4 v[172:175], v5, s[20:23], s68 offen offset:1024
    v_mfma_f32_32x32x16_bf16 v[112:127], v[44:47], a[188:191], v[112:127]
    ds_read_b64_tr_b16 v[44:45], v61 offset:0
    ds_read_b64_tr_b16 v[46:47], v61 offset:1024
    s_waitcnt lgkmcnt(6)
    v_mfma_f32_32x32x16_bf16 v[192:207], v[48:51], a[184:187], v[192:207]
    s_add_u32 s70, s55, 20480
    buffer_load_dwordx4 a[176:179], v5, s[28:31], s70 offen offset:2048 sc1
    v_mfma_f32_32x32x16_bf16 v[208:223], v[48:51], a[188:191], v[208:223]
    ds_read_b64_tr_b16 v[48:49], v62 offset:0
    ds_read_b64_tr_b16 v[50:51], v62 offset:1024
    s_waitcnt lgkmcnt(6)
    v_mfma_f32_32x32x16_bf16 v[224:239], v[52:55], a[184:187], v[224:239]
    s_add_u32 s71, s56, 20480
    buffer_load_dwordx4 a[180:183], v5, s[28:31], s71 offen offset:2048 sc1
    v_mfma_f32_32x32x16_bf16 v[240:255], v[52:55], a[188:191], v[240:255]
    ds_read_b64_tr_b16 v[52:53], v63 offset:0
    ds_read_b64_tr_b16 v[54:55], v63 offset:1024
    s_waitcnt lgkmcnt(6)
    v_mfma_f32_32x32x16_bf16 v[64:79], v[40:43], a[192:195], v[64:79]
    s_add_u32 s68, s61, 4096
    buffer_store_dwordx4 v[176:179], v5, s[20:23], s68 offen offset:2048
    v_mfma_f32_32x32x16_bf16 v[80:95], v[40:43], a[196:199], v[80:95]
    ds_read_b64_tr_b16 v[40:41], v60 offset:4096
    ds_read_b64_tr_b16 v[42:43], v60 offset:5120
    s_waitcnt lgkmcnt(6)
    v_mfma_f32_32x32x16_bf16 v[96:111], v[44:47], a[192:195], v[96:111]
    s_add_u32 s68, s61, 4096
    buffer_store_dwordx4 v[180:183], v5, s[20:23], s68 offen offset:3072
    v_mfma_f32_32x32x16_bf16 v[112:127], v[44:47], a[196:199], v[112:127]
    ds_read_b64_tr_b16 v[44:45], v61 offset:4096
    ds_read_b64_tr_b16 v[46:47], v61 offset:5120
    s_waitcnt lgkmcnt(6)
    v_mfma_f32_32x32x16_bf16 v[192:207], v[48:51], a[192:195], v[192:207]
    s_add_u32 s70, s55, 20480
    buffer_load_dwordx4 a[184:187], v5, s[28:31], s70 offen offset:3072 sc1
    v_mfma_f32_32x32x16_bf16 v[208:223], v[48:51], a[196:199], v[208:223]
    ds_read_b64_tr_b16 v[48:49], v62 offset:4096
    ds_read_b64_tr_b16 v[50:51], v62 offset:5120
    s_waitcnt lgkmcnt(6)
    v_mfma_f32_32x32x16_bf16 v[224:239], v[52:55], a[192:195], v[224:239]
    s_add_u32 s71, s56, 20480
    buffer_load_dwordx4 a[188:191], v5, s[28:31], s71 offen offset:3072 sc1
    v_mfma_f32_32x32x16_bf16 v[240:255], v[52:55], a[196:199], v[240:255]
    ds_read_b64_tr_b16 v[52:53], v63 offset:4096
    ds_read_b64_tr_b16 v[54:55], v63 offset:5120
    s_waitcnt lgkmcnt(6)
    v_mfma_f32_32x32x16_bf16 v[64:79], v[40:43], a[200:203], v[64:79]
    s_add_u32 s68, s61, 20480
    buffer_store_dwordx4 v[184:187], v5, s[20:23], s68 offen offset:2048
    v_mfma_f32_32x32x16_bf16 v[80:95], v[40:43], a[204:207], v[80:95]
    ds_read_b64_tr_b16 v[40:41], v60 offset:8192
    ds_read_b64_tr_b16 v[42:43], v60 offset:9216
    s_waitcnt lgkmcnt(6)
    v_mfma_f32_32x32x16_bf16 v[96:111], v[44:47], a[200:203], v[96:111]
    s_add_u32 s68, s61, 20480
    buffer_store_dwordx4 v[188:191], v5, s[20:23], s68 offen offset:3072
    v_mfma_f32_32x32x16_bf16 v[112:127], v[44:47], a[204:207], v[112:127]
    ds_read_b64_tr_b16 v[44:45], v61 offset:8192
    ds_read_b64_tr_b16 v[46:47], v61 offset:9216
    s_waitcnt lgkmcnt(6)
    v_mfma_f32_32x32x16_bf16 v[192:207], v[48:51], a[200:203], v[192:207]
    s_add_u32 s70, s55, 24576
    buffer_load_dwordx4 a[192:195], v5, s[28:31], s70 offen sc1
    v_mfma_f32_32x32x16_bf16 v[208:223], v[48:51], a[204:207], v[208:223]
    ds_read_b64_tr_b16 v[48:49], v62 offset:8192
    ds_read_b64_tr_b16 v[50:51], v62 offset:9216
    s_waitcnt lgkmcnt(6)
    v_mfma_f32_32x32x16_bf16 v[224:239], v[52:55], a[200:203], v[224:239]
    s_add_u32 s71, s56, 24576
    buffer_load_dwordx4 a[196:199], v5, s[28:31], s71 offen sc1
    v_mfma_f32_32x32x16_bf16 v[240:255], v[52:55], a[204:207], v[240:255]
    ds_read_b64_tr_b16 v[52:53], v63 offset:8192
    ds_read_b64_tr_b16 v[54:55], v63 offset:9216
    s_waitcnt lgkmcnt(6)
    v_mfma_f32_32x32x16_bf16 v[64:79], v[40:43], a[208:211], v[64:79]
    v_accvgpr_read_b32 v128, a0
    v_accvgpr_read_b32 v129, a1
    v_accvgpr_read_b32 v130, a2
    v_mfma_f32_32x32x16_bf16 v[80:95], v[40:43], a[212:215], v[80:95]
    ds_read_b64_tr_b16 v[40:41], v60 offset:12288
    ds_read_b64_tr_b16 v[42:43], v60 offset:13312
    v_accvgpr_read_b32 v131, a3
    s_waitcnt lgkmcnt(6)
    v_mfma_f32_32x32x16_bf16 v[96:111], v[44:47], a[208:211], v[96:111]
    v_accvgpr_read_b32 v132, a4
    v_accvgpr_read_b32 v133, a5
    v_accvgpr_read_b32 v134, a6
    v_mfma_f32_32x32x16_bf16 v[112:127], v[44:47], a[212:215], v[112:127]
    ds_read_b64_tr_b16 v[44:45], v61 offset:12288
    ds_read_b64_tr_b16 v[46:47], v61 offset:13312
    v_accvgpr_read_b32 v135, a7
    s_waitcnt lgkmcnt(6)
    v_mfma_f32_32x32x16_bf16 v[192:207], v[48:51], a[208:211], v[192:207]
    s_add_u32 s70, s55, 24576
    buffer_load_dwordx4 a[200:203], v5, s[28:31], s70 offen offset:1024 sc1
    v_cvt_pk_bf16_f32 v160, v128, v129
    v_mfma_f32_32x32x16_bf16 v[208:223], v[48:51], a[212:215], v[208:223]
    ds_read_b64_tr_b16 v[48:49], v62 offset:12288
    ds_read_b64_tr_b16 v[50:51], v62 offset:13312
    v_cvt_pk_bf16_f32 v161, v130, v131
    s_waitcnt lgkmcnt(6)
    v_mfma_f32_32x32x16_bf16 v[224:239], v[52:55], a[208:211], v[224:239]
    s_add_u32 s71, s56, 24576
    buffer_load_dwordx4 a[204:207], v5, s[28:31], s71 offen offset:1024 sc1
    v_cvt_pk_bf16_f32 v162, v132, v133
    v_mfma_f32_32x32x16_bf16 v[240:255], v[52:55], a[212:215], v[240:255]
    ds_read_b64_tr_b16 v[52:53], v63 offset:12288
    ds_read_b64_tr_b16 v[54:55], v63 offset:13312
    v_cvt_pk_bf16_f32 v163, v134, v135
    s_waitcnt lgkmcnt(6)
    v_mfma_f32_32x32x16_bf16 v[64:79], v[40:43], a[216:219], v[64:79]
    s_waitcnt vmcnt(55)
    s_barrier
    s_add_u32 s68, s61, 8192
    v_mfma_f32_32x32x16_bf16 v[80:95], v[40:43], a[220:223], v[80:95]
    ds_read_b64_tr_b16 v[40:41], v60 offset:16384
    ds_read_b64_tr_b16 v[42:43], v60 offset:17408
    buffer_store_dwordx4 v[160:163], v5, s[20:23], s68 offen
    s_waitcnt lgkmcnt(6)
    v_mfma_f32_32x32x16_bf16 v[96:111], v[44:47], a[216:219], v[96:111]
    v_accvgpr_read_b32 v136, a8
    v_accvgpr_read_b32 v137, a9
    v_accvgpr_read_b32 v138, a10
    v_mfma_f32_32x32x16_bf16 v[112:127], v[44:47], a[220:223], v[112:127]
    ds_read_b64_tr_b16 v[44:45], v61 offset:16384
    ds_read_b64_tr_b16 v[46:47], v61 offset:17408
    v_accvgpr_read_b32 v139, a11
    s_waitcnt lgkmcnt(6)
    v_mfma_f32_32x32x16_bf16 v[192:207], v[48:51], a[216:219], v[192:207]
    s_add_u32 s70, s55, 24576
    buffer_load_dwordx4 a[208:211], v5, s[28:31], s70 offen offset:2048 sc1
    v_accvgpr_read_b32 v140, a12
    v_mfma_f32_32x32x16_bf16 v[208:223], v[48:51], a[220:223], v[208:223]
    ds_read_b64_tr_b16 v[48:49], v62 offset:16384
    ds_read_b64_tr_b16 v[50:51], v62 offset:17408
    v_accvgpr_read_b32 v141, a13
    s_waitcnt lgkmcnt(6)
    v_mfma_f32_32x32x16_bf16 v[224:239], v[52:55], a[216:219], v[224:239]
    s_add_u32 s71, s56, 24576
    buffer_load_dwordx4 a[212:215], v5, s[28:31], s71 offen offset:2048 sc1
    v_accvgpr_read_b32 v142, a14
    v_mfma_f32_32x32x16_bf16 v[240:255], v[52:55], a[220:223], v[240:255]
    ds_read_b64_tr_b16 v[52:53], v63 offset:16384
    ds_read_b64_tr_b16 v[54:55], v63 offset:17408
    v_accvgpr_read_b32 v143, a15
    s_waitcnt lgkmcnt(6)
    v_mfma_f32_32x32x16_bf16 v[64:79], v[40:43], a[224:227], v[64:79]
    v_cvt_pk_bf16_f32 v164, v136, v137
    v_cvt_pk_bf16_f32 v165, v138, v139
    v_cvt_pk_bf16_f32 v166, v140, v141
    v_mfma_f32_32x32x16_bf16 v[80:95], v[40:43], a[228:231], v[80:95]
    ds_read_b64_tr_b16 v[40:41], v60 offset:20480
    ds_read_b64_tr_b16 v[42:43], v60 offset:21504
    v_cvt_pk_bf16_f32 v167, v142, v143
    s_waitcnt lgkmcnt(6)
    v_mfma_f32_32x32x16_bf16 v[96:111], v[44:47], a[224:227], v[96:111]
    s_add_u32 s68, s61, 8192
    buffer_store_dwordx4 v[164:167], v5, s[20:23], s68 offen offset:1024
    v_accvgpr_read_b32 v144, a16
    v_mfma_f32_32x32x16_bf16 v[112:127], v[44:47], a[228:231], v[112:127]
    ds_read_b64_tr_b16 v[44:45], v61 offset:20480
    ds_read_b64_tr_b16 v[46:47], v61 offset:21504
    v_accvgpr_read_b32 v145, a17
    s_waitcnt lgkmcnt(6)
    v_mfma_f32_32x32x16_bf16 v[192:207], v[48:51], a[224:227], v[192:207]
    s_add_u32 s70, s55, 24576
    buffer_load_dwordx4 a[216:219], v5, s[28:31], s70 offen offset:3072 sc1
    v_accvgpr_read_b32 v146, a18
    v_mfma_f32_32x32x16_bf16 v[208:223], v[48:51], a[228:231], v[208:223]
    ds_read_b64_tr_b16 v[48:49], v62 offset:20480
    ds_read_b64_tr_b16 v[50:51], v62 offset:21504
    v_accvgpr_read_b32 v147, a19
    s_waitcnt lgkmcnt(6)
    v_mfma_f32_32x32x16_bf16 v[224:239], v[52:55], a[224:227], v[224:239]
    s_add_u32 s71, s56, 24576
    buffer_load_dwordx4 a[220:223], v5, s[28:31], s71 offen offset:3072 sc1
    v_accvgpr_read_b32 v148, a20
    v_mfma_f32_32x32x16_bf16 v[240:255], v[52:55], a[228:231], v[240:255]
    ds_read_b64_tr_b16 v[52:53], v63 offset:20480
    ds_read_b64_tr_b16 v[54:55], v63 offset:21504
    v_accvgpr_read_b32 v149, a21
    s_waitcnt lgkmcnt(6)
    v_mfma_f32_32x32x16_bf16 v[64:79], v[40:43], a[232:235], v[64:79]
    v_accvgpr_read_b32 v150, a22
    v_accvgpr_read_b32 v151, a23
    v_cvt_pk_bf16_f32 v168, v144, v145
    v_mfma_f32_32x32x16_bf16 v[80:95], v[40:43], a[236:239], v[80:95]
    ds_read_b64_tr_b16 v[40:41], v60 offset:24576
    ds_read_b64_tr_b16 v[42:43], v60 offset:25600
    v_cvt_pk_bf16_f32 v169, v146, v147
    s_waitcnt lgkmcnt(6)
    v_mfma_f32_32x32x16_bf16 v[96:111], v[44:47], a[232:235], v[96:111]
    v_cvt_pk_bf16_f32 v170, v148, v149
    v_cvt_pk_bf16_f32 v171, v150, v151
    s_add_u32 s68, s61, 24576
    v_mfma_f32_32x32x16_bf16 v[112:127], v[44:47], a[236:239], v[112:127]
    ds_read_b64_tr_b16 v[44:45], v61 offset:24576
    ds_read_b64_tr_b16 v[46:47], v61 offset:25600
    buffer_store_dwordx4 v[168:171], v5, s[20:23], s68 offen
    s_waitcnt lgkmcnt(6)
    v_mfma_f32_32x32x16_bf16 v[192:207], v[48:51], a[232:235], v[192:207]
    s_add_u32 s70, s55, 28672
    buffer_load_dwordx4 a[224:227], v5, s[28:31], s70 offen sc1
    v_accvgpr_read_b32 v152, a24
    v_mfma_f32_32x32x16_bf16 v[208:223], v[48:51], a[236:239], v[208:223]
    ds_read_b64_tr_b16 v[48:49], v62 offset:24576
    ds_read_b64_tr_b16 v[50:51], v62 offset:25600
    v_accvgpr_read_b32 v153, a25
    s_waitcnt lgkmcnt(6)
    v_mfma_f32_32x32x16_bf16 v[224:239], v[52:55], a[232:235], v[224:239]
    s_add_u32 s71, s56, 28672
    buffer_load_dwordx4 a[228:231], v5, s[28:31], s71 offen sc1
    v_accvgpr_read_b32 v154, a26
    v_accvgpr_read_b32 v155, a27
    v_mfma_f32_32x32x16_bf16 v[240:255], v[52:55], a[236:239], v[240:255]
    ds_read_b64_tr_b16 v[52:53], v63 offset:24576
    ds_read_b64_tr_b16 v[54:55], v63 offset:25600
    v_accvgpr_read_b32 v156, a28
    v_accvgpr_read_b32 v157, a29
    s_waitcnt lgkmcnt(6)
    v_mfma_f32_32x32x16_bf16 v[64:79], v[40:43], a[240:243], v[64:79]
    v_accvgpr_read_b32 v158, a30
    v_accvgpr_read_b32 v159, a31
    v_cvt_pk_bf16_f32 v172, v152, v153
    v_cvt_pk_bf16_f32 v173, v154, v155
    s_waitcnt vmcnt(63)
    v_mfma_f32_32x32x16_bf16 v[80:95], v[40:43], a[244:247], v[80:95]
    ds_read_b64_tr_b16 v[40:41], v60 offset:28672
    ds_read_b64_tr_b16 v[42:43], v60 offset:29696
    v_cvt_pk_bf16_f32 v174, v156, v157
    v_cvt_pk_bf16_f32 v175, v158, v159
    s_waitcnt lgkmcnt(6)
    v_mfma_f32_32x32x16_bf16 v[96:111], v[44:47], a[240:243], v[96:111]
    s_add_u32 s68, s61, 24576
    buffer_store_dwordx4 v[172:175], v5, s[20:23], s68 offen offset:1024
    v_accvgpr_read_b32 v128, a32
    v_accvgpr_read_b32 v129, a33
    v_mfma_f32_32x32x16_bf16 v[112:127], v[44:47], a[244:247], v[112:127]
    ds_read_b64_tr_b16 v[44:45], v61 offset:28672
    ds_read_b64_tr_b16 v[46:47], v61 offset:29696
    v_accvgpr_read_b32 v130, a34
    v_accvgpr_read_b32 v131, a35
    s_waitcnt lgkmcnt(6)
    v_mfma_f32_32x32x16_bf16 v[192:207], v[48:51], a[240:243], v[192:207]
    s_add_u32 s70, s55, 28672
    buffer_load_dwordx4 a[232:235], v5, s[28:31], s70 offen offset:1024 sc1
    v_accvgpr_read_b32 v132, a36
    v_accvgpr_read_b32 v133, a37
    v_mfma_f32_32x32x16_bf16 v[208:223], v[48:51], a[244:247], v[208:223]
    ds_read_b64_tr_b16 v[48:49], v62 offset:28672
    ds_read_b64_tr_b16 v[50:51], v62 offset:29696
    v_accvgpr_read_b32 v134, a38
    v_accvgpr_read_b32 v135, a39
    s_waitcnt lgkmcnt(6)
    v_mfma_f32_32x32x16_bf16 v[224:239], v[52:55], a[240:243], v[224:239]
    s_add_u32 s71, s56, 28672
    buffer_load_dwordx4 a[236:239], v5, s[28:31], s71 offen offset:1024 sc1
    v_cvt_pk_bf16_f32 v176, v128, v129
    v_cvt_pk_bf16_f32 v177, v130, v131
    v_mfma_f32_32x32x16_bf16 v[240:255], v[52:55], a[244:247], v[240:255]
    ds_read_b64_tr_b16 v[52:53], v63 offset:28672
    ds_read_b64_tr_b16 v[54:55], v63 offset:29696
    v_cvt_pk_bf16_f32 v178, v132, v133
    v_cvt_pk_bf16_f32 v179, v134, v135
    s_waitcnt vmcnt(63) lgkmcnt(6)
    v_mfma_f32_32x32x16_bf16 v[64:79], v[40:43], a[248:251], v[64:79]
    s_waitcnt vmcnt(60)
    s_barrier
    s_add_u32 s68, s61, 8192
    buffer_store_dwordx4 v[176:179], v5, s[20:23], s68 offen offset:2048
    v_mfma_f32_32x32x16_bf16 v[80:95], v[40:43], a[252:255], v[80:95]
    ds_read_b64_tr_b16 v[40:41], v12 offset:0
    ds_read_b64_tr_b16 v[42:43], v12 offset:1024
    v_accvgpr_read_b32 v136, a40
    v_accvgpr_read_b32 v137, a41
    s_waitcnt lgkmcnt(6)
    v_mfma_f32_32x32x16_bf16 v[96:111], v[44:47], a[248:251], v[96:111]
    v_accvgpr_read_b32 v138, a42
    v_accvgpr_read_b32 v139, a43
    v_accvgpr_read_b32 v140, a44
    v_accvgpr_read_b32 v141, a45
    v_mfma_f32_32x32x16_bf16 v[112:127], v[44:47], a[252:255], v[112:127]
    ds_read_b64_tr_b16 v[44:45], v13 offset:0
    ds_read_b64_tr_b16 v[46:47], v13 offset:1024
    v_accvgpr_read_b32 v142, a46
    v_accvgpr_read_b32 v143, a47
    s_waitcnt lgkmcnt(6)
    v_mfma_f32_32x32x16_bf16 v[192:207], v[48:51], a[248:251], v[192:207]
    s_add_u32 s70, s55, 28672
    buffer_load_dwordx4 a[240:243], v5, s[28:31], s70 offen offset:2048 sc1
    v_cvt_pk_bf16_f32 v180, v136, v137
    v_cvt_pk_bf16_f32 v181, v138, v139
    v_mfma_f32_32x32x16_bf16 v[208:223], v[48:51], a[252:255], v[208:223]
    ds_read_b64_tr_b16 v[48:49], v14 offset:0
    ds_read_b64_tr_b16 v[50:51], v14 offset:1024
    v_cvt_pk_bf16_f32 v182, v140, v141
    v_cvt_pk_bf16_f32 v183, v142, v143
    s_waitcnt lgkmcnt(6)
    v_mfma_f32_32x32x16_bf16 v[224:239], v[52:55], a[248:251], v[224:239]
    s_add_u32 s71, s56, 28672
    buffer_load_dwordx4 a[244:247], v5, s[28:31], s71 offen offset:2048 sc1
    s_add_u32 s68, s61, 8192
    buffer_store_dwordx4 v[180:183], v5, s[20:23], s68 offen offset:3072
    v_mfma_f32_32x32x16_bf16 v[240:255], v[52:55], a[252:255], v[240:255]
    ds_read_b64_tr_b16 v[52:53], v15 offset:0
    ds_read_b64_tr_b16 v[54:55], v15 offset:1024
    v_accvgpr_read_b32 v144, a48
    v_accvgpr_read_b32 v145, a49
    s_waitcnt vmcnt(48) lgkmcnt(6)
    v_mfma_f32_32x32x16_bf16 v[64:79], v[40:43], a[128:131], v[64:79]
    v_accvgpr_read_b32 v146, a50
    v_accvgpr_read_b32 v147, a51
    v_accvgpr_read_b32 v148, a52
    v_accvgpr_read_b32 v149, a53
    s_waitcnt vmcnt(47)
    v_mfma_f32_32x32x16_bf16 v[80:95], v[40:43], a[132:135], v[80:95]
    ds_read_b64_tr_b16 v[40:41], v12 offset:4096
    ds_read_b64_tr_b16 v[42:43], v12 offset:5120
    v_accvgpr_read_b32 v150, a54
    v_accvgpr_read_b32 v151, a55
    s_waitcnt lgkmcnt(6)
    v_mfma_f32_32x32x16_bf16 v[96:111], v[44:47], a[128:131], v[96:111]
    v_cvt_pk_bf16_f32 v184, v144, v145
    v_cvt_pk_bf16_f32 v185, v146, v147
    v_cvt_pk_bf16_f32 v186, v148, v149
    v_cvt_pk_bf16_f32 v187, v150, v151
    v_mfma_f32_32x32x16_bf16 v[112:127], v[44:47], a[132:135], v[112:127]
    ds_read_b64_tr_b16 v[44:45], v13 offset:4096
    ds_read_b64_tr_b16 v[46:47], v13 offset:5120
    s_add_u32 s68, s61, 24576
    buffer_store_dwordx4 v[184:187], v5, s[20:23], s68 offen offset:2048
    s_waitcnt lgkmcnt(6)
    v_mfma_f32_32x32x16_bf16 v[192:207], v[48:51], a[128:131], v[192:207]
    s_add_u32 s70, s55, 28672
    buffer_load_dwordx4 a[248:251], v5, s[28:31], s70 offen offset:3072 sc1
    v_accvgpr_read_b32 v152, a56
    v_accvgpr_read_b32 v153, a57
    v_mfma_f32_32x32x16_bf16 v[208:223], v[48:51], a[132:135], v[208:223]
    ds_read_b64_tr_b16 v[48:49], v14 offset:4096
    ds_read_b64_tr_b16 v[50:51], v14 offset:5120
    v_accvgpr_read_b32 v154, a58
    v_accvgpr_read_b32 v155, a59
    s_waitcnt lgkmcnt(6)
    v_mfma_f32_32x32x16_bf16 v[224:239], v[52:55], a[128:131], v[224:239]
    s_add_u32 s71, s56, 28672
    buffer_load_dwordx4 a[252:255], v5, s[28:31], s71 offen offset:3072 sc1
    v_accvgpr_read_b32 v156, a60
    v_accvgpr_read_b32 v157, a61
    v_mfma_f32_32x32x16_bf16 v[240:255], v[52:55], a[132:135], v[240:255]
    ds_read_b64_tr_b16 v[52:53], v15 offset:4096
    ds_read_b64_tr_b16 v[54:55], v15 offset:5120
    v_accvgpr_read_b32 v158, a62
    v_accvgpr_read_b32 v159, a63
    s_waitcnt vmcnt(48) lgkmcnt(6)
    v_mfma_f32_32x32x16_bf16 v[64:79], v[40:43], a[136:139], v[64:79]
    v_cvt_pk_bf16_f32 v188, v152, v153
    v_cvt_pk_bf16_f32 v189, v154, v155
    v_cvt_pk_bf16_f32 v190, v156, v157
    v_cvt_pk_bf16_f32 v191, v158, v159
    s_waitcnt vmcnt(47)
    v_mfma_f32_32x32x16_bf16 v[80:95], v[40:43], a[140:143], v[80:95]
    ds_read_b64_tr_b16 v[40:41], v12 offset:8192
    ds_read_b64_tr_b16 v[42:43], v12 offset:9216
    s_add_u32 s68, s61, 24576
    buffer_store_dwordx4 v[188:191], v5, s[20:23], s68 offen offset:3072
    s_waitcnt lgkmcnt(6)
    v_mfma_f32_32x32x16_bf16 v[96:111], v[44:47], a[136:139], v[96:111]
    v_accvgpr_read_b32 v128, a64
    v_accvgpr_read_b32 v129, a65
    v_accvgpr_read_b32 v130, a66
    v_accvgpr_read_b32 v131, a67
    v_mfma_f32_32x32x16_bf16 v[112:127], v[44:47], a[140:143], v[112:127]
    ds_read_b64_tr_b16 v[44:45], v13 offset:8192
    ds_read_b64_tr_b16 v[46:47], v13 offset:9216
    v_accvgpr_read_b32 v132, a68
    v_accvgpr_read_b32 v133, a69
    s_waitcnt lgkmcnt(6)
    v_mfma_f32_32x32x16_bf16 v[192:207], v[48:51], a[136:139], v[192:207]
    v_accvgpr_read_b32 v134, a70
    v_accvgpr_read_b32 v135, a71
    v_cvt_pk_bf16_f32 v160, v128, v129
    v_cvt_pk_bf16_f32 v161, v130, v131
    v_mfma_f32_32x32x16_bf16 v[208:223], v[48:51], a[140:143], v[208:223]
    ds_read_b64_tr_b16 v[48:49], v14 offset:8192
    ds_read_b64_tr_b16 v[50:51], v14 offset:9216
    v_cvt_pk_bf16_f32 v162, v132, v133
    v_cvt_pk_bf16_f32 v163, v134, v135
    s_waitcnt lgkmcnt(6)
    v_mfma_f32_32x32x16_bf16 v[224:239], v[52:55], a[136:139], v[224:239]
    s_add_u32 s68, s61, 12288
    buffer_store_dwordx4 v[160:163], v5, s[20:23], s68 offen
    v_accvgpr_read_b32 v136, a72
    v_accvgpr_read_b32 v137, a73
    v_mfma_f32_32x32x16_bf16 v[240:255], v[52:55], a[140:143], v[240:255]
    ds_read_b64_tr_b16 v[52:53], v15 offset:8192
    ds_read_b64_tr_b16 v[54:55], v15 offset:9216
    v_accvgpr_read_b32 v138, a74
    v_accvgpr_read_b32 v139, a75
    s_waitcnt vmcnt(47) lgkmcnt(6)
    v_mfma_f32_32x32x16_bf16 v[64:79], v[40:43], a[144:147], v[64:79]
    v_accvgpr_read_b32 v140, a76
    v_accvgpr_read_b32 v141, a77
    v_accvgpr_read_b32 v142, a78
    v_accvgpr_read_b32 v143, a79
    s_waitcnt vmcnt(46)
    v_mfma_f32_32x32x16_bf16 v[80:95], v[40:43], a[148:151], v[80:95]
    ds_read_b64_tr_b16 v[40:41], v12 offset:12288
    ds_read_b64_tr_b16 v[42:43], v12 offset:13312
    v_cvt_pk_bf16_f32 v164, v136, v137
    v_cvt_pk_bf16_f32 v165, v138, v139
    s_waitcnt lgkmcnt(6)
    v_mfma_f32_32x32x16_bf16 v[96:111], v[44:47], a[144:147], v[96:111]
    v_cvt_pk_bf16_f32 v166, v140, v141
    v_cvt_pk_bf16_f32 v167, v142, v143
    s_add_u32 s68, s61, 12288
    buffer_store_dwordx4 v[164:167], v5, s[20:23], s68 offen offset:1024
    v_mfma_f32_32x32x16_bf16 v[112:127], v[44:47], a[148:151], v[112:127]
    ds_read_b64_tr_b16 v[44:45], v13 offset:12288
    ds_read_b64_tr_b16 v[46:47], v13 offset:13312
    v_accvgpr_read_b32 v144, a80
    v_accvgpr_read_b32 v145, a81
    s_waitcnt lgkmcnt(6)
    v_mfma_f32_32x32x16_bf16 v[192:207], v[48:51], a[144:147], v[192:207]
    v_accvgpr_read_b32 v146, a82
    v_accvgpr_read_b32 v147, a83
    v_accvgpr_read_b32 v148, a84
    v_accvgpr_read_b32 v149, a85
    v_mfma_f32_32x32x16_bf16 v[208:223], v[48:51], a[148:151], v[208:223]
    ds_read_b64_tr_b16 v[48:49], v14 offset:12288
    ds_read_b64_tr_b16 v[50:51], v14 offset:13312
    v_accvgpr_read_b32 v150, a86
    v_accvgpr_read_b32 v151, a87
    s_waitcnt lgkmcnt(6)
    v_mfma_f32_32x32x16_bf16 v[224:239], v[52:55], a[144:147], v[224:239]
    v_cvt_pk_bf16_f32 v168, v144, v145
    v_cvt_pk_bf16_f32 v169, v146, v147
    v_cvt_pk_bf16_f32 v170, v148, v149
    v_cvt_pk_bf16_f32 v171, v150, v151
    v_mfma_f32_32x32x16_bf16 v[240:255], v[52:55], a[148:151], v[240:255]
    ds_read_b64_tr_b16 v[52:53], v15 offset:12288
    ds_read_b64_tr_b16 v[54:55], v15 offset:13312
    s_add_u32 s68, s61, 28672
    buffer_store_dwordx4 v[168:171], v5, s[20:23], s68 offen
    s_waitcnt vmcnt(45) lgkmcnt(6)
    v_mfma_f32_32x32x16_bf16 v[64:79], v[40:43], a[152:155], v[64:79]
    s_waitcnt vmcnt(63)
    s_barrier
    v_accvgpr_read_b32 v152, a88
    v_accvgpr_read_b32 v153, a89
    s_waitcnt vmcnt(44)
    v_mfma_f32_32x32x16_bf16 v[80:95], v[40:43], a[156:159], v[80:95]
    ds_read_b64_tr_b16 v[40:41], v12 offset:16384
    ds_read_b64_tr_b16 v[42:43], v12 offset:17408
    v_accvgpr_read_b32 v154, a90
    v_accvgpr_read_b32 v155, a91
    s_waitcnt lgkmcnt(6)
    v_mfma_f32_32x32x16_bf16 v[96:111], v[44:47], a[152:155], v[96:111]
    v_accvgpr_read_b32 v156, a92
    v_accvgpr_read_b32 v157, a93
    v_accvgpr_read_b32 v158, a94
    v_accvgpr_read_b32 v159, a95
    v_mfma_f32_32x32x16_bf16 v[112:127], v[44:47], a[156:159], v[112:127]
    ds_read_b64_tr_b16 v[44:45], v13 offset:16384
    ds_read_b64_tr_b16 v[46:47], v13 offset:17408
    v_cvt_pk_bf16_f32 v172, v152, v153
    v_cvt_pk_bf16_f32 v173, v154, v155
    s_waitcnt lgkmcnt(6)
    v_mfma_f32_32x32x16_bf16 v[192:207], v[48:51], a[152:155], v[192:207]
    v_cvt_pk_bf16_f32 v174, v156, v157
    v_cvt_pk_bf16_f32 v175, v158, v159
    s_add_u32 s68, s61, 28672
    buffer_store_dwordx4 v[172:175], v5, s[20:23], s68 offen offset:1024
    v_mfma_f32_32x32x16_bf16 v[208:223], v[48:51], a[156:159], v[208:223]
    ds_read_b64_tr_b16 v[48:49], v14 offset:16384
    ds_read_b64_tr_b16 v[50:51], v14 offset:17408
    v_accvgpr_read_b32 v128, a96
    v_accvgpr_read_b32 v129, a97
    s_waitcnt lgkmcnt(6)
    v_mfma_f32_32x32x16_bf16 v[224:239], v[52:55], a[152:155], v[224:239]
    v_accvgpr_read_b32 v130, a98
    v_accvgpr_read_b32 v131, a99
    v_accvgpr_read_b32 v132, a100
    v_accvgpr_read_b32 v133, a101
    v_mfma_f32_32x32x16_bf16 v[240:255], v[52:55], a[156:159], v[240:255]
    ds_read_b64_tr_b16 v[52:53], v15 offset:16384
    ds_read_b64_tr_b16 v[54:55], v15 offset:17408
    v_accvgpr_read_b32 v134, a102
    v_accvgpr_read_b32 v135, a103
    s_waitcnt vmcnt(42) lgkmcnt(6)
    v_mfma_f32_32x32x16_bf16 v[64:79], v[40:43], a[160:163], v[64:79]
    v_cvt_pk_bf16_f32 v176, v128, v129
    v_cvt_pk_bf16_f32 v177, v130, v131
    v_cvt_pk_bf16_f32 v178, v132, v133
    v_cvt_pk_bf16_f32 v179, v134, v135
    s_waitcnt vmcnt(41)
    v_mfma_f32_32x32x16_bf16 v[80:95], v[40:43], a[164:167], v[80:95]
    ds_read_b64_tr_b16 v[40:41], v12 offset:20480
    ds_read_b64_tr_b16 v[42:43], v12 offset:21504
    s_add_u32 s68, s61, 12288
    buffer_store_dwordx4 v[176:179], v5, s[20:23], s68 offen offset:2048
    s_waitcnt lgkmcnt(6)
    v_mfma_f32_32x32x16_bf16 v[96:111], v[44:47], a[160:163], v[96:111]
    v_accvgpr_read_b32 v136, a104
    v_accvgpr_read_b32 v137, a105
    v_accvgpr_read_b32 v138, a106
    v_accvgpr_read_b32 v139, a107
    v_mfma_f32_32x32x16_bf16 v[112:127], v[44:47], a[164:167], v[112:127]
    ds_read_b64_tr_b16 v[44:45], v13 offset:20480
    ds_read_b64_tr_b16 v[46:47], v13 offset:21504
    v_accvgpr_read_b32 v140, a108
    v_accvgpr_read_b32 v141, a109
    s_waitcnt lgkmcnt(6)
    v_mfma_f32_32x32x16_bf16 v[192:207], v[48:51], a[160:163], v[192:207]
    v_accvgpr_read_b32 v142, a110
    v_accvgpr_read_b32 v143, a111
    v_cvt_pk_bf16_f32 v180, v136, v137
    v_cvt_pk_bf16_f32 v181, v138, v139
    v_mfma_f32_32x32x16_bf16 v[208:223], v[48:51], a[164:167], v[208:223]
    ds_read_b64_tr_b16 v[48:49], v14 offset:20480
    ds_read_b64_tr_b16 v[50:51], v14 offset:21504
    v_cvt_pk_bf16_f32 v182, v140, v141
    v_cvt_pk_bf16_f32 v183, v142, v143
    s_waitcnt lgkmcnt(6)
    v_mfma_f32_32x32x16_bf16 v[224:239], v[52:55], a[160:163], v[224:239]
    s_add_u32 s68, s61, 12288
    buffer_store_dwordx4 v[180:183], v5, s[20:23], s68 offen offset:3072
    v_accvgpr_read_b32 v144, a112
    v_accvgpr_read_b32 v145, a113
    v_mfma_f32_32x32x16_bf16 v[240:255], v[52:55], a[164:167], v[240:255]
    ds_read_b64_tr_b16 v[52:53], v15 offset:20480
    ds_read_b64_tr_b16 v[54:55], v15 offset:21504
    v_accvgpr_read_b32 v146, a114
    v_accvgpr_read_b32 v147, a115
    s_waitcnt vmcnt(40) lgkmcnt(6)
    v_mfma_f32_32x32x16_bf16 v[64:79], v[40:43], a[168:171], v[64:79]
    v_accvgpr_read_b32 v148, a116
    v_accvgpr_read_b32 v149, a117
    v_accvgpr_read_b32 v150, a118
    v_accvgpr_read_b32 v151, a119
    s_waitcnt vmcnt(39)
    v_mfma_f32_32x32x16_bf16 v[80:95], v[40:43], a[172:175], v[80:95]
    ds_read_b64_tr_b16 v[40:41], v12 offset:24576
    ds_read_b64_tr_b16 v[42:43], v12 offset:25600
    v_cvt_pk_bf16_f32 v184, v144, v145
    v_cvt_pk_bf16_f32 v185, v146, v147
    s_waitcnt lgkmcnt(6)
    v_mfma_f32_32x32x16_bf16 v[96:111], v[44:47], a[168:171], v[96:111]
    v_cvt_pk_bf16_f32 v186, v148, v149
    v_cvt_pk_bf16_f32 v187, v150, v151
    s_add_u32 s68, s61, 28672
    buffer_store_dwordx4 v[184:187], v5, s[20:23], s68 offen offset:2048
    v_mfma_f32_32x32x16_bf16 v[112:127], v[44:47], a[172:175], v[112:127]
    ds_read_b64_tr_b16 v[44:45], v13 offset:24576
    ds_read_b64_tr_b16 v[46:47], v13 offset:25600
    v_accvgpr_read_b32 v152, a120
    v_accvgpr_read_b32 v153, a121
    s_waitcnt lgkmcnt(6)
    v_mfma_f32_32x32x16_bf16 v[192:207], v[48:51], a[168:171], v[192:207]
    v_accvgpr_read_b32 v154, a122
    v_accvgpr_read_b32 v155, a123
    v_accvgpr_read_b32 v156, a124
    v_accvgpr_read_b32 v157, a125
    v_mfma_f32_32x32x16_bf16 v[208:223], v[48:51], a[172:175], v[208:223]
    ds_read_b64_tr_b16 v[48:49], v14 offset:24576
    ds_read_b64_tr_b16 v[50:51], v14 offset:25600
    v_accvgpr_read_b32 v158, a126
    v_accvgpr_read_b32 v159, a127
    s_waitcnt lgkmcnt(6)
    v_mfma_f32_32x32x16_bf16 v[224:239], v[52:55], a[168:171], v[224:239]
    v_cvt_pk_bf16_f32 v188, v152, v153
    v_cvt_pk_bf16_f32 v189, v154, v155
    v_cvt_pk_bf16_f32 v190, v156, v157
    v_cvt_pk_bf16_f32 v191, v158, v159
    v_mfma_f32_32x32x16_bf16 v[240:255], v[52:55], a[172:175], v[240:255]
    ds_read_b64_tr_b16 v[52:53], v15 offset:24576
    ds_read_b64_tr_b16 v[54:55], v15 offset:25600
    s_add_u32 s68, s61, 28672
    buffer_store_dwordx4 v[188:191], v5, s[20:23], s68 offen offset:3072
    s_waitcnt vmcnt(39) lgkmcnt(6)
    v_mfma_f32_32x32x16_bf16 v[64:79], v[40:43], a[176:179], v[64:79]
    v_accvgpr_write_b32 a0, 0
    v_accvgpr_write_b32 a1, 0
    s_waitcnt vmcnt(38)
    v_mfma_f32_32x32x16_bf16 v[80:95], v[40:43], a[180:183], v[80:95]
    ds_read_b64_tr_b16 v[40:41], v12 offset:28672
    ds_read_b64_tr_b16 v[42:43], v12 offset:29696
    s_waitcnt lgkmcnt(6)
    v_mfma_f32_32x32x16_bf16 v[96:111], v[44:47], a[176:179], v[96:111]
    v_accvgpr_write_b32 a2, 0
    v_accvgpr_write_b32 a3, 0
    v_mfma_f32_32x32x16_bf16 v[112:127], v[44:47], a[180:183], v[112:127]
    ds_read_b64_tr_b16 v[44:45], v13 offset:28672
    ds_read_b64_tr_b16 v[46:47], v13 offset:29696
    s_waitcnt lgkmcnt(6)
    v_mfma_f32_32x32x16_bf16 v[192:207], v[48:51], a[176:179], v[192:207]
    v_accvgpr_write_b32 a4, 0
    v_accvgpr_write_b32 a5, 0
    v_mfma_f32_32x32x16_bf16 v[208:223], v[48:51], a[180:183], v[208:223]
    ds_read_b64_tr_b16 v[48:49], v14 offset:28672
    ds_read_b64_tr_b16 v[50:51], v14 offset:29696
    s_waitcnt lgkmcnt(6)
    v_mfma_f32_32x32x16_bf16 v[224:239], v[52:55], a[176:179], v[224:239]
    v_accvgpr_write_b32 a6, 0
    v_accvgpr_write_b32 a7, 0
    v_mfma_f32_32x32x16_bf16 v[240:255], v[52:55], a[180:183], v[240:255]
    ds_read_b64_tr_b16 v[52:53], v15 offset:28672
    ds_read_b64_tr_b16 v[54:55], v15 offset:29696
    s_waitcnt vmcnt(35) lgkmcnt(6)
    v_mfma_f32_32x32x16_bf16 v[64:79], v[40:43], a[184:187], v[64:79]
    s_waitcnt vmcnt(0)
    s_barrier
    s_cmp_lg_u32 s46, 0
    s_cbranch_scc1 KA_SIG2
    s_cmp_eq_u32 s63, 1
    s_cbranch_scc1 KA_SIG2F
    buffer_wbl2 sc1
    s_waitcnt vmcnt(0)
KA_SIG2F:
    v_mov_b32 v56, 1
    s_mov_b64 exec, 1
    buffer_atomic_add v56, v58, s[32:35], 0 offen
    s_mov_b64 exec, -1
KA_SIG2:
    v_mfma_f32_32x32x16_bf16 v[80:95], v[40:43], a[188:191], v[80:95]
    ds_read_b64_tr_b16 v[40:41], v60 offset:32768
    ds_read_b64_tr_b16 v[42:43], v60 offset:33792
    s_waitcnt lgkmcnt(6)
    v_mfma_f32_32x32x16_bf16 v[96:111], v[44:47], a[184:187], v[96:111]
    v_accvgpr_write_b32 a8, 0
    v_accvgpr_write_b32 a9, 0
    v_mfma_f32_32x32x16_bf16 v[112:127], v[44:47], a[188:191], v[112:127]
    ds_read_b64_tr_b16 v[44:45], v61 offset:32768
    ds_read_b64_tr_b16 v[46:47], v61 offset:33792
    s_waitcnt lgkmcnt(6)
    v_mfma_f32_32x32x16_bf16 v[192:207], v[48:51], a[184:187], v[192:207]
    v_accvgpr_write_b32 a10, 0
    v_accvgpr_write_b32 a11, 0
    v_mfma_f32_32x32x16_bf16 v[208:223], v[48:51], a[188:191], v[208:223]
    ds_read_b64_tr_b16 v[48:49], v62 offset:32768
    ds_read_b64_tr_b16 v[50:51], v62 offset:33792
    s_waitcnt lgkmcnt(6)
    v_mfma_f32_32x32x16_bf16 v[224:239], v[52:55], a[184:187], v[224:239]
    v_accvgpr_write_b32 a12, 0
    v_accvgpr_write_b32 a13, 0
    v_mfma_f32_32x32x16_bf16 v[240:255], v[52:55], a[188:191], v[240:255]
    ds_read_b64_tr_b16 v[52:53], v63 offset:32768
    ds_read_b64_tr_b16 v[54:55], v63 offset:33792
    s_waitcnt lgkmcnt(6)
    v_mfma_f32_32x32x16_bf16 v[64:79], v[40:43], a[192:195], v[64:79]
    v_accvgpr_write_b32 a14, 0
    v_accvgpr_write_b32 a15, 0
    v_and_b32 v24, 31, v2
    v_lshrrev_b32 v25, 5, v2
    v_mfma_f32_32x32x16_bf16 v[80:95], v[40:43], a[196:199], v[80:95]
    ds_read_b64_tr_b16 v[40:41], v60 offset:36864
    ds_read_b64_tr_b16 v[42:43], v60 offset:37888
    v_lshlrev_b32 v25, 2, v25
    s_lshl_b32 s68, s46, 5
    s_waitcnt lgkmcnt(6)
    v_mfma_f32_32x32x16_bf16 v[96:111], v[44:47], a[192:195], v[96:111]
    v_accvgpr_write_b32 a16, 0
    v_accvgpr_write_b32 a17, 0
    v_add_u32 v24, s68, v24
    v_sub_u32 v24, v24, v25
    v_mfma_f32_32x32x16_bf16 v[112:127], v[44:47], a[196:199], v[112:127]
    ds_read_b64_tr_b16 v[44:45], v61 offset:36864
    ds_read_b64_tr_b16 v[46:47], v61 offset:37888
    s_cmp_eq_u32 s48, 0
    s_cselect_b32 s68, 0, 4096
    s_waitcnt lgkmcnt(6)
    v_mfma_f32_32x32x16_bf16 v[192:207], v[48:51], a[192:195], v[192:207]
    v_accvgpr_write_b32 a18, 0
    v_accvgpr_write_b32 a19, 0
    v_add_u32 v24, s68, v24
    v_mov_b32 v25, 0
    v_mfma_f32_32x32x16_bf16 v[208:223], v[48:51], a[196:199], v[208:223]
    ds_read_b64_tr_b16 v[48:49], v62 offset:36864
    ds_read_b64_tr_b16 v[50:51], v62 offset:37888
    v_mov_b32 v26, 0xff800000
    v_cmp_le_i32 s[72:73], 0, v24
    s_waitcnt lgkmcnt(6)
    v_mfma_f32_32x32x16_bf16 v[224:239], v[52:55], a[192:195], v[224:239]
    v_accvgpr_write_b32 a20, 0
    v_accvgpr_write_b32 a21, 0
    v_cmp_le_i32 s[74:75], 1, v24
    v_cmp_le_i32 s[76:77], 2, v24
    v_mfma_f32_32x32x16_bf16 v[240:255], v[52:55], a[196:199], v[240:255]
    ds_read_b64_tr_b16 v[52:53], v63 offset:36864
    ds_read_b64_tr_b16 v[54:55], v63 offset:37888
    v_cmp_le_i32 s[78:79], 3, v24
    v_cndmask_b32 v176, v26, v25, s[72:73]
    s_waitcnt lgkmcnt(6)
    v_mfma_f32_32x32x16_bf16 v[64:79], v[40:43], a[200:203], v[64:79]
    v_accvgpr_write_b32 a22, 0
    v_accvgpr_write_b32 a23, 0
    v_cndmask_b32 v177, v26, v25, s[74:75]
    v_cndmask_b32 v178, v26, v25, s[76:77]
    v_mfma_f32_32x32x16_bf16 v[80:95], v[40:43], a[204:207], v[80:95]
    ds_read_b64_tr_b16 v[40:41], v60 offset:40960
    ds_read_b64_tr_b16 v[42:43], v60 offset:41984
    v_cndmask_b32 v179, v26, v25, s[78:79]
    v_cmp_le_i32 s[72:73], 8, v24
    s_waitcnt lgkmcnt(6)
    v_mfma_f32_32x32x16_bf16 v[96:111], v[44:47], a[200:203], v[96:111]
    v_accvgpr_write_b32 a24, 0
    v_accvgpr_write_b32 a25, 0
    s_cmp_lg_u32 s46, 0
    s_cbranch_scc1 KA_PL2
    buffer_load_dword v57, v58, s[32:35], 0 offen sc1
KA_PL2:
    v_mfma_f32_32x32x16_bf16 v[112:127], v[44:47], a[204:207], v[112:127]
    ds_read_b64_tr_b16 v[44:45], v61 offset:40960
    ds_read_b64_tr_b16 v[46:47], v61 offset:41984
    v_cmp_le_i32 s[74:75], 9, v24
    v_cmp_le_i32 s[76:77], 10, v24
    s_waitcnt lgkmcnt(6)
    v_mfma_f32_32x32x16_bf16 v[192:207], v[48:51], a[200:203], v[192:207]
    v_accvgpr_write_b32 a26, 0
    v_accvgpr_write_b32 a27, 0
    v_cmp_le_i32 s[78:79], 11, v24
    v_cndmask_b32 v180, v26, v25, s[72:73]
    v_mfma_f32_32x32x16_bf16 v[208:223], v[48:51], a[204:207], v[208:223]
    ds_read_b64_tr_b16 v[48:49], v62 offset:40960
    ds_read_b64_tr_b16 v[50:51], v62 offset:41984
    v_cndmask_b32 v181, v26, v25, s[74:75]
    v_cndmask_b32 v182, v26, v25, s[76:77]
    s_waitcnt lgkmcnt(6)
    v_mfma_f32_32x32x16_bf16 v[224:239], v[52:55], a[200:203], v[224:239]
    v_accvgpr_write_b32 a28, 0
    v_accvgpr_write_b32 a29, 0
    v_cndmask_b32 v183, v26, v25, s[78:79]
    v_cmp_le_i32 s[72:73], 16, v24
    v_mfma_f32_32x32x16_bf16 v[240:255], v[52:55], a[204:207], v[240:255]
    ds_read_b64_tr_b16 v[52:53], v63 offset:40960
    ds_read_b64_tr_b16 v[54:55], v63 offset:41984
    v_cmp_le_i32 s[74:75], 17, v24
    v_cmp_le_i32 s[76:77], 18, v24
    s_waitcnt lgkmcnt(6)
    v_mfma_f32_32x32x16_bf16 v[64:79], v[40:43], a[208:211], v[64:79]
    v_accvgpr_write_b32 a30, 0
    v_accvgpr_write_b32 a31, 0
    v_cmp_le_i32 s[78:79], 19, v24
    v_cndmask_b32 v184, v26, v25, s[72:73]
    v_mfma_f32_32x32x16_bf16 v[80:95], v[40:43], a[212:215], v[80:95]
    ds_read_b64_tr_b16 v[40:41], v60 offset:45056
    ds_read_b64_tr_b16 v[42:43], v60 offset:46080
    v_cndmask_b32 v185, v26, v25, s[74:75]
    v_cndmask_b32 v186, v26, v25, s[76:77]
    s_waitcnt lgkmcnt(6)
    v_mfma_f32_32x32x16_bf16 v[96:111], v[44:47], a[208:211], v[96:111]
    v_accvgpr_write_b32 a32, 0
    v_accvgpr_write_b32 a33, 0
    v_cndmask_b32 v187, v26, v25, s[78:79]
    v_cmp_le_i32 s[72:73], 24, v24
    v_mfma_f32_32x32x16_bf16 v[112:127], v[44:47], a[212:215], v[112:127]
    ds_read_b64_tr_b16 v[44:45], v61 offset:45056
    ds_read_b64_tr_b16 v[46:47], v61 offset:46080
    v_cmp_le_i32 s[74:75], 25, v24
    v_cmp_le_i32 s[76:77], 26, v24
    s_waitcnt lgkmcnt(6)
    v_mfma_f32_32x32x16_bf16 v[192:207], v[48:51], a[208:211], v[192:207]
    v_accvgpr_write_b32 a34, 0
    v_accvgpr_write_b32 a35, 0
    v_accvgpr_write_b32 a36, 0
    v_cmp_le_i32 s[78:79], 27, v24
    v_mfma_f32_32x32x16_bf16 v[208:223], v[48:51], a[212:215], v[208:223]
    ds_read_b64_tr_b16 v[48:49], v62 offset:45056
    ds_read_b64_tr_b16 v[50:51], v62 offset:46080
    v_accvgpr_write_b32 a37, 0
    v_cndmask_b32 v188, v26, v25, s[72:73]
    s_waitcnt lgkmcnt(6)
    v_mfma_f32_32x32x16_bf16 v[224:239], v[52:55], a[208:211], v[224:239]
    v_accvgpr_write_b32 a38, 0
    v_accvgpr_write_b32 a39, 0
    v_accvgpr_write_b32 a40, 0
    v_cndmask_b32 v189, v26, v25, s[74:75]
    v_mfma_f32_32x32x16_bf16 v[240:255], v[52:55], a[212:215], v[240:255]
    ds_read_b64_tr_b16 v[52:53], v63 offset:45056
    ds_read_b64_tr_b16 v[54:55], v63 offset:46080
    v_accvgpr_write_b32 a41, 0
    v_cndmask_b32 v190, v26, v25, s[76:77]
    v_cndmask_b32 v191, v26, v25, s[78:79]
    s_waitcnt lgkmcnt(6)
    v_mfma_f32_32x32x16_bf16 v[64:79], v[40:43], a[216:219], v[64:79]
    s_waitcnt vmcnt(63)
    s_cmp_lg_u32 s46, 0
    s_cbranch_scc1 KA_CK2
    s_waitcnt vmcnt(0)
    v_cmp_gt_u32 vcc, 8, v57
    s_nop 0
    s_cbranch_vccnz KA_SP2
KA_SP2_R:
    s_cmp_eq_u32 s63, 1
    s_cbranch_scc1 KA_CK2
    buffer_inv sc1
    s_waitcnt vmcnt(0)
KA_CK2:
    s_barrier
    v_accvgpr_write_b32 a42, 0
    v_mfma_f32_32x32x16_bf16 v[80:95], v[40:43], a[220:223], v[80:95]
    ds_read_b64_tr_b16 v[40:41], v60 offset:49152
    ds_read_b64_tr_b16 v[42:43], v60 offset:50176
    v_accvgpr_write_b32 a43, 0
    s_waitcnt lgkmcnt(6)
    v_mfma_f32_32x32x16_bf16 v[96:111], v[44:47], a[216:219], v[96:111]
    v_accvgpr_write_b32 a44, 0
    v_accvgpr_write_b32 a45, 0
    v_accvgpr_write_b32 a46, 0
    s_mov_b32 m0, s50
    v_mfma_f32_32x32x16_bf16 v[112:127], v[44:47], a[220:223], v[112:127]
    ds_read_b64_tr_b16 v[44:45], v61 offset:49152
    ds_read_b64_tr_b16 v[46:47], v61 offset:50176
    v_accvgpr_write_b32 a47, 0
    buffer_load_dwordx4 v10, s[24:27], s49 offen sc1 lds
    s_waitcnt lgkmcnt(6)
    v_mfma_f32_32x32x16_bf16 v[192:207], v[48:51], a[216:219], v[192:207]
    v_accvgpr_write_b32 a48, 0
    v_accvgpr_write_b32 a49, 0
    v_accvgpr_write_b32 a50, 0
    buffer_load_dwordx4 v10, s[24:27], s49 offen offset:1024 sc1 lds
    v_mfma_f32_32x32x16_bf16 v[208:223], v[48:51], a[220:223], v[208:223]
    ds_read_b64_tr_b16 v[48:49], v62 offset:49152
    ds_read_b64_tr_b16 v[50:51], v62 offset:50176
    v_accvgpr_write_b32 a51, 0
    s_waitcnt lgkmcnt(6)
    v_mfma_f32_32x32x16_bf16 v[224:239], v[52:55], a[216:219], v[224:239]
    v_accvgpr_write_b32 a52, 0
    v_accvgpr_write_b32 a53, 0
    v_accvgpr_write_b32 a54, 0
    buffer_load_dwordx4 v10, s[24:27], s49 offen offset:2048 sc1 lds
    v_mfma_f32_32x32x16_bf16 v[240:255], v[52:55], a[220:223], v[240:255]
    ds_read_b64_tr_b16 v[52:53], v63 offset:49152
    ds_read_b64_tr_b16 v[54:55], v63 offset:50176
    v_accvgpr_write_b32 a55, 0
    buffer_load_dwordx4 v10, s[24:27], s49 offen offset:3072 sc1 lds
    s_waitcnt lgkmcnt(6)
    v_mfma_f32_32x32x16_bf16 v[64:79], v[40:43], a[224:227], v[64:79]
    v_accvgpr_write_b32 a56, 0
    v_accvgpr_write_b32 a57, 0
    v_accvgpr_write_b32 a58, 0
    v_mfma_f32_32x32x16_bf16 v[80:95], v[40:43], a[228:231], v[80:95]
    ds_read_b64_tr_b16 v[40:41], v60 offset:53248
    ds_read_b64_tr_b16 v[42:43], v60 offset:54272
    v_accvgpr_write_b32 a59, 0
    s_waitcnt lgkmcnt(6)
    v_mfma_f32_32x32x16_bf16 v[96:111], v[44:47], a[224:227], v[96:111]
    v_accvgpr_write_b32 a60, 0
    v_accvgpr_write_b32 a61, 0
    v_accvgpr_write_b32 a62, 0
    s_add_u32 m0, s50, 4096
    v_mfma_f32_32x32x16_bf16 v[112:127], v[44:47], a[228:231], v[112:127]
    ds_read_b64_tr_b16 v[44:45], v61 offset:53248
    ds_read_b64_tr_b16 v[46:47], v61 offset:54272
    v_accvgpr_write_b32 a63, 0
    buffer_load_dwordx4 v11, s[24:27], s49 offen sc1 lds
    s_waitcnt lgkmcnt(6)
    v_mfma_f32_32x32x16_bf16 v[192:207], v[48:51], a[224:227], v[192:207]
    v_accvgpr_write_b32 a64, 0
    v_accvgpr_write_b32 a65, 0
    v_accvgpr_write_b32 a66, 0
    buffer_load_dwordx4 v11, s[24:27], s49 offen offset:1024 sc1 lds
    v_mfma_f32_32x32x16_bf16 v[208:223], v[48:51], a[228:231], v[208:223]
    ds_read_b64_tr_b16 v[48:49], v62 offset:53248
    ds_read_b64_tr_b16 v[50:51], v62 offset:54272
    v_accvgpr_write_b32 a67, 0
    s_waitcnt lgkmcnt(6)
    v_mfma_f32_32x32x16_bf16 v[224:239], v[52:55], a[224:227], v[224:239]
    v_accvgpr_write_b32 a68, 0
    v_accvgpr_write_b32 a69, 0
    v_accvgpr_write_b32 a70, 0
    buffer_load_dwordx4 v11, s[24:27], s49 offen offset:2048 sc1 lds
    v_mfma_f32_32x32x16_bf16 v[240:255], v[52:55], a[228:231], v[240:255]
    ds_read_b64_tr_b16 v[52:53], v63 offset:53248
    ds_read_b64_tr_b16 v[54:55], v63 offset:54272
    v_accvgpr_write_b32 a71, 0
    buffer_load_dwordx4 v11, s[24:27], s49 offen offset:3072 sc1 lds
    s_waitcnt lgkmcnt(6)
    v_mfma_f32_32x32x16_bf16 v[64:79], v[40:43], a[232:235], v[64:79]
    v_accvgpr_write_b32 a72, 0
    v_accvgpr_write_b32 a73, 0
    v_accvgpr_write_b32 a74, 0
    v_mfma_f32_32x32x16_bf16 v[80:95], v[40:43], a[236:239], v[80:95]
    ds_read_b64_tr_b16 v[40:41], v60 offset:57344
    ds_read_b64_tr_b16 v[42:43], v60 offset:58368
    v_accvgpr_write_b32 a75, 0
    s_waitcnt lgkmcnt(6)
    v_mfma_f32_32x32x16_bf16 v[96:111], v[44:47], a[232:235], v[96:111]
    v_accvgpr_write_b32 a76, 0
    v_accvgpr_write_b32 a77, 0
    v_accvgpr_write_b32 a78, 0
    s_add_u32 s49, s49, 32768
    s_add_u32 s50, s50, 32768
    s_and_b32 s50, s50, 0x1ffff
    v_mfma_f32_32x32x16_bf16 v[112:127], v[44:47], a[236:239], v[112:127]
    ds_read_b64_tr_b16 v[44:45], v61 offset:57344
    ds_read_b64_tr_b16 v[46:47], v61 offset:58368
    v_accvgpr_write_b32 a79, 0
    s_mov_b32 m0, s50
    s_waitcnt lgkmcnt(6)
    v_mfma_f32_32x32x16_bf16 v[192:207], v[48:51], a[232:235], v[192:207]
    v_accvgpr_write_b32 a80, 0
    v_accvgpr_write_b32 a81, 0
    v_accvgpr_write_b32 a82, 0
    buffer_load_dwordx4 v10, s[24:27], s49 offen sc1 lds
    v_mfma_f32_32x32x16_bf16 v[208:223], v[48:51], a[236:239], v[208:223]
    ds_read_b64_tr_b16 v[48:49], v62 offset:57344
    ds_read_b64_tr_b16 v[50:51], v62 offset:58368
    v_accvgpr_write_b32 a83, 0
    s_waitcnt lgkmcnt(6)
    v_mfma_f32_32x32x16_bf16 v[224:239], v[52:55], a[232:235], v[224:239]
    v_accvgpr_write_b32 a84, 0
    v_accvgpr_write_b32 a85, 0
    v_accvgpr_write_b32 a86, 0
    buffer_load_dwordx4 v10, s[24:27], s49 offen offset:1024 sc1 lds
    v_mfma_f32_32x32x16_bf16 v[240:255], v[52:55], a[236:239], v[240:255]
    ds_read_b64_tr_b16 v[52:53], v63 offset:57344
    ds_read_b64_tr_b16 v[54:55], v63 offset:58368
    v_accvgpr_write_b32 a87, 0
    buffer_load_dwordx4 v10, s[24:27], s49 offen offset:2048 sc1 lds
    s_waitcnt lgkmcnt(6)
    v_mfma_f32_32x32x16_bf16 v[64:79], v[40:43], a[240:243], v[64:79]
    v_accvgpr_write_b32 a88, 0
    v_accvgpr_write_b32 a89, 0
    v_accvgpr_write_b32 a90, 0
    v_mfma_f32_32x32x16_bf16 v[80:95], v[40:43], a[244:247], v[80:95]
    ds_read_b64_tr_b16 v[40:41], v60 offset:61440
    ds_read_b64_tr_b16 v[42:43], v60 offset:62464
    v_accvgpr_write_b32 a91, 0
    s_waitcnt lgkmcnt(6)
    v_mfma_f32_32x32x16_bf16 v[96:111], v[44:47], a[240:243], v[96:111]
    v_accvgpr_write_b32 a92, 0
    v_accvgpr_write_b32 a93, 0
    v_accvgpr_write_b32 a94, 0
    buffer_load_dwordx4 v10, s[24:27], s49 offen offset:3072 sc1 lds
    v_mfma_f32_32x32x16_bf16 v[112:127], v[44:47], a[244:247], v[112:127]
    ds_read_b64_tr_b16 v[44:45], v61 offset:61440
    ds_read_b64_tr_b16 v[46:47], v61 offset:62464
    v_accvgpr_write_b32 a95, 0
    s_add_u32 m0, s50, 4096
    s_waitcnt lgkmcnt(6)
    v_mfma_f32_32x32x16_bf16 v[192:207], v[48:51], a[240:243], v[192:207]
    v_accvgpr_write_b32 a96, 0
    v_accvgpr_write_b32 a97, 0
    v_accvgpr_write_b32 a98, 0
    buffer_load_dwordx4 v11, s[24:27], s49 offen sc1 lds
    v_mfma_f32_32x32x16_bf16 v[208:223], v[48:51], a[244:247], v[208:223]
    ds_read_b64_tr_b16 v[48:49], v62 offset:61440
    ds_read_b64_tr_b16 v[50:51], v62 offset:62464
    v_accvgpr_write_b32 a99, 0
    s_waitcnt lgkmcnt(6)
    v_mfma_f32_32x32x16_bf16 v[224:239], v[52:55], a[240:243], v[224:239]
    v_accvgpr_write_b32 a100, 0
    v_accvgpr_write_b32 a101, 0
    v_accvgpr_write_b32 a102, 0
    buffer_load_dwordx4 v11, s[24:27], s49 offen offset:1024 sc1 lds
    v_mfma_f32_32x32x16_bf16 v[240:255], v[52:55], a[244:247], v[240:255]
    ds_read_b64_tr_b16 v[52:53], v63 offset:61440
    ds_read_b64_tr_b16 v[54:55], v63 offset:62464
    v_accvgpr_write_b32 a103, 0
    buffer_load_dwordx4 v11, s[24:27], s49 offen offset:2048 sc1 lds
    s_waitcnt lgkmcnt(6)
    v_mfma_f32_32x32x16_bf16 v[64:79], v[40:43], a[248:251], v[64:79]
    v_accvgpr_write_b32 a104, 0
    v_accvgpr_write_b32 a105, 0
    v_accvgpr_write_b32 a106, 0
    s_waitcnt lgkmcnt(4)
    v_mfma_f32_32x32x16_bf16 v[96:111], v[44:47], a[248:251], v[96:111]
    v_accvgpr_write_b32 a107, 0
    v_accvgpr_write_b32 a108, 0
    v_accvgpr_write_b32 a109, 0
    v_mfma_f32_32x32x16_bf16 v[80:95], v[40:43], a[252:255], v[80:95]
    v_accvgpr_write_b32 a110, 0
    v_accvgpr_write_b32 a111, 0
    v_accvgpr_write_b32 a112, 0
    buffer_load_dwordx4 v11, s[24:27], s49 offen offset:3072 sc1 lds
    v_mfma_f32_32x32x16_bf16 v[112:127], v[44:47], a[252:255], v[112:127]
    v_accvgpr_write_b32 a113, 0
    v_accvgpr_write_b32 a114, 0
    v_accvgpr_write_b32 a115, 0
    s_add_u32 s49, s49, 32768
    s_add_u32 s50, s50, 32768
    s_and_b32 s50, s50, 0x1ffff
    s_waitcnt lgkmcnt(2)
    v_mfma_f32_32x32x16_bf16 v[192:207], v[48:51], a[248:251], v[192:207]
    v_accvgpr_write_b32 a116, 0
    v_accvgpr_write_b32 a117, 0
    v_accvgpr_write_b32 a118, 0
    v_cvt_pk_bf16_f32 v64, v64, v65
    v_cvt_pk_bf16_f32 v65, v66, v67
    v_cvt_pk_bf16_f32 v66, v68, v69
    v_cvt_pk_bf16_f32 v67, v70, v71
    v_mfma_f32_32x32x16_bf16 v[208:223], v[48:51], a[252:255], v[208:223]
    v_accvgpr_write_b32 a119, 0
    v_accvgpr_write_b32 a120, 0
    v_accvgpr_write_b32 a121, 0
    v_cvt_pk_bf16_f32 v68, v72, v73
    v_cvt_pk_bf16_f32 v69, v74, v75
    v_cvt_pk_bf16_f32 v70, v76, v77
    v_cvt_pk_bf16_f32 v71, v78, v79
    s_waitcnt lgkmcnt(0)
    v_mfma_f32_32x32x16_bf16 v[224:239], v[52:55], a[248:251], v[224:239]
    v_accvgpr_write_b32 a122, 0
    v_accvgpr_write_b32 a123, 0
    v_accvgpr_write_b32 a124, 0
    v_cvt_pk_bf16_f32 v72, v96, v97
    v_cvt_pk_bf16_f32 v73, v98, v99
    v_cvt_pk_bf16_f32 v74, v100, v101
    v_cvt_pk_bf16_f32 v75, v102, v103
    v_mfma_f32_32x32x16_bf16 v[240:255], v[52:55], a[252:255], v[240:255]
    v_accvgpr_write_b32 a125, 0
    v_accvgpr_write_b32 a126, 0
    v_accvgpr_write_b32 a127, 0
    v_cvt_pk_bf16_f32 v76, v104, v105
    v_cvt_pk_bf16_f32 v77, v106, v107
    v_cvt_pk_bf16_f32 v78, v108, v109
    v_cvt_pk_bf16_f32 v79, v110, v111
    s_barrier
    s_mov_b32 m0, s50
    s_nop 0
    buffer_load_dwordx4 v10, s[24:27], s49 offen sc1 lds
    buffer_load_dwordx4 v10, s[24:27], s49 offen offset:1024 sc1 lds
    buffer_load_dwordx4 v10, s[24:27], s49 offen offset:2048 sc1 lds
    buffer_load_dwordx4 v10, s[24:27], s49 offen offset:3072 sc1 lds
    s_add_u32 m0, s50, 4096
    s_nop 0
    buffer_load_dwordx4 v11, s[24:27], s49 offen sc1 lds
    buffer_load_dwordx4 v11, s[24:27], s49 offen offset:1024 sc1 lds
    buffer_load_dwordx4 v11, s[24:27], s49 offen offset:2048 sc1 lds
    buffer_load_dwordx4 v11, s[24:27], s49 offen offset:3072 sc1 lds
    s_add_u32 s49, s49, 32768
    s_add_u32 s50, s50, 32768
    s_and_b32 s50, s50, 0x1ffff
    v_cvt_pk_bf16_f32 v96, v80, v81
    v_cvt_pk_bf16_f32 v97, v82, v83
    v_cvt_pk_bf16_f32 v98, v84, v85
    v_cvt_pk_bf16_f32 v99, v86, v87
    v_cvt_pk_bf16_f32 v100, v88, v89
    v_cvt_pk_bf16_f32 v101, v90, v91
    v_cvt_pk_bf16_f32 v102, v92, v93
    v_cvt_pk_bf16_f32 v103, v94, v95
    v_cvt_pk_bf16_f32 v104, v112, v113
    v_cvt_pk_bf16_f32 v105, v114, v115
    v_cvt_pk_bf16_f32 v106, v116, v117
    v_cvt_pk_bf16_f32 v107, v118, v119
    v_cvt_pk_bf16_f32 v108, v120, v121
    v_cvt_pk_bf16_f32 v109, v122, v123
    v_cvt_pk_bf16_f32 v110, v124, v125
    v_cvt_pk_bf16_f32 v111, v126, v127
    v_cvt_pk_bf16_f32 v80, v192, v193
    v_cvt_pk_bf16_f32 v81, v194, v195
    v_cvt_pk_bf16_f32 v82, v196, v197
    v_cvt_pk_bf16_f32 v83, v198, v199
    v_cvt_pk_bf16_f32 v84, v200, v201
    v_cvt_pk_bf16_f32 v85, v202, v203
    v_cvt_pk_bf16_f32 v86, v204, v205
    v_cvt_pk_bf16_f32 v87, v206, v207
    v_cvt_pk_bf16_f32 v112, v208, v209
    v_cvt_pk_bf16_f32 v113, v210, v211
    v_cvt_pk_bf16_f32 v114, v212, v213
    v_cvt_pk_bf16_f32 v115, v214, v215
    v_cvt_pk_bf16_f32 v116, v216, v217
    v_cvt_pk_bf16_f32 v117, v218, v219
    v_cvt_pk_bf16_f32 v118, v220, v221
    v_cvt_pk_bf16_f32 v119, v222, v223
    v_cvt_pk_bf16_f32 v88, v224, v225
    v_cvt_pk_bf16_f32 v89, v226, v227
    v_cvt_pk_bf16_f32 v90, v228, v229
    v_cvt_pk_bf16_f32 v91, v230, v231
    v_cvt_pk_bf16_f32 v92, v232, v233
    v_cvt_pk_bf16_f32 v93, v234, v235
    v_cvt_pk_bf16_f32 v94, v236, v237
    v_cvt_pk_bf16_f32 v95, v238, v239
    v_cvt_pk_bf16_f32 v120, v240, v241
    v_cvt_pk_bf16_f32 v121, v242, v243
    v_cvt_pk_bf16_f32 v122, v244, v245
    v_cvt_pk_bf16_f32 v123, v246, v247
    v_cvt_pk_bf16_f32 v124, v248, v249
    v_cvt_pk_bf16_f32 v125, v250, v251
    v_cvt_pk_bf16_f32 v126, v252, v253
    v_cvt_pk_bf16_f32 v127, v254, v255
    v_mov_b32 v231, 0xff800000
    v_and_b32 v3, 31, v2
    v_lshrrev_b32 v4, 5, v2
    v_lshlrev_b32 v4, 2, v4
    s_lshl_b32 s64, s46, 5
    v_add_u32 v3, s64, v3
    v_sub_u32 v229, v3, v4
    v_mov_b32 v230, v229
    v_mov_b32 v224, 0
    v_mov_b32 v225, 0
    s_load_dwordx2 s[72:73], s[0:1], 40
    s_load_dwordx2 s[74:75], s[0:1], 72
    s_load_dwordx2 s[76:77], s[0:1], 56
    v_lshrrev_b32 v1, 6, v0
    v_and_b32 v4, 63, v0
    v_lshlrev_b32 v4, 4, v4
    v_lshl_add_u32 v4, v1, 10, v4
    s_waitcnt lgkmcnt(0)
    s_mov_b32 s8, s72
    s_mov_b32 s9, s73
    s_mov_b32 s10, 4194304
    s_mov_b32 s11, 0x20000
    s_lshl_b32 s69, s2, 14
    buffer_load_dwordx4 v[16:19], v4, s[8:11], s69 offen
    s_add_u32 s69, s69, 4096
    buffer_load_dwordx4 v[20:23], v4, s[8:11], s69 offen
    s_add_u32 s69, s69, 4096
    buffer_load_dwordx4 v[24:27], v4, s[8:11], s69 offen
    s_add_u32 s69, s69, 4096
    buffer_load_dwordx4 v[28:31], v4, s[8:11], s69 offen
    s_add_u32 s69, s69, 4096
    s_mov_b32 s8, s74
    s_mov_b32 s9, s75
    s_mov_b32 s10, 1835008
    s_mov_b32 s11, 0x20000
    s_mul_i32 s69, s2, 7168
    buffer_load_dwordx4 v[32:35], v4, s[8:11], s69 offen
    s_add_u32 s69, s69, 4096
    buffer_load_dwordx4 v[36:39], v4, s[8:11], s69 offen
    s_mov_b32 s8, s76
    s_mov_b32 s9, s77
    s_mov_b32 s10, 1835008
    s_mov_b32 s11, 0x20000
    s_mul_i32 s69, s2, 7168
    v_lshlrev_b32 v4, 4, v0
    buffer_load_dwordx4 v[40:43], v4, s[8:11], s69 offen
    s_add_u32 s69, s69, 4096
    buffer_load_dwordx4 v[44:47], v4, s[8:11], s69 offen
    s_waitcnt vmcnt(24)
    s_barrier
    ds_read_b128 a[128:131], v8
    ds_read_b128 a[132:135], v8 offset:1024
    ds_read_b128 a[136:139], v8 offset:2048
    ds_read_b128 a[140:143], v8 offset:3072
    ds_read_b128 a[144:147], v8 offset:4096
    ds_read_b128 a[148:151], v8 offset:5120
    ds_read_b128 a[152:155], v8 offset:6144
    ds_read_b128 a[156:159], v8 offset:7168
    ds_read_b128 a[160:163], v8 offset:8192
    ds_read_b128 a[168:171], v8 offset:10240
    ds_read_b128 a[176:179], v8 offset:12288
    ds_read_b128 a[184:187], v8 offset:14336
    ds_read_b128 a[164:167], v8 offset:9216
    ds_read_b128 a[172:175], v8 offset:11264
    ds_read_b128 a[180:183], v8 offset:13312
    ds_read_b128 a[188:191], v8 offset:15360
KA_FIRST:
    s_cmp_eq_u32 s48, 0
    s_cselect_b32 s64, 32, 0
    v_subrev_u32 v230, s64, v230
    s_waitcnt lgkmcnt(15)
    v_mfma_f32_32x32x16_bf16 v[128:143], a[128:131], v[64:67], 0
    s_waitcnt lgkmcnt(14)
    v_mfma_f32_32x32x16_bf16 v[128:143], a[132:135], v[68:71], v[128:143]
    s_waitcnt lgkmcnt(13)
    v_mfma_f32_32x32x16_bf16 v[128:143], a[136:139], v[72:75], v[128:143]
    s_waitcnt lgkmcnt(12)
    v_mfma_f32_32x32x16_bf16 v[128:143], a[140:143], v[76:79], v[128:143]
    s_waitcnt lgkmcnt(11)
    v_mfma_f32_32x32x16_bf16 v[128:143], a[144:147], v[80:83], v[128:143]
    s_waitcnt lgkmcnt(10)
    v_mfma_f32_32x32x16_bf16 v[128:143], a[148:151], v[84:87], v[128:143]
    s_waitcnt lgkmcnt(9)
    v_mfma_f32_32x32x16_bf16 v[128:143], a[152:155], v[88:91], v[128:143]
    s_waitcnt lgkmcnt(8)
    v_mfma_f32_32x32x16_bf16 v[128:143], a[156:159], v[92:95], v[128:143]
    v_mfma_f32_32x32x16_bf16 v[144:159], a[128:131], v[96:99], v[176:191]
    ds_read_b128 a[128:131], v8 offset:16384
    v_mfma_f32_32x32x16_bf16 v[144:159], a[132:135], v[100:103], v[144:159]
    ds_read_b128 a[132:135], v8 offset:17408
    v_mfma_f32_32x32x16_bf16 v[144:159], a[136:139], v[104:107], v[144:159]
    ds_read_b128 a[136:139], v8 offset:18432
    s_nop 5
    v_max3_f32 v234, v128, v129, v130
    v_max3_f32 v234, v234, v131, v132
    v_max3_f32 v234, v234, v133, v134
    v_max3_f32 v234, v234, v135, v136
    v_mfma_f32_32x32x16_bf16 v[144:159], a[140:143], v[108:111], v[144:159]
    ds_read_b128 a[140:143], v8 offset:19456
    v_max3_f32 v234, v234, v137, v138
    v_max3_f32 v234, v234, v139, v140
    v_max3_f32 v234, v234, v141, v142
    v_max_f32 v234, v234, v143
    v_mov_b32 v235, v234
    v_mfma_f32_32x32x16_bf16 v[144:159], a[144:147], v[112:115], v[144:159]
    ds_read_b128 a[144:147], v8 offset:20480
    s_nop 1
    v_permlane32_swap_b32 v234, v235
    s_nop 1
    v_max_f32 v234, v234, v235
    v_mfma_f32_32x32x16_bf16 v[144:159], a[148:151], v[116:119], v[144:159]
    ds_read_b128 a[148:151], v8 offset:21504
    v_sub_f32 v227, 0, v234
    v_add_f32 v128, v128, v227
    v_add_f32 v129, v129, v227
    v_add_f32 v130, v130, v227
    v_add_f32 v131, v131, v227
    v_add_f32 v132, v132, v227
    v_add_f32 v133, v133, v227
    v_mfma_f32_32x32x16_bf16 v[144:159], a[152:155], v[120:123], v[144:159]
    ds_read_b128 a[152:155], v8 offset:22528
    v_add_f32 v134, v134, v227
    v_add_f32 v135, v135, v227
    v_add_f32 v136, v136, v227
    v_add_f32 v137, v137, v227
    v_add_f32 v138, v138, v227
    v_add_f32 v139, v139, v227
    v_mfma_f32_32x32x16_bf16 v[144:159], a[156:159], v[124:127], v[144:159]
    ds_read_b128 a[156:159], v8 offset:23552
    v_add_f32 v140, v140, v227
    v_add_f32 v141, v141, v227
    v_add_f32 v142, v142, v227
    v_add_f32 v143, v143, v227
    v_mov_b32 v236, v227
    v_mov_b32 v237, v227
    v_pk_mov_b32 v[160:161], v[236:237], v[236:237]
    v_pk_mov_b32 v[162:163], v[236:237], v[236:237]
    v_pk_mov_b32 v[164:165], v[236:237], v[236:237]
    v_pk_mov_b32 v[166:167], v[236:237], v[236:237]
    v_pk_mov_b32 v[168:169], v[236:237], v[236:237]
    v_pk_mov_b32 v[170:171], v[236:237], v[236:237]
    v_pk_mov_b32 v[172:173], v[236:237], v[236:237]
    v_pk_mov_b32 v[174:175], v[236:237], v[236:237]
    v_exp_f32 v208, v128
    v_exp_f32 v209, v129
    v_exp_f32 v210, v130
    v_add_f32 v226, v208, v209
    v_cvt_pk_bf16_f32 v192, v208, v209
    v_exp_f32 v211, v131
    v_add_f32 v226, v226, v210
    v_exp_f32 v212, v132
    v_add_f32 v226, v226, v211
    v_cvt_pk_bf16_f32 v193, v210, v211
    v_exp_f32 v213, v133
    v_add_f32 v226, v226, v212
    v_exp_f32 v214, v134
    v_add_f32 v226, v226, v213
    v_cvt_pk_bf16_f32 v194, v212, v213
    v_exp_f32 v215, v135
    v_add_f32 v226, v226, v214
    v_exp_f32 v216, v136
    v_add_f32 v226, v226, v215
    v_cvt_pk_bf16_f32 v195, v214, v215
    v_exp_f32 v217, v137
    v_add_f32 v226, v226, v216
    v_exp_f32 v218, v138
    v_add_f32 v226, v226, v217
    v_exp_f32 v219, v139
    v_add_f32 v226, v226, v218
    v_exp_f32 v220, v140
    v_add_f32 v226, v226, v219
    v_exp_f32 v221, v141
    v_add_f32 v226, v226, v220
    v_exp_f32 v222, v142
    v_add_f32 v226, v226, v221
    v_exp_f32 v223, v143
    v_add_f32 v226, v226, v222
    v_add_f32 v226, v226, v223
    v_add_f32 v224, v224, v226
    v_max3_f32 v234, v144, v145, v146
    v_max3_f32 v234, v234, v147, v148
    v_max3_f32 v234, v234, v149, v150
    v_max3_f32 v234, v234, v151, v152
    v_max3_f32 v234, v234, v153, v154
    v_max3_f32 v234, v234, v155, v156
    v_max3_f32 v234, v234, v157, v158
    v_max_f32 v234, v234, v159
    v_mov_b32 v235, v234
    s_nop 1
    v_permlane32_swap_b32 v234, v235
    s_nop 1
    v_max_f32 v234, v234, v235
    v_sub_f32 v228, 0, v234
    v_mov_b32 v236, v228
    v_mov_b32 v237, v228
    v_pk_add_f32 v[144:145], v[144:145], v[236:237]
    v_pk_add_f32 v[146:147], v[146:147], v[236:237]
    v_pk_add_f32 v[148:149], v[148:149], v[236:237]
    v_pk_add_f32 v[150:151], v[150:151], v[236:237]
    v_pk_add_f32 v[152:153], v[152:153], v[236:237]
    v_pk_add_f32 v[154:155], v[154:155], v[236:237]
    v_pk_add_f32 v[156:157], v[156:157], v[236:237]
    v_pk_add_f32 v[158:159], v[158:159], v[236:237]
    v_pk_mov_b32 v[176:177], v[236:237], v[236:237]
    v_pk_mov_b32 v[178:179], v[236:237], v[236:237]
    v_pk_mov_b32 v[180:181], v[236:237], v[236:237]
    v_pk_mov_b32 v[182:183], v[236:237], v[236:237]
    v_pk_mov_b32 v[184:185], v[236:237], v[236:237]
    v_pk_mov_b32 v[186:187], v[236:237], v[236:237]
    v_pk_mov_b32 v[188:189], v[236:237], v[236:237]
    v_pk_mov_b32 v[190:191], v[236:237], v[236:237]
    s_waitcnt lgkmcnt(15)
    v_mfma_f32_32x32x16_bf16 a[0:15], a[160:163], v[192:195], a[0:15]
    v_cvt_pk_bf16_f32 v196, v216, v217
    v_cvt_pk_bf16_f32 v197, v218, v219
    v_cvt_pk_bf16_f32 v198, v220, v221
    v_cvt_pk_bf16_f32 v199, v222, v223
    s_waitcnt lgkmcnt(14)
    v_mfma_f32_32x32x16_bf16 a[16:31], a[168:171], v[192:195], a[16:31]
    v_exp_f32 v208, v144
    v_exp_f32 v209, v145
    s_waitcnt lgkmcnt(13)
    v_mfma_f32_32x32x16_bf16 a[32:47], a[176:179], v[192:195], a[32:47]
    v_exp_f32 v210, v146
    v_add_f32 v226, v208, v209
    s_waitcnt lgkmcnt(12)
    v_mfma_f32_32x32x16_bf16 a[48:63], a[184:187], v[192:195], a[48:63]
    v_cvt_pk_bf16_f32 v200, v208, v209
    v_exp_f32 v211, v147
    s_waitcnt lgkmcnt(11)
    v_mfma_f32_32x32x16_bf16 a[0:15], a[164:167], v[196:199], a[0:15]
    v_add_f32 v226, v226, v210
    v_exp_f32 v212, v148
    s_waitcnt lgkmcnt(10)
    v_mfma_f32_32x32x16_bf16 a[16:31], a[172:175], v[196:199], a[16:31]
    v_add_f32 v226, v226, v211
    v_cvt_pk_bf16_f32 v201, v210, v211
    v_exp_f32 v213, v149
    s_waitcnt lgkmcnt(9)
    v_mfma_f32_32x32x16_bf16 a[32:47], a[180:183], v[196:199], a[32:47]
    v_add_f32 v226, v226, v212
    v_exp_f32 v214, v150
    v_add_f32 v226, v226, v213
    s_waitcnt lgkmcnt(8)
    v_mfma_f32_32x32x16_bf16 a[48:63], a[188:191], v[196:199], a[48:63]
    v_cvt_pk_bf16_f32 v202, v212, v213
    v_exp_f32 v215, v151
    v_add_f32 v226, v226, v214
    s_mov_b32 s51, 1
    s_cmp_eq_u32 s48, 0
    s_cbranch_scc1 KA_DO_M
    s_lshl_b32 s51, s48, 1
    s_sub_u32 s51, s51, 1
    s_branch KA_DO_U
KA_DE_U:
    v_mfma_f32_32x32x16_bf16 v[128:143], a[128:131], v[64:67], v[160:175]
    s_add_u32 m0, s50, 4096
    v_exp_f32 v216, v152
    v_add_f32 v226, v226, v215
    v_mfma_f32_32x32x16_bf16 v[128:143], a[132:135], v[68:71], v[128:143]
    buffer_load_dwordx4 v11, s[24:27], s49 offen sc1 lds
    v_cvt_pk_bf16_f32 v203, v214, v215
    v_exp_f32 v217, v153
    v_mfma_f32_32x32x16_bf16 v[128:143], a[136:139], v[72:75], v[128:143]
    v_add_f32 v226, v226, v216
    v_exp_f32 v218, v154
    v_add_f32 v226, v226, v217
    v_mfma_f32_32x32x16_bf16 v[128:143], a[140:143], v[76:79], v[128:143]
    buffer_load_dwordx4 v11, s[24:27], s49 offen offset:1024 sc1 lds
    v_exp_f32 v219, v155
    v_add_f32 v226, v226, v218
    v_mfma_f32_32x32x16_bf16 v[128:143], a[144:147], v[80:83], v[128:143]
    v_exp_f32 v220, v156
    v_add_f32 v226, v226, v219
    v_exp_f32 v221, v157
    v_mfma_f32_32x32x16_bf16 v[128:143], a[148:151], v[84:87], v[128:143]
    buffer_load_dwordx4 v11, s[24:27], s49 offen offset:2048 sc1 lds
    v_add_f32 v226, v226, v220
    v_exp_f32 v222, v158
    v_add_f32 v226, v226, v221
    v_mfma_f32_32x32x16_bf16 v[128:143], a[152:155], v[88:91], v[128:143]
    v_exp_f32 v223, v159
    v_add_f32 v226, v226, v222
    v_add_f32 v226, v226, v223
    v_cmp_lt_f32 vcc, s53, v226
    v_mfma_f32_32x32x16_bf16 v[128:143], a[156:159], v[92:95], v[128:143]
    buffer_load_dwordx4 v11, s[24:27], s49 offen offset:3072 sc1 lds
    s_cbranch_vccnz KA_STUB1
KA_RET1:
    v_mfma_f32_32x32x16_bf16 a[64:79], a[160:163], v[200:203], a[64:79]
    ds_read_b128 a[160:163], v8 offset:8192
    v_add_f32 v225, v225, v226
    v_cvt_pk_bf16_f32 v204, v216, v217
    v_cvt_pk_bf16_f32 v205, v218, v219
    v_mfma_f32_32x32x16_bf16 a[80:95], a[168:171], v[200:203], a[80:95]
    ds_read_b128 a[168:171], v8 offset:10240
    v_cvt_pk_bf16_f32 v206, v220, v221
    v_cvt_pk_bf16_f32 v207, v222, v223
    s_nop 0
    v_exp_f32 v208, v128
    v_mfma_f32_32x32x16_bf16 a[96:111], a[176:179], v[200:203], a[96:111]
    ds_read_b128 a[176:179], v8 offset:12288
    s_add_u32 s49, s49, 32768
    v_exp_f32 v209, v129
    v_mfma_f32_32x32x16_bf16 a[112:127], a[184:187], v[200:203], a[112:127]
    ds_read_b128 a[184:187], v8 offset:14336
    s_add_u32 s50, s50, 32768
    v_exp_f32 v210, v130
    v_add_f32 v226, v208, v209
    v_mfma_f32_32x32x16_bf16 a[64:79], a[164:167], v[204:207], a[64:79]
    ds_read_b128 a[164:167], v8 offset:9216
    s_and_b32 s50, s50, 0x1ffff
    v_cvt_pk_bf16_f32 v192, v208, v209
    v_exp_f32 v211, v131
    v_mfma_f32_32x32x16_bf16 a[80:95], a[172:175], v[204:207], a[80:95]
    ds_read_b128 a[172:175], v8 offset:11264
    v_add_f32 v226, v226, v210
    v_exp_f32 v212, v132
    v_mfma_f32_32x32x16_bf16 a[96:111], a[180:183], v[204:207], a[96:111]
    ds_read_b128 a[180:183], v8 offset:13312
    v_add_f32 v226, v226, v211
    v_cvt_pk_bf16_f32 v193, v210, v211
    v_exp_f32 v213, v133
    v_mfma_f32_32x32x16_bf16 a[112:127], a[188:191], v[204:207], a[112:127]
    ds_read_b128 a[188:191], v8 offset:15360
    v_add_f32 v226, v226, v212
    v_exp_f32 v214, v134
    v_add_f32 v226, v226, v213
    v_mfma_f32_32x32x16_bf16 v[144:159], a[128:131], v[96:99], v[176:191]
    ds_read_b128 a[128:131], v8 offset:16384
    v_cvt_pk_bf16_f32 v194, v212, v213
    v_exp_f32 v215, v135
    v_add_f32 v226, v226, v214
    v_mfma_f32_32x32x16_bf16 v[144:159], a[132:135], v[100:103], v[144:159]
    ds_read_b128 a[132:135], v8 offset:17408
    v_exp_f32 v216, v136
    v_add_f32 v226, v226, v215
    v_cvt_pk_bf16_f32 v195, v214, v215
    v_mfma_f32_32x32x16_bf16 v[144:159], a[136:139], v[104:107], v[144:159]
    ds_read_b128 a[136:139], v8 offset:18432
    v_exp_f32 v217, v137
    v_add_f32 v226, v226, v216
    v_exp_f32 v218, v138
    v_mfma_f32_32x32x16_bf16 v[144:159], a[140:143], v[108:111], v[144:159]
    ds_read_b128 a[140:143], v8 offset:19456
    v_add_f32 v226, v226, v217
    v_exp_f32 v219, v139
    v_add_f32 v226, v226, v218
    v_mfma_f32_32x32x16_bf16 v[144:159], a[144:147], v[112:115], v[144:159]
    ds_read_b128 a[144:147], v8 offset:20480
    v_exp_f32 v220, v140
    v_add_f32 v226, v226, v219
    v_exp_f32 v221, v141
    v_mfma_f32_32x32x16_bf16 v[144:159], a[148:151], v[116:119], v[144:159]
    ds_read_b128 a[148:151], v8 offset:21504
    v_add_f32 v226, v226, v220
    v_exp_f32 v222, v142
    v_add_f32 v226, v226, v221
    v_mfma_f32_32x32x16_bf16 v[144:159], a[152:155], v[120:123], v[144:159]
    ds_read_b128 a[152:155], v8 offset:22528
    v_exp_f32 v223, v143
    v_add_f32 v226, v226, v222
    v_add_f32 v226, v226, v223
    v_cmp_lt_f32 vcc, s53, v226
    v_mfma_f32_32x32x16_bf16 v[144:159], a[156:159], v[124:127], v[144:159]
    ds_read_b128 a[156:159], v8 offset:23552
    s_cbranch_vccnz KA_STUB2
KA_RET2:
    s_waitcnt lgkmcnt(8)
    v_mfma_f32_32x32x16_bf16 a[0:15], a[160:163], v[192:195], a[0:15]
    v_add_f32 v224, v224, v226
    v_cvt_pk_bf16_f32 v196, v216, v217
    v_cvt_pk_bf16_f32 v197, v218, v219
    v_mfma_f32_32x32x16_bf16 a[16:31], a[168:171], v[192:195], a[16:31]
    v_cvt_pk_bf16_f32 v198, v220, v221
    v_cvt_pk_bf16_f32 v199, v222, v223
    s_nop 1
    v_exp_f32 v208, v144
    v_mfma_f32_32x32x16_bf16 a[32:47], a[176:179], v[192:195], a[32:47]
    v_exp_f32 v209, v145
    v_exp_f32 v210, v146
    v_mfma_f32_32x32x16_bf16 a[48:63], a[184:187], v[192:195], a[48:63]
    v_add_f32 v226, v208, v209
    v_cvt_pk_bf16_f32 v200, v208, v209
    v_exp_f32 v211, v147
    v_mfma_f32_32x32x16_bf16 a[0:15], a[164:167], v[196:199], a[0:15]
    v_add_f32 v226, v226, v210
    v_exp_f32 v212, v148
    v_add_f32 v226, v226, v211
    v_mfma_f32_32x32x16_bf16 a[16:31], a[172:175], v[196:199], a[16:31]
    v_cvt_pk_bf16_f32 v201, v210, v211
    v_exp_f32 v213, v149
    v_add_f32 v226, v226, v212
    v_mfma_f32_32x32x16_bf16 a[32:47], a[180:183], v[196:199], a[32:47]
    v_exp_f32 v214, v150
    v_add_f32 v226, v226, v213
    v_cvt_pk_bf16_f32 v202, v212, v213
    v_mfma_f32_32x32x16_bf16 a[48:63], a[188:191], v[196:199], a[48:63]
    v_exp_f32 v215, v151
    v_add_f32 v226, v226, v214
    s_waitcnt lgkmcnt(0)
KA_DO_U:
    s_waitcnt lgkmcnt(7)
    v_mfma_f32_32x32x16_bf16 v[128:143], a[128:131], v[64:67], v[160:175]
    v_exp_f32 v216, v152
    v_add_f32 v226, v226, v215
    s_waitcnt lgkmcnt(6)
    v_mfma_f32_32x32x16_bf16 v[128:143], a[132:135], v[68:71], v[128:143]
    v_cvt_pk_bf16_f32 v203, v214, v215
    v_exp_f32 v217, v153
    s_waitcnt lgkmcnt(5)
    v_mfma_f32_32x32x16_bf16 v[128:143], a[136:139], v[72:75], v[128:143]
    v_add_f32 v226, v226, v216
    v_exp_f32 v218, v154
    s_waitcnt lgkmcnt(4)
    v_mfma_f32_32x32x16_bf16 v[128:143], a[140:143], v[76:79], v[128:143]
    v_add_f32 v226, v226, v217
    v_exp_f32 v219, v155
    v_add_f32 v226, v226, v218
    s_waitcnt lgkmcnt(3)
    v_mfma_f32_32x32x16_bf16 v[128:143], a[144:147], v[80:83], v[128:143]
    v_exp_f32 v220, v156
    v_add_f32 v226, v226, v219
    v_exp_f32 v221, v157
    s_waitcnt lgkmcnt(2)
    v_mfma_f32_32x32x16_bf16 v[128:143], a[148:151], v[84:87], v[128:143]
    v_add_f32 v226, v226, v220
    v_exp_f32 v222, v158
    v_add_f32 v226, v226, v221
    s_waitcnt lgkmcnt(1)
    v_mfma_f32_32x32x16_bf16 v[128:143], a[152:155], v[88:91], v[128:143]
    v_exp_f32 v223, v159
    v_add_f32 v226, v226, v222
    v_add_f32 v226, v226, v223
    v_cmp_lt_f32 vcc, s53, v226
    s_waitcnt lgkmcnt(0)
    v_mfma_f32_32x32x16_bf16 v[128:143], a[156:159], v[92:95], v[128:143]
    s_cbranch_vccnz KA_STUB3
KA_RET3:
    v_mfma_f32_32x32x16_bf16 a[64:79], a[160:163], v[200:203], a[64:79]
    ds_read_b128 a[160:163], v8 offset:24576
    v_add_f32 v225, v225, v226
    v_cvt_pk_bf16_f32 v204, v216, v217
    v_cvt_pk_bf16_f32 v205, v218, v219
    v_mfma_f32_32x32x16_bf16 a[80:95], a[168:171], v[200:203], a[80:95]
    ds_read_b128 a[168:171], v8 offset:26624
    v_cvt_pk_bf16_f32 v206, v220, v221
    v_cvt_pk_bf16_f32 v207, v222, v223
    s_nop 1
    v_exp_f32 v208, v128
    v_mfma_f32_32x32x16_bf16 a[96:111], a[176:179], v[200:203], a[96:111]
    ds_read_b128 a[176:179], v8 offset:28672
    v_exp_f32 v209, v129
    v_exp_f32 v210, v130
    v_mfma_f32_32x32x16_bf16 a[112:127], a[184:187], v[200:203], a[112:127]
    ds_read_b128 a[184:187], v8 offset:30720
    v_add_f32 v226, v208, v209
    v_cvt_pk_bf16_f32 v192, v208, v209
    v_exp_f32 v211, v131
    v_mfma_f32_32x32x16_bf16 a[64:79], a[164:167], v[204:207], a[64:79]
    ds_read_b128 a[164:167], v8 offset:25600
    v_add_f32 v226, v226, v210
    v_exp_f32 v212, v132
    v_add_f32 v226, v226, v211
    v_mfma_f32_32x32x16_bf16 a[80:95], a[172:175], v[204:207], a[80:95]
    ds_read_b128 a[172:175], v8 offset:27648
    v_cvt_pk_bf16_f32 v193, v210, v211
    v_exp_f32 v213, v133
    v_add_f32 v226, v226, v212
    v_mfma_f32_32x32x16_bf16 a[96:111], a[180:183], v[204:207], a[96:111]
    ds_read_b128 a[180:183], v8 offset:29696
    v_exp_f32 v214, v134
    v_add_f32 v226, v226, v213
    v_cvt_pk_bf16_f32 v194, v212, v213
    v_mfma_f32_32x32x16_bf16 a[112:127], a[188:191], v[204:207], a[112:127]
    ds_read_b128 a[188:191], v8 offset:31744
    s_waitcnt vmcnt(8)
    s_barrier
    v_exp_f32 v215, v135
    v_mfma_f32_32x32x16_bf16 v[144:159], a[128:131], v[96:99], v[176:191]
    ds_read_b128 a[128:131], v9
    s_mov_b32 m0, s50
    v_add_f32 v226, v226, v214
    v_exp_f32 v216, v136
    v_mfma_f32_32x32x16_bf16 v[144:159], a[132:135], v[100:103], v[144:159]
    ds_read_b128 a[132:135], v9 offset:1024
    buffer_load_dwordx4 v10, s[24:27], s49 offen sc1 lds
    v_add_f32 v226, v226, v215
    v_cvt_pk_bf16_f32 v195, v214, v215
    v_exp_f32 v217, v137
    v_mfma_f32_32x32x16_bf16 v[144:159], a[136:139], v[104:107], v[144:159]
    ds_read_b128 a[136:139], v9 offset:2048
    v_add_f32 v226, v226, v216
    v_exp_f32 v218, v138
    v_add_f32 v226, v226, v217
    v_mfma_f32_32x32x16_bf16 v[144:159], a[140:143], v[108:111], v[144:159]
    ds_read_b128 a[140:143], v9 offset:3072
    buffer_load_dwordx4 v10, s[24:27], s49 offen offset:1024 sc1 lds
    v_exp_f32 v219, v139
    v_add_f32 v226, v226, v218
    v_mfma_f32_32x32x16_bf16 v[144:159], a[144:147], v[112:115], v[144:159]
    ds_read_b128 a[144:147], v9 offset:4096
    v_exp_f32 v220, v140
    v_add_f32 v226, v226, v219
    v_exp_f32 v221, v141
    v_mfma_f32_32x32x16_bf16 v[144:159], a[148:151], v[116:119], v[144:159]
    ds_read_b128 a[148:151], v9 offset:5120
    buffer_load_dwordx4 v10, s[24:27], s49 offen offset:2048 sc1 lds
    v_add_f32 v226, v226, v220
    v_exp_f32 v222, v142
    v_add_f32 v226, v226, v221
    v_mfma_f32_32x32x16_bf16 v[144:159], a[152:155], v[120:123], v[144:159]
    ds_read_b128 a[152:155], v9 offset:6144
    v_exp_f32 v223, v143
    v_add_f32 v226, v226, v222
    v_add_f32 v226, v226, v223
    v_cmp_lt_f32 vcc, s53, v226
    v_mfma_f32_32x32x16_bf16 v[144:159], a[156:159], v[124:127], v[144:159]
    ds_read_b128 a[156:159], v9 offset:7168
    buffer_load_dwordx4 v10, s[24:27], s49 offen offset:3072 sc1 lds
    s_cbranch_vccnz KA_STUB4
KA_RET4:
    s_waitcnt lgkmcnt(8)
    v_mfma_f32_32x32x16_bf16 a[0:15], a[160:163], v[192:195], a[0:15]
    v_add_f32 v224, v224, v226
    v_cvt_pk_bf16_f32 v196, v216, v217
    v_cvt_pk_bf16_f32 v197, v218, v219
    v_mfma_f32_32x32x16_bf16 a[16:31], a[168:171], v[192:195], a[16:31]
    v_cvt_pk_bf16_f32 v198, v220, v221
    v_cvt_pk_bf16_f32 v199, v222, v223
    s_nop 0
    v_exp_f32 v208, v144
    v_mfma_f32_32x32x16_bf16 a[32:47], a[176:179], v[192:195], a[32:47]
    v_mov_b32 v8, v9
    v_exp_f32 v209, v145
    v_exp_f32 v210, v146
    v_mfma_f32_32x32x16_bf16 a[48:63], a[184:187], v[192:195], a[48:63]
    v_add_u32 v9, 0x8000, v9
    v_add_f32 v226, v208, v209
    v_cvt_pk_bf16_f32 v200, v208, v209
    v_exp_f32 v211, v147
    v_mfma_f32_32x32x16_bf16 a[0:15], a[164:167], v[196:199], a[0:15]
    v_and_b32 v9, 0x1ffff, v9
    v_add_f32 v226, v226, v210
    v_exp_f32 v212, v148
    v_mfma_f32_32x32x16_bf16 a[16:31], a[172:175], v[196:199], a[16:31]
    v_add_f32 v226, v226, v211
    v_cvt_pk_bf16_f32 v201, v210, v211
    v_exp_f32 v213, v149
    v_add_f32 v226, v226, v212
    v_mfma_f32_32x32x16_bf16 a[32:47], a[180:183], v[196:199], a[32:47]
    v_exp_f32 v214, v150
    v_add_f32 v226, v226, v213
    v_cvt_pk_bf16_f32 v202, v212, v213
    v_exp_f32 v215, v151
    v_mfma_f32_32x32x16_bf16 a[48:63], a[188:191], v[196:199], a[48:63]
    v_add_f32 v226, v226, v214
    s_waitcnt lgkmcnt(0)
    s_sub_u32 s51, s51, 1
    s_cbranch_scc0 KA_DE_U
KA_PRE_M:
    s_mov_b32 s51, 1
KA_DE_M:
    v_mfma_f32_32x32x16_bf16 v[128:143], a[128:131], v[64:67], v[160:175]
    s_add_u32 m0, s50, 4096
    v_cmp_le_i32 s[72:73], 0, v230
    v_cmp_le_i32 s[74:75], 1, v230
    v_exp_f32 v216, v152
    v_add_f32 v226, v226, v215
    v_mfma_f32_32x32x16_bf16 v[128:143], a[132:135], v[68:71], v[128:143]
    buffer_load_dwordx4 v11, s[24:27], s49 offen sc1 lds
    v_cmp_le_i32 s[76:77], 2, v230
    v_cmp_le_i32 s[78:79], 3, v230
    v_cvt_pk_bf16_f32 v203, v214, v215
    v_exp_f32 v217, v153
    v_mfma_f32_32x32x16_bf16 v[128:143], a[136:139], v[72:75], v[128:143]
    v_cndmask_b32 v176, v231, v228, s[72:73]
    v_cndmask_b32 v177, v231, v228, s[74:75]
    v_cndmask_b32 v178, v231, v228, s[76:77]
    v_add_f32 v226, v226, v216
    v_exp_f32 v218, v154
    v_mfma_f32_32x32x16_bf16 v[128:143], a[140:143], v[76:79], v[128:143]
    buffer_load_dwordx4 v11, s[24:27], s49 offen offset:1024 sc1 lds
    v_cndmask_b32 v179, v231, v228, s[78:79]
    v_cmp_le_i32 s[72:73], 8, v230
    v_add_f32 v226, v226, v217
    v_exp_f32 v219, v155
    v_add_f32 v226, v226, v218
    v_mfma_f32_32x32x16_bf16 v[128:143], a[144:147], v[80:83], v[128:143]
    v_cmp_le_i32 s[74:75], 9, v230
    v_cmp_le_i32 s[76:77], 10, v230
    v_cmp_le_i32 s[78:79], 11, v230
    v_exp_f32 v220, v156
    v_add_f32 v226, v226, v219
    v_exp_f32 v221, v157
    v_mfma_f32_32x32x16_bf16 v[128:143], a[148:151], v[84:87], v[128:143]
    buffer_load_dwordx4 v11, s[24:27], s49 offen offset:2048 sc1 lds
    v_cndmask_b32 v180, v231, v228, s[72:73]
    v_cndmask_b32 v181, v231, v228, s[74:75]
    v_add_f32 v226, v226, v220
    v_exp_f32 v222, v158
    v_add_f32 v226, v226, v221
    v_mfma_f32_32x32x16_bf16 v[128:143], a[152:155], v[88:91], v[128:143]
    v_cndmask_b32 v182, v231, v228, s[76:77]
    v_cndmask_b32 v183, v231, v228, s[78:79]
    v_cmp_le_i32 s[72:73], 16, v230
    v_exp_f32 v223, v159
    v_add_f32 v226, v226, v222
    v_add_f32 v226, v226, v223
    v_cmp_lt_f32 vcc, s53, v226
    v_mfma_f32_32x32x16_bf16 v[128:143], a[156:159], v[92:95], v[128:143]
    buffer_load_dwordx4 v11, s[24:27], s49 offen offset:3072 sc1 lds
    s_cbranch_vccnz KA_STUB5
KA_RET5:
    v_cmp_le_i32 s[74:75], 17, v230
    v_cmp_le_i32 s[76:77], 18, v230
    v_mfma_f32_32x32x16_bf16 a[64:79], a[160:163], v[200:203], a[64:79]
    ds_read_b128 a[160:163], v8 offset:8192
    v_add_f32 v225, v225, v226
    v_cvt_pk_bf16_f32 v204, v216, v217
    v_cvt_pk_bf16_f32 v205, v218, v219
    v_mfma_f32_32x32x16_bf16 a[80:95], a[168:171], v[200:203], a[80:95]
    ds_read_b128 a[168:171], v8 offset:10240
    v_cvt_pk_bf16_f32 v206, v220, v221
    v_cvt_pk_bf16_f32 v207, v222, v223
    v_cmp_le_i32 s[78:79], 19, v230
    v_exp_f32 v208, v128
    v_mfma_f32_32x32x16_bf16 a[96:111], a[176:179], v[200:203], a[96:111]
    ds_read_b128 a[176:179], v8 offset:12288
    s_add_u32 s49, s49, 32768
    v_cndmask_b32 v184, v231, v228, s[72:73]
    v_cndmask_b32 v185, v231, v228, s[74:75]
    v_exp_f32 v209, v129
    v_mfma_f32_32x32x16_bf16 a[112:127], a[184:187], v[200:203], a[112:127]
    ds_read_b128 a[184:187], v8 offset:14336
    s_add_u32 s50, s50, 32768
    v_cndmask_b32 v186, v231, v228, s[76:77]
    v_cndmask_b32 v187, v231, v228, s[78:79]
    v_exp_f32 v210, v130
    v_mfma_f32_32x32x16_bf16 a[64:79], a[164:167], v[204:207], a[64:79]
    ds_read_b128 a[164:167], v8 offset:9216
    s_and_b32 s50, s50, 0x1ffff
    v_cmp_le_i32 s[72:73], 24, v230
    v_cmp_le_i32 s[74:75], 25, v230
    v_add_f32 v226, v208, v209
    v_cvt_pk_bf16_f32 v192, v208, v209
    v_mfma_f32_32x32x16_bf16 a[80:95], a[172:175], v[204:207], a[80:95]
    ds_read_b128 a[172:175], v8 offset:11264
    v_cmp_le_i32 s[76:77], 26, v230
    v_cmp_le_i32 s[78:79], 27, v230
    v_cndmask_b32 v188, v231, v228, s[72:73]
    v_exp_f32 v211, v131
    v_mfma_f32_32x32x16_bf16 a[96:111], a[180:183], v[204:207], a[96:111]
    ds_read_b128 a[180:183], v8 offset:13312
    v_cndmask_b32 v189, v231, v228, s[74:75]
    v_cndmask_b32 v190, v231, v228, s[76:77]
    v_cndmask_b32 v191, v231, v228, s[78:79]
    v_add_f32 v226, v226, v210
    v_mfma_f32_32x32x16_bf16 a[112:127], a[188:191], v[204:207], a[112:127]
    ds_read_b128 a[188:191], v8 offset:15360
    v_exp_f32 v212, v132
    v_add_f32 v226, v226, v211
    v_cvt_pk_bf16_f32 v193, v210, v211
    v_exp_f32 v213, v133
    v_mfma_f32_32x32x16_bf16 v[144:159], a[128:131], v[96:99], v[176:191]
    ds_read_b128 a[128:131], v8 offset:16384
    v_add_f32 v226, v226, v212
    v_exp_f32 v214, v134
    v_add_f32 v226, v226, v213
    v_cvt_pk_bf16_f32 v194, v212, v213
    v_mfma_f32_32x32x16_bf16 v[144:159], a[132:135], v[100:103], v[144:159]
    ds_read_b128 a[132:135], v8 offset:17408
    v_exp_f32 v215, v135
    v_add_f32 v226, v226, v214
    v_exp_f32 v216, v136
    v_mfma_f32_32x32x16_bf16 v[144:159], a[136:139], v[104:107], v[144:159]
    ds_read_b128 a[136:139], v8 offset:18432
    v_add_f32 v226, v226, v215
    v_cvt_pk_bf16_f32 v195, v214, v215
    v_exp_f32 v217, v137
    v_add_f32 v226, v226, v216
    v_mfma_f32_32x32x16_bf16 v[144:159], a[140:143], v[108:111], v[144:159]
    ds_read_b128 a[140:143], v8 offset:19456
    v_exp_f32 v218, v138
    v_add_f32 v226, v226, v217
    v_exp_f32 v219, v139
    v_mfma_f32_32x32x16_bf16 v[144:159], a[144:147], v[112:115], v[144:159]
    ds_read_b128 a[144:147], v8 offset:20480
    v_add_f32 v226, v226, v218
    v_exp_f32 v220, v140
    v_add_f32 v226, v226, v219
    v_mfma_f32_32x32x16_bf16 v[144:159], a[148:151], v[116:119], v[144:159]
    ds_read_b128 a[148:151], v8 offset:21504
    v_exp_f32 v221, v141
    v_add_f32 v226, v226, v220
    v_exp_f32 v222, v142
    v_mfma_f32_32x32x16_bf16 v[144:159], a[152:155], v[120:123], v[144:159]
    ds_read_b128 a[152:155], v8 offset:22528
    v_add_f32 v226, v226, v221
    v_exp_f32 v223, v143
    v_add_f32 v226, v226, v222
    v_add_f32 v226, v226, v223
    v_cmp_lt_f32 vcc, s53, v226
    v_mfma_f32_32x32x16_bf16 v[144:159], a[156:159], v[124:127], v[144:159]
    ds_read_b128 a[156:159], v8 offset:23552
    s_cbranch_vccnz KA_STUB6
KA_RET6:
    s_waitcnt lgkmcnt(8)
    v_mfma_f32_32x32x16_bf16 a[0:15], a[160:163], v[192:195], a[0:15]
    v_add_f32 v224, v224, v226
    v_cvt_pk_bf16_f32 v196, v216, v217
    v_cvt_pk_bf16_f32 v197, v218, v219
    v_mfma_f32_32x32x16_bf16 a[16:31], a[168:171], v[192:195], a[16:31]
    v_cvt_pk_bf16_f32 v198, v220, v221
    v_cvt_pk_bf16_f32 v199, v222, v223
    s_nop 1
    v_exp_f32 v208, v144
    v_mfma_f32_32x32x16_bf16 a[32:47], a[176:179], v[192:195], a[32:47]
    v_exp_f32 v209, v145
    v_exp_f32 v210, v146
    v_mfma_f32_32x32x16_bf16 a[48:63], a[184:187], v[192:195], a[48:63]
    v_add_f32 v226, v208, v209
    v_cvt_pk_bf16_f32 v200, v208, v209
    v_exp_f32 v211, v147
    v_mfma_f32_32x32x16_bf16 a[0:15], a[164:167], v[196:199], a[0:15]
    v_add_f32 v226, v226, v210
    v_exp_f32 v212, v148
    v_add_f32 v226, v226, v211
    v_mfma_f32_32x32x16_bf16 a[16:31], a[172:175], v[196:199], a[16:31]
    v_cvt_pk_bf16_f32 v201, v210, v211
    v_exp_f32 v213, v149
    v_add_f32 v226, v226, v212
    v_mfma_f32_32x32x16_bf16 a[32:47], a[180:183], v[196:199], a[32:47]
    v_subrev_u32 v230, 32, v230
    v_exp_f32 v214, v150
    v_add_f32 v226, v226, v213
    v_cvt_pk_bf16_f32 v202, v212, v213
    v_mfma_f32_32x32x16_bf16 a[48:63], a[188:191], v[196:199], a[48:63]
    v_exp_f32 v215, v151
    v_add_f32 v226, v226, v214
    s_waitcnt lgkmcnt(0)
KA_DO_M:
    s_waitcnt lgkmcnt(7)
    v_mfma_f32_32x32x16_bf16 v[128:143], a[128:131], v[64:67], v[160:175]
    v_cmp_le_i32 s[72:73], 0, v230
    v_cmp_le_i32 s[74:75], 1, v230
    v_exp_f32 v216, v152
    v_add_f32 v226, v226, v215
    v_cvt_pk_bf16_f32 v203, v214, v215
    s_waitcnt lgkmcnt(6)
    v_mfma_f32_32x32x16_bf16 v[128:143], a[132:135], v[68:71], v[128:143]
    v_cmp_le_i32 s[76:77], 2, v230
    v_cmp_le_i32 s[78:79], 3, v230
    v_cndmask_b32 v176, v231, v228, s[72:73]
    v_exp_f32 v217, v153
    v_add_f32 v226, v226, v216
    s_waitcnt lgkmcnt(5)
    v_mfma_f32_32x32x16_bf16 v[128:143], a[136:139], v[72:75], v[128:143]
    v_cndmask_b32 v177, v231, v228, s[74:75]
    v_cndmask_b32 v178, v231, v228, s[76:77]
    v_cndmask_b32 v179, v231, v228, s[78:79]
    v_exp_f32 v218, v154
    v_add_f32 v226, v226, v217
    s_waitcnt lgkmcnt(4)
    v_mfma_f32_32x32x16_bf16 v[128:143], a[140:143], v[76:79], v[128:143]
    v_cmp_le_i32 s[72:73], 8, v230
    v_cmp_le_i32 s[74:75], 9, v230
    v_cmp_le_i32 s[76:77], 10, v230
    v_exp_f32 v219, v155
    v_add_f32 v226, v226, v218
    s_waitcnt lgkmcnt(3)
    v_mfma_f32_32x32x16_bf16 v[128:143], a[144:147], v[80:83], v[128:143]
    v_cmp_le_i32 s[78:79], 11, v230
    v_cndmask_b32 v180, v231, v228, s[72:73]
    v_cndmask_b32 v181, v231, v228, s[74:75]
    v_exp_f32 v220, v156
    v_add_f32 v226, v226, v219
    v_exp_f32 v221, v157
    s_waitcnt lgkmcnt(2)
    v_mfma_f32_32x32x16_bf16 v[128:143], a[148:151], v[84:87], v[128:143]
    v_cndmask_b32 v182, v231, v228, s[76:77]
    v_cndmask_b32 v183, v231, v228, s[78:79]
    v_cmp_le_i32 s[72:73], 16, v230
    v_add_f32 v226, v226, v220
    v_exp_f32 v222, v158
    v_add_f32 v226, v226, v221
    s_waitcnt lgkmcnt(1)
    v_mfma_f32_32x32x16_bf16 v[128:143], a[152:155], v[88:91], v[128:143]
    v_cmp_le_i32 s[74:75], 17, v230
    v_cmp_le_i32 s[76:77], 18, v230
    v_cmp_le_i32 s[78:79], 19, v230
    v_exp_f32 v223, v159
    v_add_f32 v226, v226, v222
    v_add_f32 v226, v226, v223
    v_cmp_lt_f32 vcc, s53, v226
    s_waitcnt lgkmcnt(0)
    v_mfma_f32_32x32x16_bf16 v[128:143], a[156:159], v[92:95], v[128:143]
    s_cbranch_vccnz KA_STUB7
KA_RET7:
    v_cndmask_b32 v184, v231, v228, s[72:73]
    v_cndmask_b32 v185, v231, v228, s[74:75]
    v_mfma_f32_32x32x16_bf16 a[64:79], a[160:163], v[200:203], a[64:79]
    ds_read_b128 a[160:163], v8 offset:24576
    v_add_f32 v225, v225, v226
    v_cvt_pk_bf16_f32 v204, v216, v217
    v_cvt_pk_bf16_f32 v205, v218, v219
    v_mfma_f32_32x32x16_bf16 a[80:95], a[168:171], v[200:203], a[80:95]
    ds_read_b128 a[168:171], v8 offset:26624
    v_cvt_pk_bf16_f32 v206, v220, v221
    v_cvt_pk_bf16_f32 v207, v222, v223
    v_exp_f32 v208, v128
    v_exp_f32 v209, v129
    v_mfma_f32_32x32x16_bf16 a[96:111], a[176:179], v[200:203], a[96:111]
    ds_read_b128 a[176:179], v8 offset:28672
    v_cndmask_b32 v186, v231, v228, s[76:77]
    v_cndmask_b32 v187, v231, v228, s[78:79]
    v_exp_f32 v210, v130
    v_add_f32 v226, v208, v209
    v_mfma_f32_32x32x16_bf16 a[112:127], a[184:187], v[200:203], a[112:127]
    ds_read_b128 a[184:187], v8 offset:30720
    v_cmp_le_i32 s[72:73], 24, v230
    v_cmp_le_i32 s[74:75], 25, v230
    v_cvt_pk_bf16_f32 v192, v208, v209
    v_exp_f32 v211, v131
    v_mfma_f32_32x32x16_bf16 a[64:79], a[164:167], v[204:207], a[64:79]
    ds_read_b128 a[164:167], v8 offset:25600
    v_cmp_le_i32 s[76:77], 26, v230
    v_cmp_le_i32 s[78:79], 27, v230
    v_add_f32 v226, v226, v210
    v_exp_f32 v212, v132
    v_mfma_f32_32x32x16_bf16 a[80:95], a[172:175], v[204:207], a[80:95]
    ds_read_b128 a[172:175], v8 offset:27648
    v_cndmask_b32 v188, v231, v228, s[72:73]
    v_cndmask_b32 v189, v231, v228, s[74:75]
    v_add_f32 v226, v226, v211
    v_cvt_pk_bf16_f32 v193, v210, v211
    v_mfma_f32_32x32x16_bf16 a[96:111], a[180:183], v[204:207], a[96:111]
    ds_read_b128 a[180:183], v8 offset:29696
    v_cndmask_b32 v190, v231, v228, s[76:77]
    v_cndmask_b32 v191, v231, v228, s[78:79]
    v_exp_f32 v213, v133
    v_add_f32 v226, v226, v212
    v_mfma_f32_32x32x16_bf16 a[112:127], a[188:191], v[204:207], a[112:127]
    ds_read_b128 a[188:191], v8 offset:31744
    s_waitcnt vmcnt(8)
    s_barrier
    v_exp_f32 v214, v134
    v_add_f32 v226, v226, v213
    v_mfma_f32_32x32x16_bf16 v[144:159], a[128:131], v[96:99], v[176:191]
    ds_read_b128 a[128:131], v9
    s_mov_b32 m0, s50
    v_cvt_pk_bf16_f32 v194, v212, v213
    v_exp_f32 v215, v135
    v_add_f32 v226, v226, v214
    v_mfma_f32_32x32x16_bf16 v[144:159], a[132:135], v[100:103], v[144:159]
    ds_read_b128 a[132:135], v9 offset:1024
    buffer_load_dwordx4 v10, s[24:27], s49 offen sc1 lds
    v_exp_f32 v216, v136
    v_add_f32 v226, v226, v215
    v_cvt_pk_bf16_f32 v195, v214, v215
    v_mfma_f32_32x32x16_bf16 v[144:159], a[136:139], v[104:107], v[144:159]
    ds_read_b128 a[136:139], v9 offset:2048
    v_exp_f32 v217, v137
    v_add_f32 v226, v226, v216
    v_exp_f32 v218, v138
    v_mfma_f32_32x32x16_bf16 v[144:159], a[140:143], v[108:111], v[144:159]
    ds_read_b128 a[140:143], v9 offset:3072
    buffer_load_dwordx4 v10, s[24:27], s49 offen offset:1024 sc1 lds
    v_add_f32 v226, v226, v217
    v_exp_f32 v219, v139
    v_add_f32 v226, v226, v218
    v_mfma_f32_32x32x16_bf16 v[144:159], a[144:147], v[112:115], v[144:159]
    ds_read_b128 a[144:147], v9 offset:4096
    v_exp_f32 v220, v140
    v_add_f32 v226, v226, v219
    v_exp_f32 v221, v141
    v_mfma_f32_32x32x16_bf16 v[144:159], a[148:151], v[116:119], v[144:159]
    ds_read_b128 a[148:151], v9 offset:5120
    buffer_load_dwordx4 v10, s[24:27], s49 offen offset:2048 sc1 lds
    v_add_f32 v226, v226, v220
    v_exp_f32 v222, v142
    v_add_f32 v226, v226, v221
    v_mfma_f32_32x32x16_bf16 v[144:159], a[152:155], v[120:123], v[144:159]
    ds_read_b128 a[152:155], v9 offset:6144
    v_exp_f32 v223, v143
    v_add_f32 v226, v226, v222
    v_add_f32 v226, v226, v223
    v_cmp_lt_f32 vcc, s53, v226
    v_mfma_f32_32x32x16_bf16 v[144:159], a[156:159], v[124:127], v[144:159]
    ds_read_b128 a[156:159], v9 offset:7168
    buffer_load_dwordx4 v10, s[24:27], s49 offen offset:3072 sc1 lds
    s_cbranch_vccnz KA_STUB8
KA_RET8:
    s_waitcnt lgkmcnt(8)
    v_mfma_f32_32x32x16_bf16 a[0:15], a[160:163], v[192:195], a[0:15]
    v_add_f32 v224, v224, v226
    v_cvt_pk_bf16_f32 v196, v216, v217
    v_cvt_pk_bf16_f32 v197, v218, v219
    v_mfma_f32_32x32x16_bf16 a[16:31], a[168:171], v[192:195], a[16:31]
    v_cvt_pk_bf16_f32 v198, v220, v221
    v_cvt_pk_bf16_f32 v199, v222, v223
    s_nop 0
    v_exp_f32 v208, v144
    v_mfma_f32_32x32x16_bf16 a[32:47], a[176:179], v[192:195], a[32:47]
    v_mov_b32 v8, v9
    v_exp_f32 v209, v145
    v_exp_f32 v210, v146
    v_mfma_f32_32x32x16_bf16 a[48:63], a[184:187], v[192:195], a[48:63]
    v_add_u32 v9, 0x8000, v9
    v_add_f32 v226, v208, v209
    v_cvt_pk_bf16_f32 v200, v208, v209
    v_exp_f32 v211, v147
    v_mfma_f32_32x32x16_bf16 a[0:15], a[164:167], v[196:199], a[0:15]
    v_and_b32 v9, 0x1ffff, v9
    v_add_f32 v226, v226, v210
    v_exp_f32 v212, v148
    v_add_f32 v226, v226, v211
    v_mfma_f32_32x32x16_bf16 a[16:31], a[172:175], v[196:199], a[16:31]
    v_cvt_pk_bf16_f32 v201, v210, v211
    v_exp_f32 v213, v149
    v_add_f32 v226, v226, v212
    v_exp_f32 v214, v150
    v_mfma_f32_32x32x16_bf16 a[32:47], a[180:183], v[196:199], a[32:47]
    v_subrev_u32 v230, 32, v230
    v_add_f32 v226, v226, v213
    v_cvt_pk_bf16_f32 v202, v212, v213
    v_exp_f32 v215, v151
    v_mfma_f32_32x32x16_bf16 a[48:63], a[188:191], v[196:199], a[48:63]
    v_add_f32 v226, v226, v214
    s_waitcnt lgkmcnt(0)
    s_sub_u32 s51, s51, 1
    s_cbranch_scc0 KA_DE_M
    s_cmp_eq_u32 s45, 7
    s_cbranch_scc1 KA_TR_M
KA_TR_U:
    v_mfma_f32_32x32x16_bf16 v[128:143], a[128:131], v[64:67], v[160:175]
    ds_read_b128 a[128:131], v8 offset:16384
    s_add_u32 m0, s50, 4096
    v_exp_f32 v216, v152
    v_add_f32 v226, v226, v215
    v_mfma_f32_32x32x16_bf16 v[128:143], a[132:135], v[68:71], v[128:143]
    ds_read_b128 a[132:135], v8 offset:17408
    buffer_load_dwordx4 v11, s[24:27], s49 offen sc1 lds
    v_cvt_pk_bf16_f32 v203, v214, v215
    v_exp_f32 v217, v153
    v_mfma_f32_32x32x16_bf16 v[128:143], a[136:139], v[72:75], v[128:143]
    ds_read_b128 a[136:139], v8 offset:18432
    v_add_f32 v226, v226, v216
    v_exp_f32 v218, v154
    v_add_f32 v226, v226, v217
    v_mfma_f32_32x32x16_bf16 v[128:143], a[140:143], v[76:79], v[128:143]
    ds_read_b128 a[140:143], v8 offset:19456
    buffer_load_dwordx4 v11, s[24:27], s49 offen offset:1024 sc1 lds
    v_exp_f32 v219, v155
    v_add_f32 v226, v226, v218
    v_mfma_f32_32x32x16_bf16 v[128:143], a[144:147], v[80:83], v[128:143]
    ds_read_b128 a[144:147], v8 offset:20480
    v_exp_f32 v220, v156
    v_add_f32 v226, v226, v219
    v_exp_f32 v221, v157
    v_mfma_f32_32x32x16_bf16 v[128:143], a[148:151], v[84:87], v[128:143]
    ds_read_b128 a[148:151], v8 offset:21504
    buffer_load_dwordx4 v11, s[24:27], s49 offen offset:2048 sc1 lds
    v_add_f32 v226, v226, v220
    v_exp_f32 v222, v158
    v_add_f32 v226, v226, v221
    v_mfma_f32_32x32x16_bf16 v[128:143], a[152:155], v[88:91], v[128:143]
    ds_read_b128 a[152:155], v8 offset:22528
    v_exp_f32 v223, v159
    v_add_f32 v226, v226, v222
    v_add_f32 v226, v226, v223
    v_cmp_lt_f32 vcc, s53, v226
    v_mfma_f32_32x32x16_bf16 v[128:143], a[156:159], v[92:95], v[128:143]
    ds_read_b128 a[156:159], v8 offset:23552
    buffer_load_dwordx4 v11, s[24:27], s49 offen offset:3072 sc1 lds
    s_cbranch_vccnz KA_STUB9
KA_RET9:
    s_waitcnt lgkmcnt(8)
    v_mfma_f32_32x32x16_bf16 a[64:79], a[160:163], v[200:203], a[64:79]
    ds_read_b128 a[160:163], v8 offset:8192
    v_add_f32 v225, v225, v226
    v_cvt_pk_bf16_f32 v204, v216, v217
    v_cvt_pk_bf16_f32 v205, v218, v219
    v_mfma_f32_32x32x16_bf16 a[80:95], a[168:171], v[200:203], a[80:95]
    ds_read_b128 a[168:171], v8 offset:10240
    v_cvt_pk_bf16_f32 v206, v220, v221
    v_cvt_pk_bf16_f32 v207, v222, v223
    v_mov_b32 v176, v227
    v_exp_f32 v208, v128
    v_exp_f32 v209, v129
    v_mfma_f32_32x32x16_bf16 a[96:111], a[176:179], v[200:203], a[96:111]
    ds_read_b128 a[176:179], v8 offset:12288
    s_add_u32 s49, s49, 32768
    v_mov_b32 v177, v227
    v_mov_b32 v178, v227
    v_exp_f32 v210, v130
    v_add_f32 v226, v208, v209
    v_mfma_f32_32x32x16_bf16 a[112:127], a[184:187], v[200:203], a[112:127]
    ds_read_b128 a[184:187], v8 offset:14336
    s_add_u32 s50, s50, 32768
    v_mov_b32 v179, v227
    v_mov_b32 v180, v227
    v_cvt_pk_bf16_f32 v192, v208, v209
    v_exp_f32 v211, v131
    v_mfma_f32_32x32x16_bf16 a[64:79], a[164:167], v[204:207], a[64:79]
    ds_read_b128 a[164:167], v8 offset:9216
    s_and_b32 s50, s50, 0x1ffff
    v_mov_b32 v181, v227
    v_mov_b32 v182, v227
    v_mov_b32 v183, v227
    v_add_f32 v226, v226, v210
    v_mfma_f32_32x32x16_bf16 a[80:95], a[172:175], v[204:207], a[80:95]
    ds_read_b128 a[172:175], v8 offset:11264
    v_mov_b32 v184, v227
    v_mov_b32 v185, v227
    v_mov_b32 v186, v227
    v_mov_b32 v187, v227
    v_exp_f32 v212, v132
    v_mfma_f32_32x32x16_bf16 a[96:111], a[180:183], v[204:207], a[96:111]
    ds_read_b128 a[180:183], v8 offset:13312
    v_mov_b32 v188, v227
    v_mov_b32 v189, v227
    v_mov_b32 v190, v227
    v_mov_b32 v191, v227
    v_add_f32 v226, v226, v211
    v_mfma_f32_32x32x16_bf16 a[112:127], a[188:191], v[204:207], a[112:127]
    ds_read_b128 a[188:191], v8 offset:15360
    s_waitcnt vmcnt(8)
    s_barrier
    v_cvt_pk_bf16_f32 v193, v210, v211
    v_exp_f32 v213, v133
    s_waitcnt lgkmcnt(8)
    v_mfma_f32_32x32x16_bf16 v[144:159], a[128:131], v[64:67], v[176:191]
    ds_read_b128 a[128:131], v9
    s_mov_b32 m0, s50
    v_add_f32 v226, v226, v212
    v_exp_f32 v214, v134
    v_add_f32 v226, v226, v213
    v_cvt_pk_bf16_f32 v194, v212, v213
    v_mfma_f32_32x32x16_bf16 v[144:159], a[132:135], v[68:71], v[144:159]
    ds_read_b128 a[132:135], v9 offset:1024
    buffer_load_dwordx4 v10, s[24:27], s49 offen sc1 lds
    v_exp_f32 v215, v135
    v_add_f32 v226, v226, v214
    v_exp_f32 v216, v136
    v_mfma_f32_32x32x16_bf16 v[144:159], a[136:139], v[72:75], v[144:159]
    ds_read_b128 a[136:139], v9 offset:2048
    v_mov_b32 v12, v8
    v_add_f32 v226, v226, v215
    v_cvt_pk_bf16_f32 v195, v214, v215
    v_exp_f32 v217, v137
    v_mfma_f32_32x32x16_bf16 v[144:159], a[140:143], v[76:79], v[144:159]
    ds_read_b128 a[140:143], v9 offset:3072
    buffer_load_dwordx4 v10, s[24:27], s49 offen offset:1024 sc1 lds
    v_add_f32 v226, v226, v216
    v_exp_f32 v218, v138
    v_add_f32 v226, v226, v217
    v_mfma_f32_32x32x16_bf16 v[144:159], a[144:147], v[80:83], v[144:159]
    ds_read_b128 a[144:147], v9 offset:4096
    v_exp_f32 v219, v139
    v_add_f32 v226, v226, v218
    v_exp_f32 v220, v140
    v_add_f32 v226, v226, v219
    v_mfma_f32_32x32x16_bf16 v[144:159], a[148:151], v[84:87], v[144:159]
    ds_read_b128 a[148:151], v9 offset:5120
    buffer_load_dwordx4 v10, s[24:27], s49 offen offset:2048 sc1 lds
    v_exp_f32 v221, v141
    v_add_f32 v226, v226, v220
    v_exp_f32 v222, v142
    v_mfma_f32_32x32x16_bf16 v[144:159], a[152:155], v[88:91], v[144:159]
    ds_read_b128 a[152:155], v9 offset:6144
    v_add_f32 v226, v226, v221
    v_exp_f32 v223, v143
    v_add_f32 v226, v226, v222
    v_add_f32 v226, v226, v223
    v_cmp_lt_f32 vcc, s53, v226
    v_mfma_f32_32x32x16_bf16 v[144:159], a[156:159], v[92:95], v[144:159]
    ds_read_b128 a[156:159], v9 offset:7168
    buffer_load_dwordx4 v10, s[24:27], s49 offen offset:3072 sc1 lds
    s_cbranch_vccnz KA_STUB10
KA_RET10:
    s_waitcnt lgkmcnt(8)
    v_mfma_f32_32x32x16_bf16 a[0:15], a[160:163], v[192:195], a[0:15]
    ds_read_b128 a[160:163], v12 offset:24576
    v_add_f32 v224, v224, v226
    v_cvt_pk_bf16_f32 v196, v216, v217
    v_cvt_pk_bf16_f32 v197, v218, v219
    v_mfma_f32_32x32x16_bf16 a[16:31], a[168:171], v[192:195], a[16:31]
    ds_read_b128 a[168:171], v12 offset:26624
    v_cvt_pk_bf16_f32 v198, v220, v221
    v_cvt_pk_bf16_f32 v199, v222, v223
    v_exp_f32 v208, v144
    v_mfma_f32_32x32x16_bf16 a[32:47], a[176:179], v[192:195], a[32:47]
    ds_read_b128 a[176:179], v12 offset:28672
    v_mov_b32 v8, v9
    v_exp_f32 v209, v145
    v_exp_f32 v210, v146
    v_mfma_f32_32x32x16_bf16 a[48:63], a[184:187], v[192:195], a[48:63]
    ds_read_b128 a[184:187], v12 offset:30720
    v_add_u32 v9, 0x8000, v9
    v_add_f32 v226, v208, v209
    v_cvt_pk_bf16_f32 v200, v208, v209
    v_exp_f32 v211, v147
    v_mfma_f32_32x32x16_bf16 a[0:15], a[164:167], v[196:199], a[0:15]
    ds_read_b128 a[164:167], v12 offset:25600
    v_and_b32 v9, 0x1ffff, v9
    v_add_f32 v226, v226, v210
    v_exp_f32 v212, v148
    v_mfma_f32_32x32x16_bf16 a[16:31], a[172:175], v[196:199], a[16:31]
    ds_read_b128 a[172:175], v12 offset:27648
    v_add_f32 v226, v226, v211
    v_cvt_pk_bf16_f32 v201, v210, v211
    v_exp_f32 v213, v149
    v_mfma_f32_32x32x16_bf16 a[32:47], a[180:183], v[196:199], a[32:47]
    ds_read_b128 a[180:183], v12 offset:29696
    v_add_f32 v226, v226, v212
    v_exp_f32 v214, v150
    v_add_f32 v226, v226, v213
    v_cvt_pk_bf16_f32 v202, v212, v213
    v_mfma_f32_32x32x16_bf16 a[48:63], a[188:191], v[196:199], a[48:63]
    ds_read_b128 a[188:191], v12 offset:31744
    v_exp_f32 v215, v151
    v_add_f32 v226, v226, v214
    s_waitcnt lgkmcnt(8)
    s_sub_u32 s51, s47, s48
    s_lshl_b32 s51, s51, 1
    s_sub_u32 s51, s51, 4
KA_EPB:
    s_load_dwordx2 s[66:67], s[0:1], 104
    v_lshrrev_b32 v1, 6, v0
    v_and_b32 v3, 63, v0
    v_lshrrev_b32 v6, 3, v3
    v_and_b32 v7, 7, v3
    v_lshlrev_b32 v7, 4, v7
    v_lshl_add_u32 v7, v1, 7, v7
    s_waitcnt lgkmcnt(0)
    s_add_u32 s8, s66, 67108864
    s_addc_u32 s9, s67, 0
    s_mov_b32 s10, 4194304
    s_mov_b32 s11, 0x20000
    v_lshl_add_u32 v4, v6, 19, v7
    s_lshl_b32 s70, s2, 11
    buffer_store_dwordx4 v[16:19], v4, s[8:11], s70 offen
    buffer_store_dwordx4 v[20:23], v4, s[8:11], s70 offen offset:512
    buffer_store_dwordx4 v[24:27], v4, s[8:11], s70 offen offset:1024
    buffer_store_dwordx4 v[28:31], v4, s[8:11], s70 offen offset:1536
    s_add_u32 s8, s66, 71303168
    s_addc_u32 s9, s67, 0
    s_mov_b32 s10, 1835008
    s_mov_b32 s11, 0x20000
    v_mul_u32_u24 v4, 229376, v6
    v_add_u32 v4, v4, v7
    s_mul_i32 s70, s2, 896
    buffer_store_dwordx4 v[32:35], v4, s[8:11], s70 offen
    s_add_u32 s70, s70, 512
    s_cmp_eq_u32 s46, 3
    s_cselect_b32 s70, 0x7000000, s70
    buffer_store_dwordx4 v[36:39], v4, s[8:11], s70 offen
    s_lshl_b32 s64, s44, 13
    s_lshl_b32 s65, s56, 3
    s_add_u32 s65, s65, s64
    v_mov_b32 v232, v225
    s_nop 1
    v_permlane32_swap_b32 v225, v232
    s_nop 1
    v_add_f32 v225, v225, v232
    v_rcp_f32 v234, v225
    s_nop 0
    v_mov_b32 v235, v234
    v_accvgpr_read_b32 v96, a64
    v_accvgpr_read_b32 v97, a65
    v_accvgpr_read_b32 v98, a66
    v_accvgpr_read_b32 v99, a67
    v_accvgpr_read_b32 v100, a68
    v_accvgpr_read_b32 v101, a69
    v_accvgpr_read_b32 v102, a70
    v_accvgpr_read_b32 v103, a71
    v_pk_mul_f32 v[96:97], v[96:97], v[234:235]
    v_pk_mul_f32 v[98:99], v[98:99], v[234:235]
    v_pk_mul_f32 v[100:101], v[100:101], v[234:235]
    v_pk_mul_f32 v[102:103], v[102:103], v[234:235]
    v_cvt_pk_bf16_f32 v112, v96, v97
    v_cvt_pk_bf16_f32 v113, v98, v99
    v_cvt_pk_bf16_f32 v114, v100, v101
    v_cvt_pk_bf16_f32 v115, v102, v103
    s_add_u32 s67, s65, 0
    buffer_store_dwordx4 v[112:115], v5, s[36:39], s67 offen
    v_accvgpr_read_b32 v104, a72
    v_accvgpr_read_b32 v105, a73
    v_accvgpr_read_b32 v106, a74
    v_accvgpr_read_b32 v107, a75
    v_accvgpr_read_b32 v108, a76
    v_accvgpr_read_b32 v109, a77
    v_accvgpr_read_b32 v110, a78
    v_accvgpr_read_b32 v111, a79
    v_pk_mul_f32 v[104:105], v[104:105], v[234:235]
    v_pk_mul_f32 v[106:107], v[106:107], v[234:235]
    v_pk_mul_f32 v[108:109], v[108:109], v[234:235]
    v_pk_mul_f32 v[110:111], v[110:111], v[234:235]
    v_cvt_pk_bf16_f32 v116, v104, v105
    v_cvt_pk_bf16_f32 v117, v106, v107
    v_cvt_pk_bf16_f32 v118, v108, v109
    v_cvt_pk_bf16_f32 v119, v110, v111
    s_add_u32 s67, s65, 0
    buffer_store_dwordx4 v[116:119], v5, s[36:39], s67 offen offset:1024
    v_accvgpr_read_b32 v96, a80
    v_accvgpr_read_b32 v97, a81
    v_accvgpr_read_b32 v98, a82
    v_accvgpr_read_b32 v99, a83
    v_accvgpr_read_b32 v100, a84
    v_accvgpr_read_b32 v101, a85
    v_accvgpr_read_b32 v102, a86
    v_accvgpr_read_b32 v103, a87
    v_pk_mul_f32 v[96:97], v[96:97], v[234:235]
    v_pk_mul_f32 v[98:99], v[98:99], v[234:235]
    v_pk_mul_f32 v[100:101], v[100:101], v[234:235]
    v_pk_mul_f32 v[102:103], v[102:103], v[234:235]
    v_cvt_pk_bf16_f32 v120, v96, v97
    v_cvt_pk_bf16_f32 v121, v98, v99
    v_cvt_pk_bf16_f32 v122, v100, v101
    v_cvt_pk_bf16_f32 v123, v102, v103
    s_add_u32 s67, s65, 0
    buffer_store_dwordx4 v[120:123], v5, s[36:39], s67 offen offset:2048
    v_accvgpr_read_b32 v104, a88
    v_accvgpr_read_b32 v105, a89
    v_accvgpr_read_b32 v106, a90
    v_accvgpr_read_b32 v107, a91
    v_accvgpr_read_b32 v108, a92
    v_accvgpr_read_b32 v109, a93
    v_accvgpr_read_b32 v110, a94
    v_accvgpr_read_b32 v111, a95
    v_pk_mul_f32 v[104:105], v[104:105], v[234:235]
    v_pk_mul_f32 v[106:107], v[106:107], v[234:235]
    v_pk_mul_f32 v[108:109], v[108:109], v[234:235]
    v_pk_mul_f32 v[110:111], v[110:111], v[234:235]
    v_cvt_pk_bf16_f32 v124, v104, v105
    v_cvt_pk_bf16_f32 v125, v106, v107
    v_cvt_pk_bf16_f32 v126, v108, v109
    v_cvt_pk_bf16_f32 v127, v110, v111
    s_add_u32 s67, s65, 0
    buffer_store_dwordx4 v[124:127], v5, s[36:39], s67 offen offset:3072
    v_accvgpr_read_b32 v96, a96
    v_accvgpr_read_b32 v97, a97
    v_accvgpr_read_b32 v98, a98
    v_accvgpr_read_b32 v99, a99
    v_accvgpr_read_b32 v100, a100
    v_accvgpr_read_b32 v101, a101
    v_accvgpr_read_b32 v102, a102
    v_accvgpr_read_b32 v103, a103
    v_pk_mul_f32 v[96:97], v[96:97], v[234:235]
    v_pk_mul_f32 v[98:99], v[98:99], v[234:235]
    v_pk_mul_f32 v[100:101], v[100:101], v[234:235]
    v_pk_mul_f32 v[102:103], v[102:103], v[234:235]
    v_cvt_pk_bf16_f32 v112, v96, v97
    v_cvt_pk_bf16_f32 v113, v98, v99
    v_cvt_pk_bf16_f32 v114, v100, v101
    v_cvt_pk_bf16_f32 v115, v102, v103
    s_add_u32 s67, s65, 4096
    buffer_store_dwordx4 v[112:115], v5, s[36:39], s67 offen
    v_accvgpr_read_b32 v104, a104
    v_accvgpr_read_b32 v105, a105
    v_accvgpr_read_b32 v106, a106
    v_accvgpr_read_b32 v107, a107
    v_accvgpr_read_b32 v108, a108
    v_accvgpr_read_b32 v109, a109
    v_accvgpr_read_b32 v110, a110
    v_accvgpr_read_b32 v111, a111
    v_pk_mul_f32 v[104:105], v[104:105], v[234:235]
    v_pk_mul_f32 v[106:107], v[106:107], v[234:235]
    v_pk_mul_f32 v[108:109], v[108:109], v[234:235]
    v_pk_mul_f32 v[110:111], v[110:111], v[234:235]
    v_cvt_pk_bf16_f32 v116, v104, v105
    v_cvt_pk_bf16_f32 v117, v106, v107
    v_cvt_pk_bf16_f32 v118, v108, v109
    v_cvt_pk_bf16_f32 v119, v110, v111
    s_add_u32 s67, s65, 4096
    buffer_store_dwordx4 v[116:119], v5, s[36:39], s67 offen offset:1024
    v_accvgpr_read_b32 v96, a112
    v_accvgpr_read_b32 v97, a113
    v_accvgpr_read_b32 v98, a114
    v_accvgpr_read_b32 v99, a115
    v_accvgpr_read_b32 v100, a116
    v_accvgpr_read_b32 v101, a117
    v_accvgpr_read_b32 v102, a118
    v_accvgpr_read_b32 v103, a119
    v_pk_mul_f32 v[96:97], v[96:97], v[234:235]
    v_pk_mul_f32 v[98:99], v[98:99], v[234:235]
    v_pk_mul_f32 v[100:101], v[100:101], v[234:235]
    v_pk_mul_f32 v[102:103], v[102:103], v[234:235]
    v_cvt_pk_bf16_f32 v120, v96, v97
    v_cvt_pk_bf16_f32 v121, v98, v99
    v_cvt_pk_bf16_f32 v122, v100, v101
    v_cvt_pk_bf16_f32 v123, v102, v103
    s_add_u32 s67, s65, 4096
    buffer_store_dwordx4 v[120:123], v5, s[36:39], s67 offen offset:2048
    v_accvgpr_read_b32 v104, a120
    v_accvgpr_read_b32 v105, a121
    v_accvgpr_read_b32 v106, a122
    v_accvgpr_read_b32 v107, a123
    v_accvgpr_read_b32 v108, a124
    v_accvgpr_read_b32 v109, a125
    v_accvgpr_read_b32 v110, a126
    v_accvgpr_read_b32 v111, a127
    v_pk_mul_f32 v[104:105], v[104:105], v[234:235]
    v_pk_mul_f32 v[106:107], v[106:107], v[234:235]
    v_pk_mul_f32 v[108:109], v[108:109], v[234:235]
    v_pk_mul_f32 v[110:111], v[110:111], v[234:235]
    v_cvt_pk_bf16_f32 v124, v104, v105
    v_cvt_pk_bf16_f32 v125, v106, v107
    v_cvt_pk_bf16_f32 v126, v108, v109
    v_cvt_pk_bf16_f32 v127, v110, v111
    s_add_u32 s67, s65, 4096
    buffer_store_dwordx4 v[124:127], v5, s[36:39], s67 offen offset:3072
    s_cmp_eq_u32 s45, 7
    s_cbranch_scc1 KA_SG_M
KA_SG_U:
    v_mfma_f32_32x32x16_bf16 v[128:143], a[128:131], v[64:67], v[160:175]
    ds_read_b128 a[128:131], v8 offset:16384
    s_add_u32 m0, s50, 4096
    v_exp_f32 v216, v152
    v_add_f32 v226, v226, v215
    v_mfma_f32_32x32x16_bf16 v[128:143], a[132:135], v[68:71], v[128:143]
    ds_read_b128 a[132:135], v8 offset:17408
    buffer_load_dwordx4 v11, s[24:27], s49 offen sc1 lds
    v_cvt_pk_bf16_f32 v203, v214, v215
    v_exp_f32 v217, v153
    v_mfma_f32_32x32x16_bf16 v[128:143], a[136:139], v[72:75], v[128:143]
    ds_read_b128 a[136:139], v8 offset:18432
    v_add_f32 v226, v226, v216
    v_exp_f32 v218, v154
    v_add_f32 v226, v226, v217
    v_mfma_f32_32x32x16_bf16 v[128:143], a[140:143], v[76:79], v[128:143]
    ds_read_b128 a[140:143], v8 offset:19456
    buffer_load_dwordx4 v11, s[24:27], s49 offen offset:1024 sc1 lds
    v_exp_f32 v219, v155
    v_add_f32 v226, v226, v218
    v_mfma_f32_32x32x16_bf16 v[128:143], a[144:147], v[80:83], v[128:143]
    ds_read_b128 a[144:147], v8 offset:20480
    v_exp_f32 v220, v156
    v_add_f32 v226, v226, v219
    v_exp_f32 v221, v157
    v_mfma_f32_32x32x16_bf16 v[128:143], a[148:151], v[84:87], v[128:143]
    ds_read_b128 a[148:151], v8 offset:21504
    buffer_load_dwordx4 v11, s[24:27], s49 offen offset:2048 sc1 lds
    v_add_f32 v226, v226, v220
    v_exp_f32 v222, v158
    v_add_f32 v226, v226, v221
    v_mfma_f32_32x32x16_bf16 v[128:143], a[152:155], v[88:91], v[128:143]
    ds_read_b128 a[152:155], v8 offset:22528
    v_exp_f32 v223, v159
    v_add_f32 v226, v226, v222
    v_add_f32 v226, v226, v223
    v_cmp_lt_f32 vcc, s53, v226
    v_mfma_f32_32x32x16_bf16 v[128:143], a[156:159], v[92:95], v[128:143]
    ds_read_b128 a[156:159], v8 offset:23552
    buffer_load_dwordx4 v11, s[24:27], s49 offen offset:3072 sc1 lds
    s_cbranch_vccnz KA_STUB11
KA_RET11:
    s_waitcnt lgkmcnt(8)
    v_mfma_f32_32x32x16_bf16 a[0:15], a[160:163], v[200:203], a[0:15]
    ds_read_b128 a[160:163], v8 offset:8192
    v_add_f32 v224, v224, v226
    v_cvt_pk_bf16_f32 v204, v216, v217
    v_cvt_pk_bf16_f32 v205, v218, v219
    v_mfma_f32_32x32x16_bf16 a[16:31], a[168:171], v[200:203], a[16:31]
    ds_read_b128 a[168:171], v8 offset:10240
    v_cvt_pk_bf16_f32 v206, v220, v221
    v_cvt_pk_bf16_f32 v207, v222, v223
    v_exp_f32 v208, v128
    v_mfma_f32_32x32x16_bf16 a[32:47], a[176:179], v[200:203], a[32:47]
    ds_read_b128 a[176:179], v8 offset:12288
    s_add_u32 s49, s49, 32768
    v_exp_f32 v209, v129
    v_exp_f32 v210, v130
    v_mfma_f32_32x32x16_bf16 a[48:63], a[184:187], v[200:203], a[48:63]
    ds_read_b128 a[184:187], v8 offset:14336
    s_add_u32 s50, s50, 32768
    v_add_f32 v226, v208, v209
    v_cvt_pk_bf16_f32 v192, v208, v209
    v_exp_f32 v211, v131
    v_mfma_f32_32x32x16_bf16 a[0:15], a[164:167], v[204:207], a[0:15]
    ds_read_b128 a[164:167], v8 offset:9216
    s_and_b32 s50, s50, 0x1ffff
    v_add_f32 v226, v226, v210
    v_exp_f32 v212, v132
    v_mfma_f32_32x32x16_bf16 a[16:31], a[172:175], v[204:207], a[16:31]
    ds_read_b128 a[172:175], v8 offset:11264
    v_add_f32 v226, v226, v211
    v_cvt_pk_bf16_f32 v193, v210, v211
    v_exp_f32 v213, v133
    v_mfma_f32_32x32x16_bf16 a[32:47], a[180:183], v[204:207], a[32:47]
    ds_read_b128 a[180:183], v8 offset:13312
    v_add_f32 v226, v226, v212
    v_exp_f32 v214, v134
    v_add_f32 v226, v226, v213
    v_cvt_pk_bf16_f32 v194, v212, v213
    v_mfma_f32_32x32x16_bf16 a[48:63], a[188:191], v[204:207], a[48:63]
    ds_read_b128 a[188:191], v8 offset:15360
    s_waitcnt vmcnt(8)
    s_barrier
    v_exp_f32 v215, v135
    s_waitcnt lgkmcnt(8)
    v_mfma_f32_32x32x16_bf16 v[144:159], a[128:131], v[64:67], v[176:191]
    ds_read_b128 a[128:131], v9
    s_mov_b32 m0, s50
    v_add_f32 v226, v226, v214
    v_exp_f32 v216, v136
    v_mfma_f32_32x32x16_bf16 v[144:159], a[132:135], v[68:71], v[144:159]
    ds_read_b128 a[132:135], v9 offset:1024
    buffer_load_dwordx4 v10, s[24:27], s49 offen sc1 lds
    v_add_f32 v226, v226, v215
    v_cvt_pk_bf16_f32 v195, v214, v215
    v_exp_f32 v217, v137
    v_mfma_f32_32x32x16_bf16 v[144:159], a[136:139], v[72:75], v[144:159]
    ds_read_b128 a[136:139], v9 offset:2048
    v_mov_b32 v12, v8
    v_add_f32 v226, v226, v216
    v_exp_f32 v218, v138
    v_mfma_f32_32x32x16_bf16 v[144:159], a[140:143], v[76:79], v[144:159]
    ds_read_b128 a[140:143], v9 offset:3072
    buffer_load_dwordx4 v10, s[24:27], s49 offen offset:1024 sc1 lds
    v_add_f32 v226, v226, v217
    v_exp_f32 v219, v139
    v_add_f32 v226, v226, v218
    v_mfma_f32_32x32x16_bf16 v[144:159], a[144:147], v[80:83], v[144:159]
    ds_read_b128 a[144:147], v9 offset:4096
    v_exp_f32 v220, v140
    v_add_f32 v226, v226, v219
    v_exp_f32 v221, v141
    v_mfma_f32_32x32x16_bf16 v[144:159], a[148:151], v[84:87], v[144:159]
    ds_read_b128 a[148:151], v9 offset:5120
    buffer_load_dwordx4 v10, s[24:27], s49 offen offset:2048 sc1 lds
    v_add_f32 v226, v226, v220
    v_exp_f32 v222, v142
    v_add_f32 v226, v226, v221
    v_mfma_f32_32x32x16_bf16 v[144:159], a[152:155], v[88:91], v[144:159]
    ds_read_b128 a[152:155], v9 offset:6144
    v_exp_f32 v223, v143
    v_add_f32 v226, v226, v222
    v_add_f32 v226, v226, v223
    v_cmp_lt_f32 vcc, s53, v226
    v_mfma_f32_32x32x16_bf16 v[144:159], a[156:159], v[92:95], v[144:159]
    ds_read_b128 a[156:159], v9 offset:7168
    buffer_load_dwordx4 v10, s[24:27], s49 offen offset:3072 sc1 lds
    s_cbranch_vccnz KA_STUB12
KA_RET12:
    s_waitcnt lgkmcnt(8)
    v_mfma_f32_32x32x16_bf16 a[0:15], a[160:163], v[192:195], a[0:15]
    ds_read_b128 a[160:163], v12 offset:24576
    v_add_f32 v224, v224, v226
    v_cvt_pk_bf16_f32 v196, v216, v217
    v_cvt_pk_bf16_f32 v197, v218, v219
    v_mfma_f32_32x32x16_bf16 a[16:31], a[168:171], v[192:195], a[16:31]
    ds_read_b128 a[168:171], v12 offset:26624
    v_cvt_pk_bf16_f32 v198, v220, v221
    v_cvt_pk_bf16_f32 v199, v222, v223
    v_exp_f32 v208, v144
    v_mfma_f32_32x32x16_bf16 a[32:47], a[176:179], v[192:195], a[32:47]
    ds_read_b128 a[176:179], v12 offset:28672
    v_mov_b32 v8, v9
    v_exp_f32 v209, v145
    v_exp_f32 v210, v146
    v_mfma_f32_32x32x16_bf16 a[48:63], a[184:187], v[192:195], a[48:63]
    ds_read_b128 a[184:187], v12 offset:30720
    v_add_u32 v9, 0x8000, v9
    v_add_f32 v226, v208, v209
    v_cvt_pk_bf16_f32 v200, v208, v209
    v_exp_f32 v211, v147
    v_mfma_f32_32x32x16_bf16 a[0:15], a[164:167], v[196:199], a[0:15]
    ds_read_b128 a[164:167], v12 offset:25600
    v_and_b32 v9, 0x1ffff, v9
    v_add_f32 v226, v226, v210
    v_exp_f32 v212, v148
    v_mfma_f32_32x32x16_bf16 a[16:31], a[172:175], v[196:199], a[16:31]
    ds_read_b128 a[172:175], v12 offset:27648
    v_add_f32 v226, v226, v211
    v_cvt_pk_bf16_f32 v201, v210, v211
    v_exp_f32 v213, v149
    v_add_f32 v226, v226, v212
    v_mfma_f32_32x32x16_bf16 a[32:47], a[180:183], v[196:199], a[32:47]
    ds_read_b128 a[180:183], v12 offset:29696
    v_exp_f32 v214, v150
    v_add_f32 v226, v226, v213
    v_cvt_pk_bf16_f32 v202, v212, v213
    v_exp_f32 v215, v151
    v_mfma_f32_32x32x16_bf16 a[48:63], a[188:191], v[196:199], a[48:63]
    ds_read_b128 a[188:191], v12 offset:31744
    v_add_f32 v226, v226, v214
    s_waitcnt lgkmcnt(8)
    s_sub_u32 s51, s51, 1
    s_cbranch_scc0 KA_SG_U
    s_mov_b32 s51, 1
    s_branch KA_SG_M
KA_TR_M:
    v_cmp_le_i32 s[72:73], 0, v229
    v_cmp_le_i32 s[74:75], 1, v229
    v_cmp_le_i32 s[76:77], 2, v229
    v_cmp_le_i32 s[78:79], 3, v229
    v_cndmask_b32 v160, v231, v227, s[72:73]
    v_cndmask_b32 v161, v231, v227, s[74:75]
    v_cndmask_b32 v162, v231, v227, s[76:77]
    v_cndmask_b32 v163, v231, v227, s[78:79]
    v_cmp_le_i32 s[72:73], 8, v229
    v_cmp_le_i32 s[74:75], 9, v229
    v_cmp_le_i32 s[76:77], 10, v229
    v_cmp_le_i32 s[78:79], 11, v229
    v_cndmask_b32 v164, v231, v227, s[72:73]
    v_cndmask_b32 v165, v231, v227, s[74:75]
    v_cndmask_b32 v166, v231, v227, s[76:77]
    v_cndmask_b32 v167, v231, v227, s[78:79]
    v_cmp_le_i32 s[72:73], 16, v229
    v_cmp_le_i32 s[74:75], 17, v229
    v_cmp_le_i32 s[76:77], 18, v229
    v_cmp_le_i32 s[78:79], 19, v229
    v_cndmask_b32 v168, v231, v227, s[72:73]
    v_cndmask_b32 v169, v231, v227, s[74:75]
    v_cndmask_b32 v170, v231, v227, s[76:77]
    v_cndmask_b32 v171, v231, v227, s[78:79]
    v_cmp_le_i32 s[72:73], 24, v229
    v_cmp_le_i32 s[74:75], 25, v229
    v_cmp_le_i32 s[76:77], 26, v229
    v_cmp_le_i32 s[78:79], 27, v229
    v_cndmask_b32 v172, v231, v227, s[72:73]
    v_cndmask_b32 v173, v231, v227, s[74:75]
    v_cndmask_b32 v174, v231, v227, s[76:77]
    v_cndmask_b32 v175, v231, v227, s[78:79]
    v_subrev_u32 v229, 32, v229
    s_nop 0
    v_mfma_f32_32x32x16_bf16 v[128:143], a[128:131], v[64:67], v[160:175]
    ds_read_b128 a[128:131], v8 offset:16384
    s_add_u32 m0, s50, 4096
    v_cmp_le_i32 s[72:73], 0, v229
    v_cmp_le_i32 s[74:75], 1, v229
    v_exp_f32 v216, v152
    v_add_f32 v226, v226, v215
    v_mfma_f32_32x32x16_bf16 v[128:143], a[132:135], v[68:71], v[128:143]
    ds_read_b128 a[132:135], v8 offset:17408
    buffer_load_dwordx4 v11, s[24:27], s49 offen sc1 lds
    v_cmp_le_i32 s[76:77], 2, v229
    v_cmp_le_i32 s[78:79], 3, v229
    v_cvt_pk_bf16_f32 v203, v214, v215
    v_exp_f32 v217, v153
    v_mfma_f32_32x32x16_bf16 v[128:143], a[136:139], v[72:75], v[128:143]
    ds_read_b128 a[136:139], v8 offset:18432
    v_cndmask_b32 v176, v231, v227, s[72:73]
    v_cndmask_b32 v177, v231, v227, s[74:75]
    v_cndmask_b32 v178, v231, v227, s[76:77]
    v_add_f32 v226, v226, v216
    v_exp_f32 v218, v154
    v_mfma_f32_32x32x16_bf16 v[128:143], a[140:143], v[76:79], v[128:143]
    ds_read_b128 a[140:143], v8 offset:19456
    buffer_load_dwordx4 v11, s[24:27], s49 offen offset:1024 sc1 lds
    v_cndmask_b32 v179, v231, v227, s[78:79]
    v_cmp_le_i32 s[72:73], 8, v229
    v_add_f32 v226, v226, v217
    v_exp_f32 v219, v155
    v_add_f32 v226, v226, v218
    v_mfma_f32_32x32x16_bf16 v[128:143], a[144:147], v[80:83], v[128:143]
    ds_read_b128 a[144:147], v8 offset:20480
    v_cmp_le_i32 s[74:75], 9, v229
    v_cmp_le_i32 s[76:77], 10, v229
    v_cmp_le_i32 s[78:79], 11, v229
    v_exp_f32 v220, v156
    v_add_f32 v226, v226, v219
    v_exp_f32 v221, v157
    v_mfma_f32_32x32x16_bf16 v[128:143], a[148:151], v[84:87], v[128:143]
    ds_read_b128 a[148:151], v8 offset:21504
    buffer_load_dwordx4 v11, s[24:27], s49 offen offset:2048 sc1 lds
    v_cndmask_b32 v180, v231, v227, s[72:73]
    v_cndmask_b32 v181, v231, v227, s[74:75]
    v_add_f32 v226, v226, v220
    v_exp_f32 v222, v158
    v_add_f32 v226, v226, v221
    v_mfma_f32_32x32x16_bf16 v[128:143], a[152:155], v[88:91], v[128:143]
    ds_read_b128 a[152:155], v8 offset:22528
    v_cndmask_b32 v182, v231, v227, s[76:77]
    v_cndmask_b32 v183, v231, v227, s[78:79]
    v_cmp_le_i32 s[72:73], 16, v229
    v_exp_f32 v223, v159
    v_add_f32 v226, v226, v222
    v_add_f32 v226, v226, v223
    v_cmp_lt_f32 vcc, s53, v226
    v_mfma_f32_32x32x16_bf16 v[128:143], a[156:159], v[92:95], v[128:143]
    ds_read_b128 a[156:159], v8 offset:23552
    buffer_load_dwordx4 v11, s[24:27], s49 offen offset:3072 sc1 lds
    s_cbranch_vccnz KA_STUB13
KA_RET13:
    v_cmp_le_i32 s[74:75], 17, v229
    s_waitcnt lgkmcnt(8)
    v_mfma_f32_32x32x16_bf16 a[64:79], a[160:163], v[200:203], a[64:79]
    ds_read_b128 a[160:163], v8 offset:8192
    v_add_f32 v225, v225, v226
    v_cvt_pk_bf16_f32 v204, v216, v217
    v_cvt_pk_bf16_f32 v205, v218, v219
    v_mfma_f32_32x32x16_bf16 a[80:95], a[168:171], v[200:203], a[80:95]
    ds_read_b128 a[168:171], v8 offset:10240
    v_cvt_pk_bf16_f32 v206, v220, v221
    v_cvt_pk_bf16_f32 v207, v222, v223
    v_cmp_le_i32 s[76:77], 18, v229
    v_exp_f32 v208, v128
    v_mfma_f32_32x32x16_bf16 a[96:111], a[176:179], v[200:203], a[96:111]
    ds_read_b128 a[176:179], v8 offset:12288
    s_add_u32 s49, s49, 32768
    v_cmp_le_i32 s[78:79], 19, v229
    v_cndmask_b32 v184, v231, v227, s[72:73]
    v_exp_f32 v209, v129
    v_mfma_f32_32x32x16_bf16 a[112:127], a[184:187], v[200:203], a[112:127]
    ds_read_b128 a[184:187], v8 offset:14336
    s_add_u32 s50, s50, 32768
    v_cndmask_b32 v185, v231, v227, s[74:75]
    v_cndmask_b32 v186, v231, v227, s[76:77]
    v_exp_f32 v210, v130
    v_add_f32 v226, v208, v209
    v_mfma_f32_32x32x16_bf16 a[64:79], a[164:167], v[204:207], a[64:79]
    ds_read_b128 a[164:167], v8 offset:9216
    s_and_b32 s50, s50, 0x1ffff
    v_cndmask_b32 v187, v231, v227, s[78:79]
    v_cmp_le_i32 s[72:73], 24, v229
    v_cvt_pk_bf16_f32 v192, v208, v209
    v_exp_f32 v211, v131
    v_mfma_f32_32x32x16_bf16 a[80:95], a[172:175], v[204:207], a[80:95]
    ds_read_b128 a[172:175], v8 offset:11264
    v_cmp_le_i32 s[74:75], 25, v229
    v_cmp_le_i32 s[76:77], 26, v229
    v_cmp_le_i32 s[78:79], 27, v229
    v_add_f32 v226, v226, v210
    v_exp_f32 v212, v132
    v_mfma_f32_32x32x16_bf16 a[96:111], a[180:183], v[204:207], a[96:111]
    ds_read_b128 a[180:183], v8 offset:13312
    v_cndmask_b32 v188, v231, v227, s[72:73]
    v_cndmask_b32 v189, v231, v227, s[74:75]
    v_cndmask_b32 v190, v231, v227, s[76:77]
    v_cndmask_b32 v191, v231, v227, s[78:79]
    v_add_f32 v226, v226, v211
    v_mfma_f32_32x32x16_bf16 a[112:127], a[188:191], v[204:207], a[112:127]
    ds_read_b128 a[188:191], v8 offset:15360
    s_waitcnt vmcnt(8)
    s_barrier
    v_cvt_pk_bf16_f32 v193, v210, v211
    v_exp_f32 v213, v133
    s_waitcnt lgkmcnt(8)
    v_mfma_f32_32x32x16_bf16 v[144:159], a[128:131], v[64:67], v[176:191]
    ds_read_b128 a[128:131], v9
    s_mov_b32 m0, s50
    v_add_f32 v226, v226, v212
    v_exp_f32 v214, v134
    v_add_f32 v226, v226, v213
    v_cvt_pk_bf16_f32 v194, v212, v213
    v_mfma_f32_32x32x16_bf16 v[144:159], a[132:135], v[68:71], v[144:159]
    ds_read_b128 a[132:135], v9 offset:1024
    buffer_load_dwordx4 v10, s[24:27], s49 offen sc1 lds
    v_exp_f32 v215, v135
    v_add_f32 v226, v226, v214
    v_exp_f32 v216, v136
    v_mfma_f32_32x32x16_bf16 v[144:159], a[136:139], v[72:75], v[144:159]
    ds_read_b128 a[136:139], v9 offset:2048
    v_mov_b32 v12, v8
    v_add_f32 v226, v226, v215
    v_cvt_pk_bf16_f32 v195, v214, v215
    v_exp_f32 v217, v137
    v_mfma_f32_32x32x16_bf16 v[144:159], a[140:143], v[76:79], v[144:159]
    ds_read_b128 a[140:143], v9 offset:3072
    buffer_load_dwordx4 v10, s[24:27], s49 offen offset:1024 sc1 lds
    v_add_f32 v226, v226, v216
    v_exp_f32 v218, v138
    v_add_f32 v226, v226, v217
    v_mfma_f32_32x32x16_bf16 v[144:159], a[144:147], v[80:83], v[144:159]
    ds_read_b128 a[144:147], v9 offset:4096
    v_exp_f32 v219, v139
    v_add_f32 v226, v226, v218
    v_exp_f32 v220, v140
    v_add_f32 v226, v226, v219
    v_mfma_f32_32x32x16_bf16 v[144:159], a[148:151], v[84:87], v[144:159]
    ds_read_b128 a[148:151], v9 offset:5120
    buffer_load_dwordx4 v10, s[24:27], s49 offen offset:2048 sc1 lds
    v_exp_f32 v221, v141
    v_add_f32 v226, v226, v220
    v_exp_f32 v222, v142
    v_mfma_f32_32x32x16_bf16 v[144:159], a[152:155], v[88:91], v[144:159]
    ds_read_b128 a[152:155], v9 offset:6144
    v_add_f32 v226, v226, v221
    v_exp_f32 v223, v143
    v_add_f32 v226, v226, v222
    v_add_f32 v226, v226, v223
    v_cmp_lt_f32 vcc, s53, v226
    v_mfma_f32_32x32x16_bf16 v[144:159], a[156:159], v[92:95], v[144:159]
    ds_read_b128 a[156:159], v9 offset:7168
    buffer_load_dwordx4 v10, s[24:27], s49 offen offset:3072 sc1 lds
    s_cbranch_vccnz KA_STUB14
KA_RET14:
    s_waitcnt lgkmcnt(8)
    v_mfma_f32_32x32x16_bf16 a[0:15], a[160:163], v[192:195], a[0:15]
    ds_read_b128 a[160:163], v12 offset:24576
    v_add_f32 v224, v224, v226
    v_cvt_pk_bf16_f32 v196, v216, v217
    v_cvt_pk_bf16_f32 v197, v218, v219
    v_mfma_f32_32x32x16_bf16 a[16:31], a[168:171], v[192:195], a[16:31]
    ds_read_b128 a[168:171], v12 offset:26624
    v_cvt_pk_bf16_f32 v198, v220, v221
    v_cvt_pk_bf16_f32 v199, v222, v223
    v_exp_f32 v208, v144
    v_mfma_f32_32x32x16_bf16 a[32:47], a[176:179], v[192:195], a[32:47]
    ds_read_b128 a[176:179], v12 offset:28672
    v_mov_b32 v8, v9
    v_exp_f32 v209, v145
    v_exp_f32 v210, v146
    v_mfma_f32_32x32x16_bf16 a[48:63], a[184:187], v[192:195], a[48:63]
    ds_read_b128 a[184:187], v12 offset:30720
    v_add_u32 v9, 0x8000, v9
    v_add_f32 v226, v208, v209
    v_cvt_pk_bf16_f32 v200, v208, v209
    v_exp_f32 v211, v147
    v_mfma_f32_32x32x16_bf16 a[0:15], a[164:167], v[196:199], a[0:15]
    ds_read_b128 a[164:167], v12 offset:25600
    v_and_b32 v9, 0x1ffff, v9
    v_add_f32 v226, v226, v210
    v_exp_f32 v212, v148
    v_mfma_f32_32x32x16_bf16 a[16:31], a[172:175], v[196:199], a[16:31]
    ds_read_b128 a[172:175], v12 offset:27648
    v_add_f32 v226, v226, v211
    v_cvt_pk_bf16_f32 v201, v210, v211
    v_exp_f32 v213, v149
    v_add_f32 v226, v226, v212
    v_mfma_f32_32x32x16_bf16 a[32:47], a[180:183], v[196:199], a[32:47]
    ds_read_b128 a[180:183], v12 offset:29696
    v_subrev_u32 v229, 32, v229
    v_exp_f32 v214, v150
    v_add_f32 v226, v226, v213
    v_cvt_pk_bf16_f32 v202, v212, v213
    v_mfma_f32_32x32x16_bf16 a[48:63], a[188:191], v[196:199], a[48:63]
    ds_read_b128 a[188:191], v12 offset:31744
    v_exp_f32 v215, v151
    v_add_f32 v226, v226, v214
    s_waitcnt lgkmcnt(8)
    s_mov_b32 s51, 0
    s_branch KA_EPB
KA_SG_M:
    v_cmp_le_i32 s[72:73], 0, v229
    v_cmp_le_i32 s[74:75], 1, v229
    v_cmp_le_i32 s[76:77], 2, v229
    v_cmp_le_i32 s[78:79], 3, v229
    v_cndmask_b32 v160, v231, v227, s[72:73]
    v_cndmask_b32 v161, v231, v227, s[74:75]
    v_cndmask_b32 v162, v231, v227, s[76:77]
    v_cndmask_b32 v163, v231, v227, s[78:79]
    v_cmp_le_i32 s[72:73], 8, v229
    v_cmp_le_i32 s[74:75], 9, v229
    v_cmp_le_i32 s[76:77], 10, v229
    v_cmp_le_i32 s[78:79], 11, v229
    v_cndmask_b32 v164, v231, v227, s[72:73]
    v_cndmask_b32 v165, v231, v227, s[74:75]
    v_cndmask_b32 v166, v231, v227, s[76:77]
    v_cndmask_b32 v167, v231, v227, s[78:79]
    v_cmp_le_i32 s[72:73], 16, v229
    v_cmp_le_i32 s[74:75], 17, v229
    v_cmp_le_i32 s[76:77], 18, v229
    v_cmp_le_i32 s[78:79], 19, v229
    v_cndmask_b32 v168, v231, v227, s[72:73]
    v_cndmask_b32 v169, v231, v227, s[74:75]
    v_cndmask_b32 v170, v231, v227, s[76:77]
    v_cndmask_b32 v171, v231, v227, s[78:79]
    v_cmp_le_i32 s[72:73], 24, v229
    v_cmp_le_i32 s[74:75], 25, v229
    v_cmp_le_i32 s[76:77], 26, v229
    v_cmp_le_i32 s[78:79], 27, v229
    v_cndmask_b32 v172, v231, v227, s[72:73]
    v_cndmask_b32 v173, v231, v227, s[74:75]
    v_cndmask_b32 v174, v231, v227, s[76:77]
    v_cndmask_b32 v175, v231, v227, s[78:79]
    v_subrev_u32 v229, 32, v229
    s_nop 0
    v_mfma_f32_32x32x16_bf16 v[128:143], a[128:131], v[64:67], v[160:175]
    ds_read_b128 a[128:131], v8 offset:16384
    s_add_u32 m0, s50, 4096
    v_cmp_le_i32 s[72:73], 0, v229
    v_cmp_le_i32 s[74:75], 1, v229
    v_exp_f32 v216, v152
    v_add_f32 v226, v226, v215
    v_mfma_f32_32x32x16_bf16 v[128:143], a[132:135], v[68:71], v[128:143]
    ds_read_b128 a[132:135], v8 offset:17408
    buffer_load_dwordx4 v11, s[24:27], s49 offen sc1 lds
    v_cmp_le_i32 s[76:77], 2, v229
    v_cmp_le_i32 s[78:79], 3, v229
    v_cvt_pk_bf16_f32 v203, v214, v215
    v_exp_f32 v217, v153
    v_mfma_f32_32x32x16_bf16 v[128:143], a[136:139], v[72:75], v[128:143]
    ds_read_b128 a[136:139], v8 offset:18432
    v_cndmask_b32 v176, v231, v227, s[72:73]
    v_cndmask_b32 v177, v231, v227, s[74:75]
    v_cndmask_b32 v178, v231, v227, s[76:77]
    v_add_f32 v226, v226, v216
    v_exp_f32 v218, v154
    v_mfma_f32_32x32x16_bf16 v[128:143], a[140:143], v[76:79], v[128:143]
    ds_read_b128 a[140:143], v8 offset:19456
    buffer_load_dwordx4 v11, s[24:27], s49 offen offset:1024 sc1 lds
    v_cndmask_b32 v179, v231, v227, s[78:79]
    v_cmp_le_i32 s[72:73], 8, v229
    v_add_f32 v226, v226, v217
    v_exp_f32 v219, v155
    v_add_f32 v226, v226, v218
    v_mfma_f32_32x32x16_bf16 v[128:143], a[144:147], v[80:83], v[128:143]
    ds_read_b128 a[144:147], v8 offset:20480
    v_cmp_le_i32 s[74:75], 9, v229
    v_cmp_le_i32 s[76:77], 10, v229
    v_cmp_le_i32 s[78:79], 11, v229
    v_exp_f32 v220, v156
    v_add_f32 v226, v226, v219
    v_exp_f32 v221, v157
    v_mfma_f32_32x32x16_bf16 v[128:143], a[148:151], v[84:87], v[128:143]
    ds_read_b128 a[148:151], v8 offset:21504
    buffer_load_dwordx4 v11, s[24:27], s49 offen offset:2048 sc1 lds
    v_cndmask_b32 v180, v231, v227, s[72:73]
    v_cndmask_b32 v181, v231, v227, s[74:75]
    v_add_f32 v226, v226, v220
    v_exp_f32 v222, v158
    v_add_f32 v226, v226, v221
    v_mfma_f32_32x32x16_bf16 v[128:143], a[152:155], v[88:91], v[128:143]
    ds_read_b128 a[152:155], v8 offset:22528
    v_cndmask_b32 v182, v231, v227, s[76:77]
    v_cndmask_b32 v183, v231, v227, s[78:79]
    v_cmp_le_i32 s[72:73], 16, v229
    v_exp_f32 v223, v159
    v_add_f32 v226, v226, v222
    v_add_f32 v226, v226, v223
    v_cmp_lt_f32 vcc, s53, v226
    v_mfma_f32_32x32x16_bf16 v[128:143], a[156:159], v[92:95], v[128:143]
    ds_read_b128 a[156:159], v8 offset:23552
    buffer_load_dwordx4 v11, s[24:27], s49 offen offset:3072 sc1 lds
    s_cbranch_vccnz KA_STUB15
KA_RET15:
    v_cmp_le_i32 s[74:75], 17, v229
    s_waitcnt lgkmcnt(8)
    v_mfma_f32_32x32x16_bf16 a[0:15], a[160:163], v[200:203], a[0:15]
    ds_read_b128 a[160:163], v8 offset:8192
    v_add_f32 v224, v224, v226
    v_cvt_pk_bf16_f32 v204, v216, v217
    v_cvt_pk_bf16_f32 v205, v218, v219
    v_mfma_f32_32x32x16_bf16 a[16:31], a[168:171], v[200:203], a[16:31]
    ds_read_b128 a[168:171], v8 offset:10240
    v_cvt_pk_bf16_f32 v206, v220, v221
    v_cvt_pk_bf16_f32 v207, v222, v223
    v_cmp_le_i32 s[76:77], 18, v229
    v_exp_f32 v208, v128
    v_mfma_f32_32x32x16_bf16 a[32:47], a[176:179], v[200:203], a[32:47]
    ds_read_b128 a[176:179], v8 offset:12288
    s_add_u32 s49, s49, 32768
    v_cmp_le_i32 s[78:79], 19, v229
    v_cndmask_b32 v184, v231, v227, s[72:73]
    v_exp_f32 v209, v129
    v_mfma_f32_32x32x16_bf16 a[48:63], a[184:187], v[200:203], a[48:63]
    ds_read_b128 a[184:187], v8 offset:14336
    s_add_u32 s50, s50, 32768
    v_cndmask_b32 v185, v231, v227, s[74:75]
    v_cndmask_b32 v186, v231, v227, s[76:77]
    v_exp_f32 v210, v130
    v_add_f32 v226, v208, v209
    v_mfma_f32_32x32x16_bf16 a[0:15], a[164:167], v[204:207], a[0:15]
    ds_read_b128 a[164:167], v8 offset:9216
    s_and_b32 s50, s50, 0x1ffff
    v_cndmask_b32 v187, v231, v227, s[78:79]
    v_cmp_le_i32 s[72:73], 24, v229
    v_cvt_pk_bf16_f32 v192, v208, v209
    v_exp_f32 v211, v131
    v_mfma_f32_32x32x16_bf16 a[16:31], a[172:175], v[204:207], a[16:31]
    ds_read_b128 a[172:175], v8 offset:11264
    v_cmp_le_i32 s[74:75], 25, v229
    v_cmp_le_i32 s[76:77], 26, v229
    v_cmp_le_i32 s[78:79], 27, v229
    v_add_f32 v226, v226, v210
    v_exp_f32 v212, v132
    v_mfma_f32_32x32x16_bf16 a[32:47], a[180:183], v[204:207], a[32:47]
    ds_read_b128 a[180:183], v8 offset:13312
    v_cndmask_b32 v188, v231, v227, s[72:73]
    v_cndmask_b32 v189, v231, v227, s[74:75]
    v_cndmask_b32 v190, v231, v227, s[76:77]
    v_cndmask_b32 v191, v231, v227, s[78:79]
    v_add_f32 v226, v226, v211
    v_mfma_f32_32x32x16_bf16 a[48:63], a[188:191], v[204:207], a[48:63]
    ds_read_b128 a[188:191], v8 offset:15360
    s_waitcnt vmcnt(8)
    s_barrier
    v_cvt_pk_bf16_f32 v193, v210, v211
    v_exp_f32 v213, v133
    s_waitcnt lgkmcnt(8)
    v_mfma_f32_32x32x16_bf16 v[144:159], a[128:131], v[64:67], v[176:191]
    ds_read_b128 a[128:131], v9
    s_mov_b32 m0, s50
    v_add_f32 v226, v226, v212
    v_exp_f32 v214, v134
    v_add_f32 v226, v226, v213
    v_cvt_pk_bf16_f32 v194, v212, v213
    v_mfma_f32_32x32x16_bf16 v[144:159], a[132:135], v[68:71], v[144:159]
    ds_read_b128 a[132:135], v9 offset:1024
    buffer_load_dwordx4 v10, s[24:27], s49 offen sc1 lds
    v_exp_f32 v215, v135
    v_add_f32 v226, v226, v214
    v_exp_f32 v216, v136
    v_mfma_f32_32x32x16_bf16 v[144:159], a[136:139], v[72:75], v[144:159]
    ds_read_b128 a[136:139], v9 offset:2048
    v_mov_b32 v12, v8
    v_add_f32 v226, v226, v215
    v_cvt_pk_bf16_f32 v195, v214, v215
    v_exp_f32 v217, v137
    v_mfma_f32_32x32x16_bf16 v[144:159], a[140:143], v[76:79], v[144:159]
    ds_read_b128 a[140:143], v9 offset:3072
    buffer_load_dwordx4 v10, s[24:27], s49 offen offset:1024 sc1 lds
    v_add_f32 v226, v226, v216
    v_exp_f32 v218, v138
    v_add_f32 v226, v226, v217
    v_mfma_f32_32x32x16_bf16 v[144:159], a[144:147], v[80:83], v[144:159]
    ds_read_b128 a[144:147], v9 offset:4096
    v_exp_f32 v219, v139
    v_add_f32 v226, v226, v218
    v_exp_f32 v220, v140
    v_add_f32 v226, v226, v219
    v_mfma_f32_32x32x16_bf16 v[144:159], a[148:151], v[84:87], v[144:159]
    ds_read_b128 a[148:151], v9 offset:5120
    buffer_load_dwordx4 v10, s[24:27], s49 offen offset:2048 sc1 lds
    v_exp_f32 v221, v141
    v_add_f32 v226, v226, v220
    v_exp_f32 v222, v142
    v_mfma_f32_32x32x16_bf16 v[144:159], a[152:155], v[88:91], v[144:159]
    ds_read_b128 a[152:155], v9 offset:6144
    v_add_f32 v226, v226, v221
    v_exp_f32 v223, v143
    v_add_f32 v226, v226, v222
    v_add_f32 v226, v226, v223
    v_cmp_lt_f32 vcc, s53, v226
    v_mfma_f32_32x32x16_bf16 v[144:159], a[156:159], v[92:95], v[144:159]
    ds_read_b128 a[156:159], v9 offset:7168
    buffer_load_dwordx4 v10, s[24:27], s49 offen offset:3072 sc1 lds
    s_cbranch_vccnz KA_STUB16
KA_RET16:
    s_waitcnt lgkmcnt(8)
    v_mfma_f32_32x32x16_bf16 a[0:15], a[160:163], v[192:195], a[0:15]
    ds_read_b128 a[160:163], v12 offset:24576
    v_add_f32 v224, v224, v226
    v_cvt_pk_bf16_f32 v196, v216, v217
    v_cvt_pk_bf16_f32 v197, v218, v219
    v_mfma_f32_32x32x16_bf16 a[16:31], a[168:171], v[192:195], a[16:31]
    ds_read_b128 a[168:171], v12 offset:26624
    v_cvt_pk_bf16_f32 v198, v220, v221
    v_cvt_pk_bf16_f32 v199, v222, v223
    v_exp_f32 v208, v144
    v_mfma_f32_32x32x16_bf16 a[32:47], a[176:179], v[192:195], a[32:47]
    ds_read_b128 a[176:179], v12 offset:28672
    v_mov_b32 v8, v9
    v_exp_f32 v209, v145
    v_exp_f32 v210, v146
    v_mfma_f32_32x32x16_bf16 a[48:63], a[184:187], v[192:195], a[48:63]
    ds_read_b128 a[184:187], v12 offset:30720
    v_add_u32 v9, 0x8000, v9
    v_add_f32 v226, v208, v209
    v_cvt_pk_bf16_f32 v200, v208, v209
    v_exp_f32 v211, v147
    v_mfma_f32_32x32x16_bf16 a[0:15], a[164:167], v[196:199], a[0:15]
    ds_read_b128 a[164:167], v12 offset:25600
    v_and_b32 v9, 0x1ffff, v9
    v_add_f32 v226, v226, v210
    v_exp_f32 v212, v148
    v_add_f32 v226, v226, v211
    v_mfma_f32_32x32x16_bf16 a[16:31], a[172:175], v[196:199], a[16:31]
    ds_read_b128 a[172:175], v12 offset:27648
    v_cvt_pk_bf16_f32 v201, v210, v211
    v_exp_f32 v213, v149
    v_add_f32 v226, v226, v212
    v_exp_f32 v214, v150
    v_mfma_f32_32x32x16_bf16 a[32:47], a[180:183], v[196:199], a[32:47]
    ds_read_b128 a[180:183], v12 offset:29696
    v_subrev_u32 v229, 32, v229
    v_add_f32 v226, v226, v213
    v_cvt_pk_bf16_f32 v202, v212, v213
    v_exp_f32 v215, v151
    v_mfma_f32_32x32x16_bf16 a[48:63], a[188:191], v[196:199], a[48:63]
    ds_read_b128 a[188:191], v12 offset:31744
    v_add_f32 v226, v226, v214
    s_waitcnt lgkmcnt(8)
    s_sub_u32 s51, s51, 1
    s_cbranch_scc0 KA_SG_M
KA_DRAIN:
    v_exp_f32 v216, v152
    v_add_f32 v226, v226, v215
    v_cvt_pk_bf16_f32 v203, v214, v215
    v_exp_f32 v217, v153
    v_add_f32 v226, v226, v216
    v_exp_f32 v218, v154
    v_add_f32 v226, v226, v217
    v_exp_f32 v219, v155
    v_add_f32 v226, v226, v218
    v_exp_f32 v220, v156
    v_add_f32 v226, v226, v219
    v_exp_f32 v221, v157
    v_add_f32 v226, v226, v220
    v_exp_f32 v222, v158
    v_add_f32 v226, v226, v221
    v_exp_f32 v223, v159
    v_add_f32 v226, v226, v222
    v_add_f32 v226, v226, v223
    v_cmp_lt_f32 vcc, s53, v226
    s_nop 1
    s_cbranch_vccnz KA_STUB17
KA_RET17:
    v_add_f32 v224, v224, v226
    v_cvt_pk_bf16_f32 v204, v216, v217
    v_cvt_pk_bf16_f32 v205, v218, v219
    v_cvt_pk_bf16_f32 v206, v220, v221
    v_cvt_pk_bf16_f32 v207, v222, v223
    s_nop 1
    s_waitcnt lgkmcnt(7)
    v_mfma_f32_32x32x16_bf16 a[0:15], a[160:163], v[200:203], a[0:15]
    s_waitcnt lgkmcnt(6)
    v_mfma_f32_32x32x16_bf16 a[16:31], a[168:171], v[200:203], a[16:31]
    s_waitcnt lgkmcnt(5)
    v_mfma_f32_32x32x16_bf16 a[32:47], a[176:179], v[200:203], a[32:47]
    s_waitcnt lgkmcnt(4)
    v_mfma_f32_32x32x16_bf16 a[48:63], a[184:187], v[200:203], a[48:63]
    s_waitcnt lgkmcnt(3)
    v_mfma_f32_32x32x16_bf16 a[0:15], a[164:167], v[204:207], a[0:15]
    s_waitcnt lgkmcnt(2)
    v_mfma_f32_32x32x16_bf16 a[16:31], a[172:175], v[204:207], a[16:31]
    s_waitcnt lgkmcnt(1)
    v_mfma_f32_32x32x16_bf16 a[32:47], a[180:183], v[204:207], a[32:47]
    s_waitcnt lgkmcnt(0)
    v_mfma_f32_32x32x16_bf16 a[48:63], a[188:191], v[204:207], a[48:63]
    s_nop 7
    s_lshl_b32 s64, s44, 13
    s_lshl_b32 s65, s55, 3
    s_add_u32 s65, s65, s64
    v_mov_b32 v232, v224
    s_nop 1
    v_permlane32_swap_b32 v224, v232
    s_nop 1
    v_add_f32 v224, v224, v232
    v_rcp_f32 v234, v224
    s_nop 0
    v_mov_b32 v235, v234
    v_accvgpr_read_b32 v128, a0
    v_accvgpr_read_b32 v129, a1
    v_accvgpr_read_b32 v130, a2
    v_accvgpr_read_b32 v131, a3
    v_accvgpr_read_b32 v132, a4
    v_accvgpr_read_b32 v133, a5
    v_accvgpr_read_b32 v134, a6
    v_accvgpr_read_b32 v135, a7
    v_pk_mul_f32 v[128:129], v[128:129], v[234:235]
    v_pk_mul_f32 v[130:131], v[130:131], v[234:235]
    v_pk_mul_f32 v[132:133], v[132:133], v[234:235]
    v_pk_mul_f32 v[134:135], v[134:135], v[234:235]
    v_cvt_pk_bf16_f32 v160, v128, v129
    v_cvt_pk_bf16_f32 v161, v130, v131
    v_cvt_pk_bf16_f32 v162, v132, v133
    v_cvt_pk_bf16_f32 v163, v134, v135
    s_add_u32 s67, s65, 0
    buffer_store_dwordx4 v[160:163], v5, s[36:39], s67 offen sc1
    v_accvgpr_read_b32 v136, a8
    v_accvgpr_read_b32 v137, a9
    v_accvgpr_read_b32 v138, a10
    v_accvgpr_read_b32 v139, a11
    v_accvgpr_read_b32 v140, a12
    v_accvgpr_read_b32 v141, a13
    v_accvgpr_read_b32 v142, a14
    v_accvgpr_read_b32 v143, a15
    v_pk_mul_f32 v[136:137], v[136:137], v[234:235]
    v_pk_mul_f32 v[138:139], v[138:139], v[234:235]
    v_pk_mul_f32 v[140:141], v[140:141], v[234:235]
    v_pk_mul_f32 v[142:143], v[142:143], v[234:235]
    v_cvt_pk_bf16_f32 v164, v136, v137
    v_cvt_pk_bf16_f32 v165, v138, v139
    v_cvt_pk_bf16_f32 v166, v140, v141
    v_cvt_pk_bf16_f32 v167, v142, v143
    s_add_u32 s67, s65, 0
    buffer_store_dwordx4 v[164:167], v5, s[36:39], s67 offen offset:1024 sc1
    v_accvgpr_read_b32 v144, a16
    v_accvgpr_read_b32 v145, a17
    v_accvgpr_read_b32 v146, a18
    v_accvgpr_read_b32 v147, a19
    v_accvgpr_read_b32 v148, a20
    v_accvgpr_read_b32 v149, a21
    v_accvgpr_read_b32 v150, a22
    v_accvgpr_read_b32 v151, a23
    v_pk_mul_f32 v[144:145], v[144:145], v[234:235]
    v_pk_mul_f32 v[146:147], v[146:147], v[234:235]
    v_pk_mul_f32 v[148:149], v[148:149], v[234:235]
    v_pk_mul_f32 v[150:151], v[150:151], v[234:235]
    v_cvt_pk_bf16_f32 v168, v144, v145
    v_cvt_pk_bf16_f32 v169, v146, v147
    v_cvt_pk_bf16_f32 v170, v148, v149
    v_cvt_pk_bf16_f32 v171, v150, v151
    s_add_u32 s67, s65, 0
    buffer_store_dwordx4 v[168:171], v5, s[36:39], s67 offen offset:2048 sc1
    v_accvgpr_read_b32 v152, a24
    v_accvgpr_read_b32 v153, a25
    v_accvgpr_read_b32 v154, a26
    v_accvgpr_read_b32 v155, a27
    v_accvgpr_read_b32 v156, a28
    v_accvgpr_read_b32 v157, a29
    v_accvgpr_read_b32 v158, a30
    v_accvgpr_read_b32 v159, a31
    v_pk_mul_f32 v[152:153], v[152:153], v[234:235]
    v_pk_mul_f32 v[154:155], v[154:155], v[234:235]
    v_pk_mul_f32 v[156:157], v[156:157], v[234:235]
    v_pk_mul_f32 v[158:159], v[158:159], v[234:235]
    v_cvt_pk_bf16_f32 v172, v152, v153
    v_cvt_pk_bf16_f32 v173, v154, v155
    v_cvt_pk_bf16_f32 v174, v156, v157
    v_cvt_pk_bf16_f32 v175, v158, v159
    s_add_u32 s67, s65, 0
    buffer_store_dwordx4 v[172:175], v5, s[36:39], s67 offen offset:3072 sc1
    v_accvgpr_read_b32 v128, a32
    v_accvgpr_read_b32 v129, a33
    v_accvgpr_read_b32 v130, a34
    v_accvgpr_read_b32 v131, a35
    v_accvgpr_read_b32 v132, a36
    v_accvgpr_read_b32 v133, a37
    v_accvgpr_read_b32 v134, a38
    v_accvgpr_read_b32 v135, a39
    v_pk_mul_f32 v[128:129], v[128:129], v[234:235]
    v_pk_mul_f32 v[130:131], v[130:131], v[234:235]
    v_pk_mul_f32 v[132:133], v[132:133], v[234:235]
    v_pk_mul_f32 v[134:135], v[134:135], v[234:235]
    v_cvt_pk_bf16_f32 v176, v128, v129
    v_cvt_pk_bf16_f32 v177, v130, v131
    v_cvt_pk_bf16_f32 v178, v132, v133
    v_cvt_pk_bf16_f32 v179, v134, v135
    s_add_u32 s67, s65, 4096
    buffer_store_dwordx4 v[176:179], v5, s[36:39], s67 offen sc1
    v_accvgpr_read_b32 v136, a40
    v_accvgpr_read_b32 v137, a41
    v_accvgpr_read_b32 v138, a42
    v_accvgpr_read_b32 v139, a43
    v_accvgpr_read_b32 v140, a44
    v_accvgpr_read_b32 v141, a45
    v_accvgpr_read_b32 v142, a46
    v_accvgpr_read_b32 v143, a47
    v_pk_mul_f32 v[136:137], v[136:137], v[234:235]
    v_pk_mul_f32 v[138:139], v[138:139], v[234:235]
    v_pk_mul_f32 v[140:141], v[140:141], v[234:235]
    v_pk_mul_f32 v[142:143], v[142:143], v[234:235]
    v_cvt_pk_bf16_f32 v180, v136, v137
    v_cvt_pk_bf16_f32 v181, v138, v139
    v_cvt_pk_bf16_f32 v182, v140, v141
    v_cvt_pk_bf16_f32 v183, v142, v143
    s_add_u32 s67, s65, 4096
    buffer_store_dwordx4 v[180:183], v5, s[36:39], s67 offen offset:1024 sc1
    v_accvgpr_read_b32 v144, a48
    v_accvgpr_read_b32 v145, a49
    v_accvgpr_read_b32 v146, a50
    v_accvgpr_read_b32 v147, a51
    v_accvgpr_read_b32 v148, a52
    v_accvgpr_read_b32 v149, a53
    v_accvgpr_read_b32 v150, a54
    v_accvgpr_read_b32 v151, a55
    v_pk_mul_f32 v[144:145], v[144:145], v[234:235]
    v_pk_mul_f32 v[146:147], v[146:147], v[234:235]
    v_pk_mul_f32 v[148:149], v[148:149], v[234:235]
    v_pk_mul_f32 v[150:151], v[150:151], v[234:235]
    v_cvt_pk_bf16_f32 v184, v144, v145
    v_cvt_pk_bf16_f32 v185, v146, v147
    v_cvt_pk_bf16_f32 v186, v148, v149
    v_cvt_pk_bf16_f32 v187, v150, v151
    s_add_u32 s67, s65, 4096
    buffer_store_dwordx4 v[184:187], v5, s[36:39], s67 offen offset:2048 sc1
    v_accvgpr_read_b32 v152, a56
    v_accvgpr_read_b32 v153, a57
    v_accvgpr_read_b32 v154, a58
    v_accvgpr_read_b32 v155, a59
    v_accvgpr_read_b32 v156, a60
    v_accvgpr_read_b32 v157, a61
    v_accvgpr_read_b32 v158, a62
    v_accvgpr_read_b32 v159, a63
    v_pk_mul_f32 v[152:153], v[152:153], v[234:235]
    v_pk_mul_f32 v[154:155], v[154:155], v[234:235]
    v_pk_mul_f32 v[156:157], v[156:157], v[234:235]
    v_pk_mul_f32 v[158:159], v[158:159], v[234:235]
    v_cvt_pk_bf16_f32 v188, v152, v153
    v_cvt_pk_bf16_f32 v189, v154, v155
    v_cvt_pk_bf16_f32 v190, v156, v157
    v_cvt_pk_bf16_f32 v191, v158, v159
    s_add_u32 s67, s65, 4096
    buffer_store_dwordx4 v[188:191], v5, s[36:39], s67 offen offset:3072 sc1
KA_END:
KA_EXIT:
    s_endpgm
KA_SP0:
    s_mov_b32 s62, 262144
KA_SP0_L:
    buffer_load_dword v57, v58, s[40:43], 0 offen sc1
    s_waitcnt vmcnt(0)
    v_cmp_gt_u32 vcc, 1, v57
    s_nop 0
    s_cbranch_vccz KA_SP0_R
    s_sub_u32 s62, s62, 1
    s_cbranch_scc0 KA_SP0_L
    s_branch KA_SP0_R
KA_SP1:
    s_mov_b32 s62, 262144
KA_SP1_L:
    buffer_load_dword v57, v58, s[32:35], 0 offen sc1
    s_waitcnt vmcnt(0)
    v_cmp_gt_u32 vcc, v1, v57
    s_nop 0
    s_cbranch_vccz KA_SP1_R
    s_sub_u32 s62, s62, 1
    s_cbranch_scc0 KA_SP1_L
    s_branch KA_SP1_R
KA_SP2:
    s_mov_b32 s62, 262144
KA_SP2_L:
    buffer_load_dword v57, v58, s[32:35], 0 offen sc1
    s_waitcnt vmcnt(0)
    v_cmp_gt_u32 vcc, 8, v57
    s_nop 0
    s_cbranch_vccz KA_SP2_R
    s_sub_u32 s62, s62, 1
    s_cbranch_scc0 KA_SP2_L
    s_branch KA_SP2_R
KA_STUB1:
    s_mov_b32 s52, 1
    s_branch KA_FIX_S1b
KA_STUB3:
    s_mov_b32 s52, 3
    s_branch KA_FIX_S1b
KA_STUB5:
    s_mov_b32 s52, 5
    s_branch KA_FIX_S1b
KA_STUB7:
    s_mov_b32 s52, 7
    s_branch KA_FIX_S1b
KA_STUB2:
    s_mov_b32 s52, 2
    s_branch KA_FIX_S0a
KA_STUB4:
    s_mov_b32 s52, 4
    s_branch KA_FIX_S0a
KA_STUB6:
    s_mov_b32 s52, 6
    s_branch KA_FIX_S0a
KA_STUB8:
    s_mov_b32 s52, 8
    s_branch KA_FIX_S0a
KA_STUB9:
    s_mov_b32 s52, 9
    s_branch KA_FIX_S1bn
KA_STUB13:
    s_mov_b32 s52, 13
    s_branch KA_FIX_S1bn
KA_STUB10:
    s_mov_b32 s52, 10
    s_branch KA_FIX_S0s
KA_STUB12:
    s_mov_b32 s52, 12
    s_branch KA_FIX_S0s
KA_STUB14:
    s_mov_b32 s52, 14
    s_branch KA_FIX_S0s
KA_STUB16:
    s_mov_b32 s52, 16
    s_branch KA_FIX_S0s
KA_STUB11:
    s_mov_b32 s52, 11
    s_branch KA_FIX_S1a
KA_STUB15:
    s_mov_b32 s52, 15
    s_branch KA_FIX_S1a
KA_STUB17:
    s_mov_b32 s52, 17
    s_branch KA_FIX_S1a
KA_FIX_S1b:
    s_nop 15
    s_nop 15
    v_max3_f32 v232, v144, v145, v146
    v_max3_f32 v232, v232, v147, v148
    v_max3_f32 v232, v232, v149, v150
    v_max3_f32 v232, v232, v151, v152
    v_max3_f32 v232, v232, v153, v154
    v_max3_f32 v232, v232, v155, v156
    v_max3_f32 v232, v232, v157, v158
    v_max3_f32 v232, v232, v159, 0
    v_mov_b32 v233, v232
    s_nop 1
    v_permlane32_swap_b32 v232, v233
    s_nop 1
    v_max_f32 v232, v232, v233
    v_sub_f32 v234, 0, v232
    v_exp_f32 v234, v234
    v_sub_f32 v228, v228, v232
    v_mul_f32 v225, v225, v234
    v_sub_f32 v144, v144, v232
    v_sub_f32 v145, v145, v232
    v_sub_f32 v146, v146, v232
    v_sub_f32 v147, v147, v232
    v_sub_f32 v148, v148, v232
    v_sub_f32 v149, v149, v232
    v_sub_f32 v150, v150, v232
    v_sub_f32 v151, v151, v232
    v_sub_f32 v152, v152, v232
    v_sub_f32 v153, v153, v232
    v_sub_f32 v154, v154, v232
    v_sub_f32 v155, v155, v232
    v_sub_f32 v156, v156, v232
    v_sub_f32 v157, v157, v232
    v_sub_f32 v158, v158, v232
    v_sub_f32 v159, v159, v232
    v_sub_f32 v176, v176, v232
    v_sub_f32 v177, v177, v232
    v_sub_f32 v178, v178, v232
    v_sub_f32 v179, v179, v232
    v_sub_f32 v180, v180, v232
    v_sub_f32 v181, v181, v232
    v_sub_f32 v182, v182, v232
    v_sub_f32 v183, v183, v232
    v_sub_f32 v184, v184, v232
    v_sub_f32 v185, v185, v232
    v_sub_f32 v186, v186, v232
    v_sub_f32 v187, v187, v232
    v_sub_f32 v188, v188, v232
    v_sub_f32 v189, v189, v232
    v_sub_f32 v190, v190, v232
    v_sub_f32 v191, v191, v232
    v_accvgpr_read_b32 v236, a64
    v_accvgpr_read_b32 v237, a65
    v_accvgpr_read_b32 v238, a66
    v_accvgpr_read_b32 v239, a67
    v_accvgpr_read_b32 v240, a68
    v_accvgpr_read_b32 v241, a69
    v_accvgpr_read_b32 v242, a70
    v_accvgpr_read_b32 v243, a71
    v_mul_f32 v236, v236, v234
    v_mul_f32 v237, v237, v234
    v_mul_f32 v238, v238, v234
    v_mul_f32 v239, v239, v234
    v_mul_f32 v240, v240, v234
    v_mul_f32 v241, v241, v234
    v_mul_f32 v242, v242, v234
    v_mul_f32 v243, v243, v234
    v_accvgpr_write_b32 a64, v236
    v_accvgpr_write_b32 a65, v237
    v_accvgpr_write_b32 a66, v238
    v_accvgpr_write_b32 a67, v239
    v_accvgpr_write_b32 a68, v240
    v_accvgpr_write_b32 a69, v241
    v_accvgpr_write_b32 a70, v242
    v_accvgpr_write_b32 a71, v243
    v_accvgpr_read_b32 v236, a72
    v_accvgpr_read_b32 v237, a73
    v_accvgpr_read_b32 v238, a74
    v_accvgpr_read_b32 v239, a75
    v_accvgpr_read_b32 v240, a76
    v_accvgpr_read_b32 v241, a77
    v_accvgpr_read_b32 v242, a78
    v_accvgpr_read_b32 v243, a79
    v_mul_f32 v236, v236, v234
    v_mul_f32 v237, v237, v234
    v_mul_f32 v238, v238, v234
    v_mul_f32 v239, v239, v234
    v_mul_f32 v240, v240, v234
    v_mul_f32 v241, v241, v234
    v_mul_f32 v242, v242, v234
    v_mul_f32 v243, v243, v234
    v_accvgpr_write_b32 a72, v236
    v_accvgpr_write_b32 a73, v237
    v_accvgpr_write_b32 a74, v238
    v_accvgpr_write_b32 a75, v239
    v_accvgpr_write_b32 a76, v240
    v_accvgpr_write_b32 a77, v241
    v_accvgpr_write_b32 a78, v242
    v_accvgpr_write_b32 a79, v243
    v_accvgpr_read_b32 v236, a80
    v_accvgpr_read_b32 v237, a81
    v_accvgpr_read_b32 v238, a82
    v_accvgpr_read_b32 v239, a83
    v_accvgpr_read_b32 v240, a84
    v_accvgpr_read_b32 v241, a85
    v_accvgpr_read_b32 v242, a86
    v_accvgpr_read_b32 v243, a87
    v_mul_f32 v236, v236, v234
    v_mul_f32 v237, v237, v234
    v_mul_f32 v238, v238, v234
    v_mul_f32 v239, v239, v234
    v_mul_f32 v240, v240, v234
    v_mul_f32 v241, v241, v234
    v_mul_f32 v242, v242, v234
    v_mul_f32 v243, v243, v234
    v_accvgpr_write_b32 a80, v236
    v_accvgpr_write_b32 a81, v237
    v_accvgpr_write_b32 a82, v238
    v_accvgpr_write_b32 a83, v239
    v_accvgpr_write_b32 a84, v240
    v_accvgpr_write_b32 a85, v241
    v_accvgpr_write_b32 a86, v242
    v_accvgpr_write_b32 a87, v243
    v_accvgpr_read_b32 v236, a88
    v_accvgpr_read_b32 v237, a89
    v_accvgpr_read_b32 v238, a90
    v_accvgpr_read_b32 v239, a91
    v_accvgpr_read_b32 v240, a92
    v_accvgpr_read_b32 v241, a93
    v_accvgpr_read_b32 v242, a94
    v_accvgpr_read_b32 v243, a95
    v_mul_f32 v236, v236, v234
    v_mul_f32 v237, v237, v234
    v_mul_f32 v238, v238, v234
    v_mul_f32 v239, v239, v234
    v_mul_f32 v240, v240, v234
    v_mul_f32 v241, v241, v234
    v_mul_f32 v242, v242, v234
    v_mul_f32 v243, v243, v234
    v_accvgpr_write_b32 a88, v236
    v_accvgpr_write_b32 a89, v237
    v_accvgpr_write_b32 a90, v238
    v_accvgpr_write_b32 a91, v239
    v_accvgpr_write_b32 a92, v240
    v_accvgpr_write_b32 a93, v241
    v_accvgpr_write_b32 a94, v242
    v_accvgpr_write_b32 a95, v243
    v_accvgpr_read_b32 v236, a96
    v_accvgpr_read_b32 v237, a97
    v_accvgpr_read_b32 v238, a98
    v_accvgpr_read_b32 v239, a99
    v_accvgpr_read_b32 v240, a100
    v_accvgpr_read_b32 v241, a101
    v_accvgpr_read_b32 v242, a102
    v_accvgpr_read_b32 v243, a103
    v_mul_f32 v236, v236, v234
    v_mul_f32 v237, v237, v234
    v_mul_f32 v238, v238, v234
    v_mul_f32 v239, v239, v234
    v_mul_f32 v240, v240, v234
    v_mul_f32 v241, v241, v234
    v_mul_f32 v242, v242, v234
    v_mul_f32 v243, v243, v234
    v_accvgpr_write_b32 a96, v236
    v_accvgpr_write_b32 a97, v237
    v_accvgpr_write_b32 a98, v238
    v_accvgpr_write_b32 a99, v239
    v_accvgpr_write_b32 a100, v240
    v_accvgpr_write_b32 a101, v241
    v_accvgpr_write_b32 a102, v242
    v_accvgpr_write_b32 a103, v243
    v_accvgpr_read_b32 v236, a104
    v_accvgpr_read_b32 v237, a105
    v_accvgpr_read_b32 v238, a106
    v_accvgpr_read_b32 v239, a107
    v_accvgpr_read_b32 v240, a108
    v_accvgpr_read_b32 v241, a109
    v_accvgpr_read_b32 v242, a110
    v_accvgpr_read_b32 v243, a111
    v_mul_f32 v236, v236, v234
    v_mul_f32 v237, v237, v234
    v_mul_f32 v238, v238, v234
    v_mul_f32 v239, v239, v234
    v_mul_f32 v240, v240, v234
    v_mul_f32 v241, v241, v234
    v_mul_f32 v242, v242, v234
    v_mul_f32 v243, v243, v234
    v_accvgpr_write_b32 a104, v236
    v_accvgpr_write_b32 a105, v237
    v_accvgpr_write_b32 a106, v238
    v_accvgpr_write_b32 a107, v239
    v_accvgpr_write_b32 a108, v240
    v_accvgpr_write_b32 a109, v241
    v_accvgpr_write_b32 a110, v242
    v_accvgpr_write_b32 a111, v243
    v_accvgpr_read_b32 v236, a112
    v_accvgpr_read_b32 v237, a113
    v_accvgpr_read_b32 v238, a114
    v_accvgpr_read_b32 v239, a115
    v_accvgpr_read_b32 v240, a116
    v_accvgpr_read_b32 v241, a117
    v_accvgpr_read_b32 v242, a118
    v_accvgpr_read_b32 v243, a119
    v_mul_f32 v236, v236, v234
    v_mul_f32 v237, v237, v234
    v_mul_f32 v238, v238, v234
    v_mul_f32 v239, v239, v234
    v_mul_f32 v240, v240, v234
    v_mul_f32 v241, v241, v234
    v_mul_f32 v242, v242, v234
    v_mul_f32 v243, v243, v234
    v_accvgpr_write_b32 a112, v236
    v_accvgpr_write_b32 a113, v237
    v_accvgpr_write_b32 a114, v238
    v_accvgpr_write_b32 a115, v239
    v_accvgpr_write_b32 a116, v240
    v_accvgpr_write_b32 a117, v241
    v_accvgpr_write_b32 a118, v242
    v_accvgpr_write_b32 a119, v243
    v_accvgpr_read_b32 v236, a120
    v_accvgpr_read_b32 v237, a121
    v_accvgpr_read_b32 v238, a122
    v_accvgpr_read_b32 v239, a123
    v_accvgpr_read_b32 v240, a124
    v_accvgpr_read_b32 v241, a125
    v_accvgpr_read_b32 v242, a126
    v_accvgpr_read_b32 v243, a127
    v_mul_f32 v236, v236, v234
    v_mul_f32 v237, v237, v234
    v_mul_f32 v238, v238, v234
    v_mul_f32 v239, v239, v234
    v_mul_f32 v240, v240, v234
    v_mul_f32 v241, v241, v234
    v_mul_f32 v242, v242, v234
    v_mul_f32 v243, v243, v234
    v_accvgpr_write_b32 a120, v236
    v_accvgpr_write_b32 a121, v237
    v_accvgpr_write_b32 a122, v238
    v_accvgpr_write_b32 a123, v239
    v_accvgpr_write_b32 a124, v240
    v_accvgpr_write_b32 a125, v241
    v_accvgpr_write_b32 a126, v242
    v_accvgpr_write_b32 a127, v243
    v_exp_f32 v208, v144
    v_exp_f32 v209, v145
    v_exp_f32 v210, v146
    v_exp_f32 v211, v147
    v_exp_f32 v212, v148
    v_exp_f32 v213, v149
    v_exp_f32 v214, v150
    v_exp_f32 v215, v151
    v_exp_f32 v216, v152
    v_exp_f32 v217, v153
    v_exp_f32 v218, v154
    v_exp_f32 v219, v155
    v_exp_f32 v220, v156
    v_exp_f32 v221, v157
    v_exp_f32 v222, v158
    v_exp_f32 v223, v159
    s_nop 0
    v_add_f32 v226, v208, v209
    v_add_f32 v226, v226, v210
    v_add_f32 v226, v226, v211
    v_add_f32 v226, v226, v212
    v_add_f32 v226, v226, v213
    v_add_f32 v226, v226, v214
    v_add_f32 v226, v226, v215
    v_add_f32 v226, v226, v216
    v_add_f32 v226, v226, v217
    v_add_f32 v226, v226, v218
    v_add_f32 v226, v226, v219
    v_add_f32 v226, v226, v220
    v_add_f32 v226, v226, v221
    v_add_f32 v226, v226, v222
    v_add_f32 v226, v226, v223
    v_cvt_pk_bf16_f32 v200, v208, v209
    v_cvt_pk_bf16_f32 v201, v210, v211
    v_cvt_pk_bf16_f32 v202, v212, v213
    v_cvt_pk_bf16_f32 v203, v214, v215
    s_nop 1
    s_cmp_eq_u32 s52, 1
    s_cbranch_scc1 KA_RET1
    s_cmp_eq_u32 s52, 3
    s_cbranch_scc1 KA_RET3
    s_cmp_eq_u32 s52, 5
    s_cbranch_scc1 KA_RET5
    s_cmp_eq_u32 s52, 7
    s_cbranch_scc1 KA_RET7
    s_endpgm
KA_FIX_S0a:
    s_nop 15
    s_nop 15
    v_max3_f32 v232, v128, v129, v130
    v_max3_f32 v232, v232, v131, v132
    v_max3_f32 v232, v232, v133, v134
    v_max3_f32 v232, v232, v135, v136
    v_max3_f32 v232, v232, v137, v138
    v_max3_f32 v232, v232, v139, v140
    v_max3_f32 v232, v232, v141, v142
    v_max3_f32 v232, v232, v143, 0
    v_mov_b32 v233, v232
    s_nop 1
    v_permlane32_swap_b32 v232, v233
    s_nop 1
    v_max_f32 v232, v232, v233
    v_sub_f32 v234, 0, v232
    v_exp_f32 v234, v234
    v_sub_f32 v227, v227, v232
    v_mul_f32 v224, v224, v234
    v_sub_f32 v128, v128, v232
    v_sub_f32 v129, v129, v232
    v_sub_f32 v130, v130, v232
    v_sub_f32 v131, v131, v232
    v_sub_f32 v132, v132, v232
    v_sub_f32 v133, v133, v232
    v_sub_f32 v134, v134, v232
    v_sub_f32 v135, v135, v232
    v_sub_f32 v136, v136, v232
    v_sub_f32 v137, v137, v232
    v_sub_f32 v138, v138, v232
    v_sub_f32 v139, v139, v232
    v_sub_f32 v140, v140, v232
    v_sub_f32 v141, v141, v232
    v_sub_f32 v142, v142, v232
    v_sub_f32 v143, v143, v232
    v_sub_f32 v160, v160, v232
    v_sub_f32 v161, v161, v232
    v_sub_f32 v162, v162, v232
    v_sub_f32 v163, v163, v232
    v_sub_f32 v164, v164, v232
    v_sub_f32 v165, v165, v232
    v_sub_f32 v166, v166, v232
    v_sub_f32 v167, v167, v232
    v_sub_f32 v168, v168, v232
    v_sub_f32 v169, v169, v232
    v_sub_f32 v170, v170, v232
    v_sub_f32 v171, v171, v232
    v_sub_f32 v172, v172, v232
    v_sub_f32 v173, v173, v232
    v_sub_f32 v174, v174, v232
    v_sub_f32 v175, v175, v232
    v_accvgpr_read_b32 v236, a0
    v_accvgpr_read_b32 v237, a1
    v_accvgpr_read_b32 v238, a2
    v_accvgpr_read_b32 v239, a3
    v_accvgpr_read_b32 v240, a4
    v_accvgpr_read_b32 v241, a5
    v_accvgpr_read_b32 v242, a6
    v_accvgpr_read_b32 v243, a7
    v_mul_f32 v236, v236, v234
    v_mul_f32 v237, v237, v234
    v_mul_f32 v238, v238, v234
    v_mul_f32 v239, v239, v234
    v_mul_f32 v240, v240, v234
    v_mul_f32 v241, v241, v234
    v_mul_f32 v242, v242, v234
    v_mul_f32 v243, v243, v234
    v_accvgpr_write_b32 a0, v236
    v_accvgpr_write_b32 a1, v237
    v_accvgpr_write_b32 a2, v238
    v_accvgpr_write_b32 a3, v239
    v_accvgpr_write_b32 a4, v240
    v_accvgpr_write_b32 a5, v241
    v_accvgpr_write_b32 a6, v242
    v_accvgpr_write_b32 a7, v243
    v_accvgpr_read_b32 v236, a8
    v_accvgpr_read_b32 v237, a9
    v_accvgpr_read_b32 v238, a10
    v_accvgpr_read_b32 v239, a11
    v_accvgpr_read_b32 v240, a12
    v_accvgpr_read_b32 v241, a13
    v_accvgpr_read_b32 v242, a14
    v_accvgpr_read_b32 v243, a15
    v_mul_f32 v236, v236, v234
    v_mul_f32 v237, v237, v234
    v_mul_f32 v238, v238, v234
    v_mul_f32 v239, v239, v234
    v_mul_f32 v240, v240, v234
    v_mul_f32 v241, v241, v234
    v_mul_f32 v242, v242, v234
    v_mul_f32 v243, v243, v234
    v_accvgpr_write_b32 a8, v236
    v_accvgpr_write_b32 a9, v237
    v_accvgpr_write_b32 a10, v238
    v_accvgpr_write_b32 a11, v239
    v_accvgpr_write_b32 a12, v240
    v_accvgpr_write_b32 a13, v241
    v_accvgpr_write_b32 a14, v242
    v_accvgpr_write_b32 a15, v243
    v_accvgpr_read_b32 v236, a16
    v_accvgpr_read_b32 v237, a17
    v_accvgpr_read_b32 v238, a18
    v_accvgpr_read_b32 v239, a19
    v_accvgpr_read_b32 v240, a20
    v_accvgpr_read_b32 v241, a21
    v_accvgpr_read_b32 v242, a22
    v_accvgpr_read_b32 v243, a23
    v_mul_f32 v236, v236, v234
    v_mul_f32 v237, v237, v234
    v_mul_f32 v238, v238, v234
    v_mul_f32 v239, v239, v234
    v_mul_f32 v240, v240, v234
    v_mul_f32 v241, v241, v234
    v_mul_f32 v242, v242, v234
    v_mul_f32 v243, v243, v234
    v_accvgpr_write_b32 a16, v236
    v_accvgpr_write_b32 a17, v237
    v_accvgpr_write_b32 a18, v238
    v_accvgpr_write_b32 a19, v239
    v_accvgpr_write_b32 a20, v240
    v_accvgpr_write_b32 a21, v241
    v_accvgpr_write_b32 a22, v242
    v_accvgpr_write_b32 a23, v243
    v_accvgpr_read_b32 v236, a24
    v_accvgpr_read_b32 v237, a25
    v_accvgpr_read_b32 v238, a26
    v_accvgpr_read_b32 v239, a27
    v_accvgpr_read_b32 v240, a28
    v_accvgpr_read_b32 v241, a29
    v_accvgpr_read_b32 v242, a30
    v_accvgpr_read_b32 v243, a31
    v_mul_f32 v236, v236, v234
    v_mul_f32 v237, v237, v234
    v_mul_f32 v238, v238, v234
    v_mul_f32 v239, v239, v234
    v_mul_f32 v240, v240, v234
    v_mul_f32 v241, v241, v234
    v_mul_f32 v242, v242, v234
    v_mul_f32 v243, v243, v234
    v_accvgpr_write_b32 a24, v236
    v_accvgpr_write_b32 a25, v237
    v_accvgpr_write_b32 a26, v238
    v_accvgpr_write_b32 a27, v239
    v_accvgpr_write_b32 a28, v240
    v_accvgpr_write_b32 a29, v241
    v_accvgpr_write_b32 a30, v242
    v_accvgpr_write_b32 a31, v243
    v_accvgpr_read_b32 v236, a32
    v_accvgpr_read_b32 v237, a33
    v_accvgpr_read_b32 v238, a34
    v_accvgpr_read_b32 v239, a35
    v_accvgpr_read_b32 v240, a36
    v_accvgpr_read_b32 v241, a37
    v_accvgpr_read_b32 v242, a38
    v_accvgpr_read_b32 v243, a39
    v_mul_f32 v236, v236, v234
    v_mul_f32 v237, v237, v234
    v_mul_f32 v238, v238, v234
    v_mul_f32 v239, v239, v234
    v_mul_f32 v240, v240, v234
    v_mul_f32 v241, v241, v234
    v_mul_f32 v242, v242, v234
    v_mul_f32 v243, v243, v234
    v_accvgpr_write_b32 a32, v236
    v_accvgpr_write_b32 a33, v237
    v_accvgpr_write_b32 a34, v238
    v_accvgpr_write_b32 a35, v239
    v_accvgpr_write_b32 a36, v240
    v_accvgpr_write_b32 a37, v241
    v_accvgpr_write_b32 a38, v242
    v_accvgpr_write_b32 a39, v243
    v_accvgpr_read_b32 v236, a40
    v_accvgpr_read_b32 v237, a41
    v_accvgpr_read_b32 v238, a42
    v_accvgpr_read_b32 v239, a43
    v_accvgpr_read_b32 v240, a44
    v_accvgpr_read_b32 v241, a45
    v_accvgpr_read_b32 v242, a46
    v_accvgpr_read_b32 v243, a47
    v_mul_f32 v236, v236, v234
    v_mul_f32 v237, v237, v234
    v_mul_f32 v238, v238, v234
    v_mul_f32 v239, v239, v234
    v_mul_f32 v240, v240, v234
    v_mul_f32 v241, v241, v234
    v_mul_f32 v242, v242, v234
    v_mul_f32 v243, v243, v234
    v_accvgpr_write_b32 a40, v236
    v_accvgpr_write_b32 a41, v237
    v_accvgpr_write_b32 a42, v238
    v_accvgpr_write_b32 a43, v239
    v_accvgpr_write_b32 a44, v240
    v_accvgpr_write_b32 a45, v241
    v_accvgpr_write_b32 a46, v242
    v_accvgpr_write_b32 a47, v243
    v_accvgpr_read_b32 v236, a48
    v_accvgpr_read_b32 v237, a49
    v_accvgpr_read_b32 v238, a50
    v_accvgpr_read_b32 v239, a51
    v_accvgpr_read_b32 v240, a52
    v_accvgpr_read_b32 v241, a53
    v_accvgpr_read_b32 v242, a54
    v_accvgpr_read_b32 v243, a55
    v_mul_f32 v236, v236, v234
    v_mul_f32 v237, v237, v234
    v_mul_f32 v238, v238, v234
    v_mul_f32 v239, v239, v234
    v_mul_f32 v240, v240, v234
    v_mul_f32 v241, v241, v234
    v_mul_f32 v242, v242, v234
    v_mul_f32 v243, v243, v234
    v_accvgpr_write_b32 a48, v236
    v_accvgpr_write_b32 a49, v237
    v_accvgpr_write_b32 a50, v238
    v_accvgpr_write_b32 a51, v239
    v_accvgpr_write_b32 a52, v240
    v_accvgpr_write_b32 a53, v241
    v_accvgpr_write_b32 a54, v242
    v_accvgpr_write_b32 a55, v243
    v_accvgpr_read_b32 v236, a56
    v_accvgpr_read_b32 v237, a57
    v_accvgpr_read_b32 v238, a58
    v_accvgpr_read_b32 v239, a59
    v_accvgpr_read_b32 v240, a60
    v_accvgpr_read_b32 v241, a61
    v_accvgpr_read_b32 v242, a62
    v_accvgpr_read_b32 v243, a63
    v_mul_f32 v236, v236, v234
    v_mul_f32 v237, v237, v234
    v_mul_f32 v238, v238, v234
    v_mul_f32 v239, v239, v234
    v_mul_f32 v240, v240, v234
    v_mul_f32 v241, v241, v234
    v_mul_f32 v242, v242, v234
    v_mul_f32 v243, v243, v234
    v_accvgpr_write_b32 a56, v236
    v_accvgpr_write_b32 a57, v237
    v_accvgpr_write_b32 a58, v238
    v_accvgpr_write_b32 a59, v239
    v_accvgpr_write_b32 a60, v240
    v_accvgpr_write_b32 a61, v241
    v_accvgpr_write_b32 a62, v242
    v_accvgpr_write_b32 a63, v243
    v_exp_f32 v208, v128
    v_exp_f32 v209, v129
    v_exp_f32 v210, v130
    v_exp_f32 v211, v131
    v_exp_f32 v212, v132
    v_exp_f32 v213, v133
    v_exp_f32 v214, v134
    v_exp_f32 v215, v135
    v_exp_f32 v216, v136
    v_exp_f32 v217, v137
    v_exp_f32 v218, v138
    v_exp_f32 v219, v139
    v_exp_f32 v220, v140
    v_exp_f32 v221, v141
    v_exp_f32 v222, v142
    v_exp_f32 v223, v143
    s_nop 0
    v_add_f32 v226, v208, v209
    v_add_f32 v226, v226, v210
    v_add_f32 v226, v226, v211
    v_add_f32 v226, v226, v212
    v_add_f32 v226, v226, v213
    v_add_f32 v226, v226, v214
    v_add_f32 v226, v226, v215
    v_add_f32 v226, v226, v216
    v_add_f32 v226, v226, v217
    v_add_f32 v226, v226, v218
    v_add_f32 v226, v226, v219
    v_add_f32 v226, v226, v220
    v_add_f32 v226, v226, v221
    v_add_f32 v226, v226, v222
    v_add_f32 v226, v226, v223
    v_cvt_pk_bf16_f32 v192, v208, v209
    v_cvt_pk_bf16_f32 v193, v210, v211
    v_cvt_pk_bf16_f32 v194, v212, v213
    v_cvt_pk_bf16_f32 v195, v214, v215
    s_nop 1
    s_cmp_eq_u32 s52, 2
    s_cbranch_scc1 KA_RET2
    s_cmp_eq_u32 s52, 4
    s_cbranch_scc1 KA_RET4
    s_cmp_eq_u32 s52, 6
    s_cbranch_scc1 KA_RET6
    s_cmp_eq_u32 s52, 8
    s_cbranch_scc1 KA_RET8
    s_endpgm
KA_FIX_S1bn:
    s_nop 15
    s_nop 15
    v_max3_f32 v232, v144, v145, v146
    v_max3_f32 v232, v232, v147, v148
    v_max3_f32 v232, v232, v149, v150
    v_max3_f32 v232, v232, v151, v152
    v_max3_f32 v232, v232, v153, v154
    v_max3_f32 v232, v232, v155, v156
    v_max3_f32 v232, v232, v157, v158
    v_max3_f32 v232, v232, v159, 0
    v_mov_b32 v233, v232
    s_nop 1
    v_permlane32_swap_b32 v232, v233
    s_nop 1
    v_max_f32 v232, v232, v233
    v_sub_f32 v234, 0, v232
    v_exp_f32 v234, v234
    v_sub_f32 v228, v228, v232
    v_mul_f32 v225, v225, v234
    v_sub_f32 v144, v144, v232
    v_sub_f32 v145, v145, v232
    v_sub_f32 v146, v146, v232
    v_sub_f32 v147, v147, v232
    v_sub_f32 v148, v148, v232
    v_sub_f32 v149, v149, v232
    v_sub_f32 v150, v150, v232
    v_sub_f32 v151, v151, v232
    v_sub_f32 v152, v152, v232
    v_sub_f32 v153, v153, v232
    v_sub_f32 v154, v154, v232
    v_sub_f32 v155, v155, v232
    v_sub_f32 v156, v156, v232
    v_sub_f32 v157, v157, v232
    v_sub_f32 v158, v158, v232
    v_sub_f32 v159, v159, v232
    v_accvgpr_read_b32 v236, a64
    v_accvgpr_read_b32 v237, a65
    v_accvgpr_read_b32 v238, a66
    v_accvgpr_read_b32 v239, a67
    v_accvgpr_read_b32 v240, a68
    v_accvgpr_read_b32 v241, a69
    v_accvgpr_read_b32 v242, a70
    v_accvgpr_read_b32 v243, a71
    v_mul_f32 v236, v236, v234
    v_mul_f32 v237, v237, v234
    v_mul_f32 v238, v238, v234
    v_mul_f32 v239, v239, v234
    v_mul_f32 v240, v240, v234
    v_mul_f32 v241, v241, v234
    v_mul_f32 v242, v242, v234
    v_mul_f32 v243, v243, v234
    v_accvgpr_write_b32 a64, v236
    v_accvgpr_write_b32 a65, v237
    v_accvgpr_write_b32 a66, v238
    v_accvgpr_write_b32 a67, v239
    v_accvgpr_write_b32 a68, v240
    v_accvgpr_write_b32 a69, v241
    v_accvgpr_write_b32 a70, v242
    v_accvgpr_write_b32 a71, v243
    v_accvgpr_read_b32 v236, a72
    v_accvgpr_read_b32 v237, a73
    v_accvgpr_read_b32 v238, a74
    v_accvgpr_read_b32 v239, a75
    v_accvgpr_read_b32 v240, a76
    v_accvgpr_read_b32 v241, a77
    v_accvgpr_read_b32 v242, a78
    v_accvgpr_read_b32 v243, a79
    v_mul_f32 v236, v236, v234
    v_mul_f32 v237, v237, v234
    v_mul_f32 v238, v238, v234
    v_mul_f32 v239, v239, v234
    v_mul_f32 v240, v240, v234
    v_mul_f32 v241, v241, v234
    v_mul_f32 v242, v242, v234
    v_mul_f32 v243, v243, v234
    v_accvgpr_write_b32 a72, v236
    v_accvgpr_write_b32 a73, v237
    v_accvgpr_write_b32 a74, v238
    v_accvgpr_write_b32 a75, v239
    v_accvgpr_write_b32 a76, v240
    v_accvgpr_write_b32 a77, v241
    v_accvgpr_write_b32 a78, v242
    v_accvgpr_write_b32 a79, v243
    v_accvgpr_read_b32 v236, a80
    v_accvgpr_read_b32 v237, a81
    v_accvgpr_read_b32 v238, a82
    v_accvgpr_read_b32 v239, a83
    v_accvgpr_read_b32 v240, a84
    v_accvgpr_read_b32 v241, a85
    v_accvgpr_read_b32 v242, a86
    v_accvgpr_read_b32 v243, a87
    v_mul_f32 v236, v236, v234
    v_mul_f32 v237, v237, v234
    v_mul_f32 v238, v238, v234
    v_mul_f32 v239, v239, v234
    v_mul_f32 v240, v240, v234
    v_mul_f32 v241, v241, v234
    v_mul_f32 v242, v242, v234
    v_mul_f32 v243, v243, v234
    v_accvgpr_write_b32 a80, v236
    v_accvgpr_write_b32 a81, v237
    v_accvgpr_write_b32 a82, v238
    v_accvgpr_write_b32 a83, v239
    v_accvgpr_write_b32 a84, v240
    v_accvgpr_write_b32 a85, v241
    v_accvgpr_write_b32 a86, v242
    v_accvgpr_write_b32 a87, v243
    v_accvgpr_read_b32 v236, a88
    v_accvgpr_read_b32 v237, a89
    v_accvgpr_read_b32 v238, a90
    v_accvgpr_read_b32 v239, a91
    v_accvgpr_read_b32 v240, a92
    v_accvgpr_read_b32 v241, a93
    v_accvgpr_read_b32 v242, a94
    v_accvgpr_read_b32 v243, a95
    v_mul_f32 v236, v236, v234
    v_mul_f32 v237, v237, v234
    v_mul_f32 v238, v238, v234
    v_mul_f32 v239, v239, v234
    v_mul_f32 v240, v240, v234
    v_mul_f32 v241, v241, v234
    v_mul_f32 v242, v242, v234
    v_mul_f32 v243, v243, v234
    v_accvgpr_write_b32 a88, v236
    v_accvgpr_write_b32 a89, v237
    v_accvgpr_write_b32 a90, v238
    v_accvgpr_write_b32 a91, v239
    v_accvgpr_write_b32 a92, v240
    v_accvgpr_write_b32 a93, v241
    v_accvgpr_write_b32 a94, v242
    v_accvgpr_write_b32 a95, v243
    v_accvgpr_read_b32 v236, a96
    v_accvgpr_read_b32 v237, a97
    v_accvgpr_read_b32 v238, a98
    v_accvgpr_read_b32 v239, a99
    v_accvgpr_read_b32 v240, a100
    v_accvgpr_read_b32 v241, a101
    v_accvgpr_read_b32 v242, a102
    v_accvgpr_read_b32 v243, a103
    v_mul_f32 v236, v236, v234
    v_mul_f32 v237, v237, v234
    v_mul_f32 v238, v238, v234
    v_mul_f32 v239, v239, v234
    v_mul_f32 v240, v240, v234
    v_mul_f32 v241, v241, v234
    v_mul_f32 v242, v242, v234
    v_mul_f32 v243, v243, v234
    v_accvgpr_write_b32 a96, v236
    v_accvgpr_write_b32 a97, v237
    v_accvgpr_write_b32 a98, v238
    v_accvgpr_write_b32 a99, v239
    v_accvgpr_write_b32 a100, v240
    v_accvgpr_write_b32 a101, v241
    v_accvgpr_write_b32 a102, v242
    v_accvgpr_write_b32 a103, v243
    v_accvgpr_read_b32 v236, a104
    v_accvgpr_read_b32 v237, a105
    v_accvgpr_read_b32 v238, a106
    v_accvgpr_read_b32 v239, a107
    v_accvgpr_read_b32 v240, a108
    v_accvgpr_read_b32 v241, a109
    v_accvgpr_read_b32 v242, a110
    v_accvgpr_read_b32 v243, a111
    v_mul_f32 v236, v236, v234
    v_mul_f32 v237, v237, v234
    v_mul_f32 v238, v238, v234
    v_mul_f32 v239, v239, v234
    v_mul_f32 v240, v240, v234
    v_mul_f32 v241, v241, v234
    v_mul_f32 v242, v242, v234
    v_mul_f32 v243, v243, v234
    v_accvgpr_write_b32 a104, v236
    v_accvgpr_write_b32 a105, v237
    v_accvgpr_write_b32 a106, v238
    v_accvgpr_write_b32 a107, v239
    v_accvgpr_write_b32 a108, v240
    v_accvgpr_write_b32 a109, v241
    v_accvgpr_write_b32 a110, v242
    v_accvgpr_write_b32 a111, v243
    v_accvgpr_read_b32 v236, a112
    v_accvgpr_read_b32 v237, a113
    v_accvgpr_read_b32 v238, a114
    v_accvgpr_read_b32 v239, a115
    v_accvgpr_read_b32 v240, a116
    v_accvgpr_read_b32 v241, a117
    v_accvgpr_read_b32 v242, a118
    v_accvgpr_read_b32 v243, a119
    v_mul_f32 v236, v236, v234
    v_mul_f32 v237, v237, v234
    v_mul_f32 v238, v238, v234
    v_mul_f32 v239, v239, v234
    v_mul_f32 v240, v240, v234
    v_mul_f32 v241, v241, v234
    v_mul_f32 v242, v242, v234
    v_mul_f32 v243, v243, v234
    v_accvgpr_write_b32 a112, v236
    v_accvgpr_write_b32 a113, v237
    v_accvgpr_write_b32 a114, v238
    v_accvgpr_write_b32 a115, v239
    v_accvgpr_write_b32 a116, v240
    v_accvgpr_write_b32 a117, v241
    v_accvgpr_write_b32 a118, v242
    v_accvgpr_write_b32 a119, v243
    v_accvgpr_read_b32 v236, a120
    v_accvgpr_read_b32 v237, a121
    v_accvgpr_read_b32 v238, a122
    v_accvgpr_read_b32 v239, a123
    v_accvgpr_read_b32 v240, a124
    v_accvgpr_read_b32 v241, a125
    v_accvgpr_read_b32 v242, a126
    v_accvgpr_read_b32 v243, a127
    v_mul_f32 v236, v236, v234
    v_mul_f32 v237, v237, v234
    v_mul_f32 v238, v238, v234
    v_mul_f32 v239, v239, v234
    v_mul_f32 v240, v240, v234
    v_mul_f32 v241, v241, v234
    v_mul_f32 v242, v242, v234
    v_mul_f32 v243, v243, v234
    v_accvgpr_write_b32 a120, v236
    v_accvgpr_write_b32 a121, v237
    v_accvgpr_write_b32 a122, v238
    v_accvgpr_write_b32 a123, v239
    v_accvgpr_write_b32 a124, v240
    v_accvgpr_write_b32 a125, v241
    v_accvgpr_write_b32 a126, v242
    v_accvgpr_write_b32 a127, v243
    v_exp_f32 v208, v144
    v_exp_f32 v209, v145
    v_exp_f32 v210, v146
    v_exp_f32 v211, v147
    v_exp_f32 v212, v148
    v_exp_f32 v213, v149
    v_exp_f32 v214, v150
    v_exp_f32 v215, v151
    v_exp_f32 v216, v152
    v_exp_f32 v217, v153
    v_exp_f32 v218, v154
    v_exp_f32 v219, v155
    v_exp_f32 v220, v156
    v_exp_f32 v221, v157
    v_exp_f32 v222, v158
    v_exp_f32 v223, v159
    s_nop 0
    v_add_f32 v226, v208, v209
    v_add_f32 v226, v226, v210
    v_add_f32 v226, v226, v211
    v_add_f32 v226, v226, v212
    v_add_f32 v226, v226, v213
    v_add_f32 v226, v226, v214
    v_add_f32 v226, v226, v215
    v_add_f32 v226, v226, v216
    v_add_f32 v226, v226, v217
    v_add_f32 v226, v226, v218
    v_add_f32 v226, v226, v219
    v_add_f32 v226, v226, v220
    v_add_f32 v226, v226, v221
    v_add_f32 v226, v226, v222
    v_add_f32 v226, v226, v223
    v_cvt_pk_bf16_f32 v200, v208, v209
    v_cvt_pk_bf16_f32 v201, v210, v211
    v_cvt_pk_bf16_f32 v202, v212, v213
    v_cvt_pk_bf16_f32 v203, v214, v215
    s_nop 1
    s_cmp_eq_u32 s52, 9
    s_cbranch_scc1 KA_RET9
    s_cmp_eq_u32 s52, 13
    s_cbranch_scc1 KA_RET13
    s_endpgm
KA_FIX_S0s:
    s_nop 15
    s_nop 15
    v_max3_f32 v232, v128, v129, v130
    v_max3_f32 v232, v232, v131, v132
    v_max3_f32 v232, v232, v133, v134
    v_max3_f32 v232, v232, v135, v136
    v_max3_f32 v232, v232, v137, v138
    v_max3_f32 v232, v232, v139, v140
    v_max3_f32 v232, v232, v141, v142
    v_max3_f32 v232, v232, v143, 0
    v_mov_b32 v233, v232
    s_nop 1
    v_permlane32_swap_b32 v232, v233
    s_nop 1
    v_max_f32 v232, v232, v233
    v_sub_f32 v234, 0, v232
    v_exp_f32 v234, v234
    v_sub_f32 v227, v227, v232
    v_mul_f32 v224, v224, v234
    v_sub_f32 v128, v128, v232
    v_sub_f32 v129, v129, v232
    v_sub_f32 v130, v130, v232
    v_sub_f32 v131, v131, v232
    v_sub_f32 v132, v132, v232
    v_sub_f32 v133, v133, v232
    v_sub_f32 v134, v134, v232
    v_sub_f32 v135, v135, v232
    v_sub_f32 v136, v136, v232
    v_sub_f32 v137, v137, v232
    v_sub_f32 v138, v138, v232
    v_sub_f32 v139, v139, v232
    v_sub_f32 v140, v140, v232
    v_sub_f32 v141, v141, v232
    v_sub_f32 v142, v142, v232
    v_sub_f32 v143, v143, v232
    v_sub_f32 v160, v160, v232
    v_sub_f32 v161, v161, v232
    v_sub_f32 v162, v162, v232
    v_sub_f32 v163, v163, v232
    v_sub_f32 v164, v164, v232
    v_sub_f32 v165, v165, v232
    v_sub_f32 v166, v166, v232
    v_sub_f32 v167, v167, v232
    v_sub_f32 v168, v168, v232
    v_sub_f32 v169, v169, v232
    v_sub_f32 v170, v170, v232
    v_sub_f32 v171, v171, v232
    v_sub_f32 v172, v172, v232
    v_sub_f32 v173, v173, v232
    v_sub_f32 v174, v174, v232
    v_sub_f32 v175, v175, v232
    v_sub_f32 v176, v176, v232
    v_sub_f32 v177, v177, v232
    v_sub_f32 v178, v178, v232
    v_sub_f32 v179, v179, v232
    v_sub_f32 v180, v180, v232
    v_sub_f32 v181, v181, v232
    v_sub_f32 v182, v182, v232
    v_sub_f32 v183, v183, v232
    v_sub_f32 v184, v184, v232
    v_sub_f32 v185, v185, v232
    v_sub_f32 v186, v186, v232
    v_sub_f32 v187, v187, v232
    v_sub_f32 v188, v188, v232
    v_sub_f32 v189, v189, v232
    v_sub_f32 v190, v190, v232
    v_sub_f32 v191, v191, v232
    v_sub_f32 v144, v144, v232
    v_sub_f32 v145, v145, v232
    v_sub_f32 v146, v146, v232
    v_sub_f32 v147, v147, v232
    v_sub_f32 v148, v148, v232
    v_sub_f32 v149, v149, v232
    v_sub_f32 v150, v150, v232
    v_sub_f32 v151, v151, v232
    v_sub_f32 v152, v152, v232
    v_sub_f32 v153, v153, v232
    v_sub_f32 v154, v154, v232
    v_sub_f32 v155, v155, v232
    v_sub_f32 v156, v156, v232
    v_sub_f32 v157, v157, v232
    v_sub_f32 v158, v158, v232
    v_sub_f32 v159, v159, v232
    v_accvgpr_read_b32 v236, a0
    v_accvgpr_read_b32 v237, a1
    v_accvgpr_read_b32 v238, a2
    v_accvgpr_read_b32 v239, a3
    v_accvgpr_read_b32 v240, a4
    v_accvgpr_read_b32 v241, a5
    v_accvgpr_read_b32 v242, a6
    v_accvgpr_read_b32 v243, a7
    v_mul_f32 v236, v236, v234
    v_mul_f32 v237, v237, v234
    v_mul_f32 v238, v238, v234
    v_mul_f32 v239, v239, v234
    v_mul_f32 v240, v240, v234
    v_mul_f32 v241, v241, v234
    v_mul_f32 v242, v242, v234
    v_mul_f32 v243, v243, v234
    v_accvgpr_write_b32 a0, v236
    v_accvgpr_write_b32 a1, v237
    v_accvgpr_write_b32 a2, v238
    v_accvgpr_write_b32 a3, v239
    v_accvgpr_write_b32 a4, v240
    v_accvgpr_write_b32 a5, v241
    v_accvgpr_write_b32 a6, v242
    v_accvgpr_write_b32 a7, v243
    v_accvgpr_read_b32 v236, a8
    v_accvgpr_read_b32 v237, a9
    v_accvgpr_read_b32 v238, a10
    v_accvgpr_read_b32 v239, a11
    v_accvgpr_read_b32 v240, a12
    v_accvgpr_read_b32 v241, a13
    v_accvgpr_read_b32 v242, a14
    v_accvgpr_read_b32 v243, a15
    v_mul_f32 v236, v236, v234
    v_mul_f32 v237, v237, v234
    v_mul_f32 v238, v238, v234
    v_mul_f32 v239, v239, v234
    v_mul_f32 v240, v240, v234
    v_mul_f32 v241, v241, v234
    v_mul_f32 v242, v242, v234
    v_mul_f32 v243, v243, v234
    v_accvgpr_write_b32 a8, v236
    v_accvgpr_write_b32 a9, v237
    v_accvgpr_write_b32 a10, v238
    v_accvgpr_write_b32 a11, v239
    v_accvgpr_write_b32 a12, v240
    v_accvgpr_write_b32 a13, v241
    v_accvgpr_write_b32 a14, v242
    v_accvgpr_write_b32 a15, v243
    v_accvgpr_read_b32 v236, a16
    v_accvgpr_read_b32 v237, a17
    v_accvgpr_read_b32 v238, a18
    v_accvgpr_read_b32 v239, a19
    v_accvgpr_read_b32 v240, a20
    v_accvgpr_read_b32 v241, a21
    v_accvgpr_read_b32 v242, a22
    v_accvgpr_read_b32 v243, a23
    v_mul_f32 v236, v236, v234
    v_mul_f32 v237, v237, v234
    v_mul_f32 v238, v238, v234
    v_mul_f32 v239, v239, v234
    v_mul_f32 v240, v240, v234
    v_mul_f32 v241, v241, v234
    v_mul_f32 v242, v242, v234
    v_mul_f32 v243, v243, v234
    v_accvgpr_write_b32 a16, v236
    v_accvgpr_write_b32 a17, v237
    v_accvgpr_write_b32 a18, v238
    v_accvgpr_write_b32 a19, v239
    v_accvgpr_write_b32 a20, v240
    v_accvgpr_write_b32 a21, v241
    v_accvgpr_write_b32 a22, v242
    v_accvgpr_write_b32 a23, v243
    v_accvgpr_read_b32 v236, a24
    v_accvgpr_read_b32 v237, a25
    v_accvgpr_read_b32 v238, a26
    v_accvgpr_read_b32 v239, a27
    v_accvgpr_read_b32 v240, a28
    v_accvgpr_read_b32 v241, a29
    v_accvgpr_read_b32 v242, a30
    v_accvgpr_read_b32 v243, a31
    v_mul_f32 v236, v236, v234
    v_mul_f32 v237, v237, v234
    v_mul_f32 v238, v238, v234
    v_mul_f32 v239, v239, v234
    v_mul_f32 v240, v240, v234
    v_mul_f32 v241, v241, v234
    v_mul_f32 v242, v242, v234
    v_mul_f32 v243, v243, v234
    v_accvgpr_write_b32 a24, v236
    v_accvgpr_write_b32 a25, v237
    v_accvgpr_write_b32 a26, v238
    v_accvgpr_write_b32 a27, v239
    v_accvgpr_write_b32 a28, v240
    v_accvgpr_write_b32 a29, v241
    v_accvgpr_write_b32 a30, v242
    v_accvgpr_write_b32 a31, v243
    v_accvgpr_read_b32 v236, a32
    v_accvgpr_read_b32 v237, a33
    v_accvgpr_read_b32 v238, a34
    v_accvgpr_read_b32 v239, a35
    v_accvgpr_read_b32 v240, a36
    v_accvgpr_read_b32 v241, a37
    v_accvgpr_read_b32 v242, a38
    v_accvgpr_read_b32 v243, a39
    v_mul_f32 v236, v236, v234
    v_mul_f32 v237, v237, v234
    v_mul_f32 v238, v238, v234
    v_mul_f32 v239, v239, v234
    v_mul_f32 v240, v240, v234
    v_mul_f32 v241, v241, v234
    v_mul_f32 v242, v242, v234
    v_mul_f32 v243, v243, v234
    v_accvgpr_write_b32 a32, v236
    v_accvgpr_write_b32 a33, v237
    v_accvgpr_write_b32 a34, v238
    v_accvgpr_write_b32 a35, v239
    v_accvgpr_write_b32 a36, v240
    v_accvgpr_write_b32 a37, v241
    v_accvgpr_write_b32 a38, v242
    v_accvgpr_write_b32 a39, v243
    v_accvgpr_read_b32 v236, a40
    v_accvgpr_read_b32 v237, a41
    v_accvgpr_read_b32 v238, a42
    v_accvgpr_read_b32 v239, a43
    v_accvgpr_read_b32 v240, a44
    v_accvgpr_read_b32 v241, a45
    v_accvgpr_read_b32 v242, a46
    v_accvgpr_read_b32 v243, a47
    v_mul_f32 v236, v236, v234
    v_mul_f32 v237, v237, v234
    v_mul_f32 v238, v238, v234
    v_mul_f32 v239, v239, v234
    v_mul_f32 v240, v240, v234
    v_mul_f32 v241, v241, v234
    v_mul_f32 v242, v242, v234
    v_mul_f32 v243, v243, v234
    v_accvgpr_write_b32 a40, v236
    v_accvgpr_write_b32 a41, v237
    v_accvgpr_write_b32 a42, v238
    v_accvgpr_write_b32 a43, v239
    v_accvgpr_write_b32 a44, v240
    v_accvgpr_write_b32 a45, v241
    v_accvgpr_write_b32 a46, v242
    v_accvgpr_write_b32 a47, v243
    v_accvgpr_read_b32 v236, a48
    v_accvgpr_read_b32 v237, a49
    v_accvgpr_read_b32 v238, a50
    v_accvgpr_read_b32 v239, a51
    v_accvgpr_read_b32 v240, a52
    v_accvgpr_read_b32 v241, a53
    v_accvgpr_read_b32 v242, a54
    v_accvgpr_read_b32 v243, a55
    v_mul_f32 v236, v236, v234
    v_mul_f32 v237, v237, v234
    v_mul_f32 v238, v238, v234
    v_mul_f32 v239, v239, v234
    v_mul_f32 v240, v240, v234
    v_mul_f32 v241, v241, v234
    v_mul_f32 v242, v242, v234
    v_mul_f32 v243, v243, v234
    v_accvgpr_write_b32 a48, v236
    v_accvgpr_write_b32 a49, v237
    v_accvgpr_write_b32 a50, v238
    v_accvgpr_write_b32 a51, v239
    v_accvgpr_write_b32 a52, v240
    v_accvgpr_write_b32 a53, v241
    v_accvgpr_write_b32 a54, v242
    v_accvgpr_write_b32 a55, v243
    v_accvgpr_read_b32 v236, a56
    v_accvgpr_read_b32 v237, a57
    v_accvgpr_read_b32 v238, a58
    v_accvgpr_read_b32 v239, a59
    v_accvgpr_read_b32 v240, a60
    v_accvgpr_read_b32 v241, a61
    v_accvgpr_read_b32 v242, a62
    v_accvgpr_read_b32 v243, a63
    v_mul_f32 v236, v236, v234
    v_mul_f32 v237, v237, v234
    v_mul_f32 v238, v238, v234
    v_mul_f32 v239, v239, v234
    v_mul_f32 v240, v240, v234
    v_mul_f32 v241, v241, v234
    v_mul_f32 v242, v242, v234
    v_mul_f32 v243, v243, v234
    v_accvgpr_write_b32 a56, v236
    v_accvgpr_write_b32 a57, v237
    v_accvgpr_write_b32 a58, v238
    v_accvgpr_write_b32 a59, v239
    v_accvgpr_write_b32 a60, v240
    v_accvgpr_write_b32 a61, v241
    v_accvgpr_write_b32 a62, v242
    v_accvgpr_write_b32 a63, v243
    v_exp_f32 v208, v128
    v_exp_f32 v209, v129
    v_exp_f32 v210, v130
    v_exp_f32 v211, v131
    v_exp_f32 v212, v132
    v_exp_f32 v213, v133
    v_exp_f32 v214, v134
    v_exp_f32 v215, v135
    v_exp_f32 v216, v136
    v_exp_f32 v217, v137
    v_exp_f32 v218, v138
    v_exp_f32 v219, v139
    v_exp_f32 v220, v140
    v_exp_f32 v221, v141
    v_exp_f32 v222, v142
    v_exp_f32 v223, v143
    s_nop 0
    v_add_f32 v226, v208, v209
    v_add_f32 v226, v226, v210
    v_add_f32 v226, v226, v211
    v_add_f32 v226, v226, v212
    v_add_f32 v226, v226, v213
    v_add_f32 v226, v226, v214
    v_add_f32 v226, v226, v215
    v_add_f32 v226, v226, v216
    v_add_f32 v226, v226, v217
    v_add_f32 v226, v226, v218
    v_add_f32 v226, v226, v219
    v_add_f32 v226, v226, v220
    v_add_f32 v226, v226, v221
    v_add_f32 v226, v226, v222
    v_add_f32 v226, v226, v223
    v_cvt_pk_bf16_f32 v192, v208, v209
    v_cvt_pk_bf16_f32 v193, v210, v211
    v_cvt_pk_bf16_f32 v194, v212, v213
    v_cvt_pk_bf16_f32 v195, v214, v215
    s_nop 1
    s_cmp_eq_u32 s52, 10
    s_cbranch_scc1 KA_RET10
    s_cmp_eq_u32 s52, 12
    s_cbranch_scc1 KA_RET12
    s_cmp_eq_u32 s52, 14
    s_cbranch_scc1 KA_RET14
    s_cmp_eq_u32 s52, 16
    s_cbranch_scc1 KA_RET16
    s_endpgm
KA_FIX_S1a:
    s_nop 15
    s_nop 15
    v_max3_f32 v232, v144, v145, v146
    v_max3_f32 v232, v232, v147, v148
    v_max3_f32 v232, v232, v149, v150
    v_max3_f32 v232, v232, v151, v152
    v_max3_f32 v232, v232, v153, v154
    v_max3_f32 v232, v232, v155, v156
    v_max3_f32 v232, v232, v157, v158
    v_max3_f32 v232, v232, v159, 0
    v_mov_b32 v233, v232
    s_nop 1
    v_permlane32_swap_b32 v232, v233
    s_nop 1
    v_max_f32 v232, v232, v233
    v_sub_f32 v234, 0, v232
    v_exp_f32 v234, v234
    v_sub_f32 v227, v227, v232
    v_mul_f32 v224, v224, v234
    v_sub_f32 v144, v144, v232
    v_sub_f32 v145, v145, v232
    v_sub_f32 v146, v146, v232
    v_sub_f32 v147, v147, v232
    v_sub_f32 v148, v148, v232
    v_sub_f32 v149, v149, v232
    v_sub_f32 v150, v150, v232
    v_sub_f32 v151, v151, v232
    v_sub_f32 v152, v152, v232
    v_sub_f32 v153, v153, v232
    v_sub_f32 v154, v154, v232
    v_sub_f32 v155, v155, v232
    v_sub_f32 v156, v156, v232
    v_sub_f32 v157, v157, v232
    v_sub_f32 v158, v158, v232
    v_sub_f32 v159, v159, v232
    v_sub_f32 v160, v160, v232
    v_sub_f32 v161, v161, v232
    v_sub_f32 v162, v162, v232
    v_sub_f32 v163, v163, v232
    v_sub_f32 v164, v164, v232
    v_sub_f32 v165, v165, v232
    v_sub_f32 v166, v166, v232
    v_sub_f32 v167, v167, v232
    v_sub_f32 v168, v168, v232
    v_sub_f32 v169, v169, v232
    v_sub_f32 v170, v170, v232
    v_sub_f32 v171, v171, v232
    v_sub_f32 v172, v172, v232
    v_sub_f32 v173, v173, v232
    v_sub_f32 v174, v174, v232
    v_sub_f32 v175, v175, v232
    v_sub_f32 v176, v176, v232
    v_sub_f32 v177, v177, v232
    v_sub_f32 v178, v178, v232
    v_sub_f32 v179, v179, v232
    v_sub_f32 v180, v180, v232
    v_sub_f32 v181, v181, v232
    v_sub_f32 v182, v182, v232
    v_sub_f32 v183, v183, v232
    v_sub_f32 v184, v184, v232
    v_sub_f32 v185, v185, v232
    v_sub_f32 v186, v186, v232
    v_sub_f32 v187, v187, v232
    v_sub_f32 v188, v188, v232
    v_sub_f32 v189, v189, v232
    v_sub_f32 v190, v190, v232
    v_sub_f32 v191, v191, v232
    v_sub_f32 v128, v128, v232
    v_sub_f32 v129, v129, v232
    v_sub_f32 v130, v130, v232
    v_sub_f32 v131, v131, v232
    v_sub_f32 v132, v132, v232
    v_sub_f32 v133, v133, v232
    v_sub_f32 v134, v134, v232
    v_sub_f32 v135, v135, v232
    v_sub_f32 v136, v136, v232
    v_sub_f32 v137, v137, v232
    v_sub_f32 v138, v138, v232
    v_sub_f32 v139, v139, v232
    v_sub_f32 v140, v140, v232
    v_sub_f32 v141, v141, v232
    v_sub_f32 v142, v142, v232
    v_sub_f32 v143, v143, v232
    v_accvgpr_read_b32 v236, a0
    v_accvgpr_read_b32 v237, a1
    v_accvgpr_read_b32 v238, a2
    v_accvgpr_read_b32 v239, a3
    v_accvgpr_read_b32 v240, a4
    v_accvgpr_read_b32 v241, a5
    v_accvgpr_read_b32 v242, a6
    v_accvgpr_read_b32 v243, a7
    v_mul_f32 v236, v236, v234
    v_mul_f32 v237, v237, v234
    v_mul_f32 v238, v238, v234
    v_mul_f32 v239, v239, v234
    v_mul_f32 v240, v240, v234
    v_mul_f32 v241, v241, v234
    v_mul_f32 v242, v242, v234
    v_mul_f32 v243, v243, v234
    v_accvgpr_write_b32 a0, v236
    v_accvgpr_write_b32 a1, v237
    v_accvgpr_write_b32 a2, v238
    v_accvgpr_write_b32 a3, v239
    v_accvgpr_write_b32 a4, v240
    v_accvgpr_write_b32 a5, v241
    v_accvgpr_write_b32 a6, v242
    v_accvgpr_write_b32 a7, v243
    v_accvgpr_read_b32 v236, a8
    v_accvgpr_read_b32 v237, a9
    v_accvgpr_read_b32 v238, a10
    v_accvgpr_read_b32 v239, a11
    v_accvgpr_read_b32 v240, a12
    v_accvgpr_read_b32 v241, a13
    v_accvgpr_read_b32 v242, a14
    v_accvgpr_read_b32 v243, a15
    v_mul_f32 v236, v236, v234
    v_mul_f32 v237, v237, v234
    v_mul_f32 v238, v238, v234
    v_mul_f32 v239, v239, v234
    v_mul_f32 v240, v240, v234
    v_mul_f32 v241, v241, v234
    v_mul_f32 v242, v242, v234
    v_mul_f32 v243, v243, v234
    v_accvgpr_write_b32 a8, v236
    v_accvgpr_write_b32 a9, v237
    v_accvgpr_write_b32 a10, v238
    v_accvgpr_write_b32 a11, v239
    v_accvgpr_write_b32 a12, v240
    v_accvgpr_write_b32 a13, v241
    v_accvgpr_write_b32 a14, v242
    v_accvgpr_write_b32 a15, v243
    v_accvgpr_read_b32 v236, a16
    v_accvgpr_read_b32 v237, a17
    v_accvgpr_read_b32 v238, a18
    v_accvgpr_read_b32 v239, a19
    v_accvgpr_read_b32 v240, a20
    v_accvgpr_read_b32 v241, a21
    v_accvgpr_read_b32 v242, a22
    v_accvgpr_read_b32 v243, a23
    v_mul_f32 v236, v236, v234
    v_mul_f32 v237, v237, v234
    v_mul_f32 v238, v238, v234
    v_mul_f32 v239, v239, v234
    v_mul_f32 v240, v240, v234
    v_mul_f32 v241, v241, v234
    v_mul_f32 v242, v242, v234
    v_mul_f32 v243, v243, v234
    v_accvgpr_write_b32 a16, v236
    v_accvgpr_write_b32 a17, v237
    v_accvgpr_write_b32 a18, v238
    v_accvgpr_write_b32 a19, v239
    v_accvgpr_write_b32 a20, v240
    v_accvgpr_write_b32 a21, v241
    v_accvgpr_write_b32 a22, v242
    v_accvgpr_write_b32 a23, v243
    v_accvgpr_read_b32 v236, a24
    v_accvgpr_read_b32 v237, a25
    v_accvgpr_read_b32 v238, a26
    v_accvgpr_read_b32 v239, a27
    v_accvgpr_read_b32 v240, a28
    v_accvgpr_read_b32 v241, a29
    v_accvgpr_read_b32 v242, a30
    v_accvgpr_read_b32 v243, a31
    v_mul_f32 v236, v236, v234
    v_mul_f32 v237, v237, v234
    v_mul_f32 v238, v238, v234
    v_mul_f32 v239, v239, v234
    v_mul_f32 v240, v240, v234
    v_mul_f32 v241, v241, v234
    v_mul_f32 v242, v242, v234
    v_mul_f32 v243, v243, v234
    v_accvgpr_write_b32 a24, v236
    v_accvgpr_write_b32 a25, v237
    v_accvgpr_write_b32 a26, v238
    v_accvgpr_write_b32 a27, v239
    v_accvgpr_write_b32 a28, v240
    v_accvgpr_write_b32 a29, v241
    v_accvgpr_write_b32 a30, v242
    v_accvgpr_write_b32 a31, v243
    v_accvgpr_read_b32 v236, a32
    v_accvgpr_read_b32 v237, a33
    v_accvgpr_read_b32 v238, a34
    v_accvgpr_read_b32 v239, a35
    v_accvgpr_read_b32 v240, a36
    v_accvgpr_read_b32 v241, a37
    v_accvgpr_read_b32 v242, a38
    v_accvgpr_read_b32 v243, a39
    v_mul_f32 v236, v236, v234
    v_mul_f32 v237, v237, v234
    v_mul_f32 v238, v238, v234
    v_mul_f32 v239, v239, v234
    v_mul_f32 v240, v240, v234
    v_mul_f32 v241, v241, v234
    v_mul_f32 v242, v242, v234
    v_mul_f32 v243, v243, v234
    v_accvgpr_write_b32 a32, v236
    v_accvgpr_write_b32 a33, v237
    v_accvgpr_write_b32 a34, v238
    v_accvgpr_write_b32 a35, v239
    v_accvgpr_write_b32 a36, v240
    v_accvgpr_write_b32 a37, v241
    v_accvgpr_write_b32 a38, v242
    v_accvgpr_write_b32 a39, v243
    v_accvgpr_read_b32 v236, a40
    v_accvgpr_read_b32 v237, a41
    v_accvgpr_read_b32 v238, a42
    v_accvgpr_read_b32 v239, a43
    v_accvgpr_read_b32 v240, a44
    v_accvgpr_read_b32 v241, a45
    v_accvgpr_read_b32 v242, a46
    v_accvgpr_read_b32 v243, a47
    v_mul_f32 v236, v236, v234
    v_mul_f32 v237, v237, v234
    v_mul_f32 v238, v238, v234
    v_mul_f32 v239, v239, v234
    v_mul_f32 v240, v240, v234
    v_mul_f32 v241, v241, v234
    v_mul_f32 v242, v242, v234
    v_mul_f32 v243, v243, v234
    v_accvgpr_write_b32 a40, v236
    v_accvgpr_write_b32 a41, v237
    v_accvgpr_write_b32 a42, v238
    v_accvgpr_write_b32 a43, v239
    v_accvgpr_write_b32 a44, v240
    v_accvgpr_write_b32 a45, v241
    v_accvgpr_write_b32 a46, v242
    v_accvgpr_write_b32 a47, v243
    v_accvgpr_read_b32 v236, a48
    v_accvgpr_read_b32 v237, a49
    v_accvgpr_read_b32 v238, a50
    v_accvgpr_read_b32 v239, a51
    v_accvgpr_read_b32 v240, a52
    v_accvgpr_read_b32 v241, a53
    v_accvgpr_read_b32 v242, a54
    v_accvgpr_read_b32 v243, a55
    v_mul_f32 v236, v236, v234
    v_mul_f32 v237, v237, v234
    v_mul_f32 v238, v238, v234
    v_mul_f32 v239, v239, v234
    v_mul_f32 v240, v240, v234
    v_mul_f32 v241, v241, v234
    v_mul_f32 v242, v242, v234
    v_mul_f32 v243, v243, v234
    v_accvgpr_write_b32 a48, v236
    v_accvgpr_write_b32 a49, v237
    v_accvgpr_write_b32 a50, v238
    v_accvgpr_write_b32 a51, v239
    v_accvgpr_write_b32 a52, v240
    v_accvgpr_write_b32 a53, v241
    v_accvgpr_write_b32 a54, v242
    v_accvgpr_write_b32 a55, v243
    v_accvgpr_read_b32 v236, a56
    v_accvgpr_read_b32 v237, a57
    v_accvgpr_read_b32 v238, a58
    v_accvgpr_read_b32 v239, a59
    v_accvgpr_read_b32 v240, a60
    v_accvgpr_read_b32 v241, a61
    v_accvgpr_read_b32 v242, a62
    v_accvgpr_read_b32 v243, a63
    v_mul_f32 v236, v236, v234
    v_mul_f32 v237, v237, v234
    v_mul_f32 v238, v238, v234
    v_mul_f32 v239, v239, v234
    v_mul_f32 v240, v240, v234
    v_mul_f32 v241, v241, v234
    v_mul_f32 v242, v242, v234
    v_mul_f32 v243, v243, v234
    v_accvgpr_write_b32 a56, v236
    v_accvgpr_write_b32 a57, v237
    v_accvgpr_write_b32 a58, v238
    v_accvgpr_write_b32 a59, v239
    v_accvgpr_write_b32 a60, v240
    v_accvgpr_write_b32 a61, v241
    v_accvgpr_write_b32 a62, v242
    v_accvgpr_write_b32 a63, v243
    v_exp_f32 v208, v144
    v_exp_f32 v209, v145
    v_exp_f32 v210, v146
    v_exp_f32 v211, v147
    v_exp_f32 v212, v148
    v_exp_f32 v213, v149
    v_exp_f32 v214, v150
    v_exp_f32 v215, v151
    v_exp_f32 v216, v152
    v_exp_f32 v217, v153
    v_exp_f32 v218, v154
    v_exp_f32 v219, v155
    v_exp_f32 v220, v156
    v_exp_f32 v221, v157
    v_exp_f32 v222, v158
    v_exp_f32 v223, v159
    s_nop 0
    v_add_f32 v226, v208, v209
    v_add_f32 v226, v226, v210
    v_add_f32 v226, v226, v211
    v_add_f32 v226, v226, v212
    v_add_f32 v226, v226, v213
    v_add_f32 v226, v226, v214
    v_add_f32 v226, v226, v215
    v_add_f32 v226, v226, v216
    v_add_f32 v226, v226, v217
    v_add_f32 v226, v226, v218
    v_add_f32 v226, v226, v219
    v_add_f32 v226, v226, v220
    v_add_f32 v226, v226, v221
    v_add_f32 v226, v226, v222
    v_add_f32 v226, v226, v223
    v_cvt_pk_bf16_f32 v200, v208, v209
    v_cvt_pk_bf16_f32 v201, v210, v211
    v_cvt_pk_bf16_f32 v202, v212, v213
    v_cvt_pk_bf16_f32 v203, v214, v215
    s_nop 1
    s_cmp_eq_u32 s52, 11
    s_cbranch_scc1 KA_RET11
    s_cmp_eq_u32 s52, 15
    s_cbranch_scc1 KA_RET15
    s_cmp_eq_u32 s52, 17
    s_cbranch_scc1 KA_RET17
    s_endpgm
.globl kc_tail_kernel
.p2align 8
.type kc_tail_kernel,@function
kc_tail_kernel:
KC_PRO:
    s_cmp_ge_u32 s2, 256
    s_cbranch_scc1 KC_EXIT
    s_load_dwordx2 s[66:67], s[0:1], 56
    s_load_dwordx2 s[70:71], s[0:1], 64
    s_load_dwordx2 s[72:73], s[0:1], 80
    s_load_dwordx2 s[74:75], s[0:1], 0
    s_load_dwordx2 s[76:77], s[0:1], 88
    s_load_dwordx2 s[78:79], s[0:1], 104
    s_bfe_u32 s61, s2, 0x20001
    s_lshr_b32 s52, s2, 6
    s_lshl_b32 s52, s52, 2
    s_add_u32 s61, s61, s52
    s_bfe_u32 s62, s2, 0x20004
    s_and_b32 s63, s2, 1
    s_lshl_b32 s63, s63, 1
    s_bfe_u32 s52, s2, 0x10003
    s_add_u32 s63, s63, s52
    s_lshl_b32 s40, s61, 1
    s_lshr_b32 s52, s63, 1
    s_add_u32 s40, s40, s52
    s_lshl_b32 s41, s62, 1
    s_and_b32 s52, s63, 1
    s_add_u32 s41, s41, s52
    s_lshl_b32 s51, s61, 2
    s_add_u32 s51, s51, s62
    v_lshrrev_b32 v1, 6, v0
    v_and_b32 v2, 63, v0
    s_nop 0
    v_readfirstlane_b32 s42, v1
    v_lshlrev_b32 v14, 4, v2
    s_nop 0
    s_and_b32 s47, s42, 1
    v_lshrrev_b32 v1, 3, v2
    v_bfe_u32 v3, v2, 2, 1
    v_bfe_u32 v4, v2, 4, 1
    v_xor_b32 v3, v3, v4
    v_and_b32 v4, 3, v2
    v_lshl_add_u32 v3, v3, 2, v4
    v_lshlrev_b32 v3, 4, v3
    v_lshl_add_u32 v8, v1, 7, v3
    s_waitcnt lgkmcnt(0)
    s_add_u32 s4, s78, 67108864
    s_addc_u32 s5, s79, 0
    s_mov_b32 s6, 4194304
    s_mov_b32 s7, 0x20000
    s_add_u32 s8, s78, 35651584
    s_addc_u32 s9, s79, 0
    s_mov_b32 s10, 16777216
    s_mov_b32 s11, 0x20000
    s_mov_b32 s12, s74
    s_mov_b32 s13, s75
    s_mov_b32 s14, 2097152
    s_mov_b32 s15, 0x20000
    s_lshl_b32 s43, s62, 1
    s_add_u32 s43, s43, s47
    s_lshl_b32 s43, s43, 19
    s_lshl_b32 s52, s63, 17
    s_add_u32 s43, s43, s52
    s_lshr_b32 s52, s42, 1
    s_lshl_b32 s53, s52, 12
    s_add_u32 s43, s43, s53
    s_lshl_b32 s53, s52, 12
    s_lshl_b32 s44, s47, 13
    s_add_u32 s44, s44, s53
    s_lshl_b32 s45, s61, 2
    s_add_u32 s45, s45, s42
    s_lshl_b32 s45, s45, 18
    s_lshl_b32 s52, s63, 16
    s_add_u32 s45, s45, s52
    s_lshl_b32 s46, s42, 12
    s_add_u32 s46, s46, 16384
    s_lshl_b32 s3, s62, 2
    s_add_u32 s3, s3, s61
    s_and_b32 s3, s3, 15
    s_add_u32 m0, s44, 0
    s_add_u32 s56, s43, 0
    buffer_load_dwordx4 v8, s[4:7], s56 offen lds
    buffer_load_dwordx4 v8, s[4:7], s56 offen offset:1024 lds
    buffer_load_dwordx4 v8, s[4:7], s56 offen offset:2048 lds
    buffer_load_dwordx4 v8, s[4:7], s56 offen offset:3072 lds
    s_add_u32 m0, s46, 0
    s_add_u32 s57, s45, 0
    buffer_load_dwordx4 v14, s[8:11], s57 offen lds
    buffer_load_dwordx4 v14, s[8:11], s57 offen offset:1024 lds
    buffer_load_dwordx4 v14, s[8:11], s57 offen offset:2048 lds
    buffer_load_dwordx4 v14, s[8:11], s57 offen offset:3072 lds
    s_add_u32 m0, s44, 32768
    s_add_u32 s56, s43, 8192
    buffer_load_dwordx4 v8, s[4:7], s56 offen lds
    buffer_load_dwordx4 v8, s[4:7], s56 offen offset:1024 lds
    buffer_load_dwordx4 v8, s[4:7], s56 offen offset:2048 lds
    buffer_load_dwordx4 v8, s[4:7], s56 offen offset:3072 lds
    s_add_u32 m0, s46, 32768
    s_add_u32 s57, s45, 4096
    buffer_load_dwordx4 v14, s[8:11], s57 offen lds
    buffer_load_dwordx4 v14, s[8:11], s57 offen offset:1024 lds
    buffer_load_dwordx4 v14, s[8:11], s57 offen offset:2048 lds
    buffer_load_dwordx4 v14, s[8:11], s57 offen offset:3072 lds
    v_and_b32 v3, 15, v2
    v_lshrrev_b32 v4, 2, v3
    v_and_b32 v3, 3, v3
    v_bfe_u32 v6, v2, 4, 1
    v_lshrrev_b32 v7, 5, v2
    v_lshl_add_u32 v1, v7, 2, v4
    v_lshlrev_b32 v1, 7, v1
    v_lshl_add_u32 v1, v6, 5, v1
    v_lshl_add_u32 v1, v3, 3, v1
    s_lshl_b32 s52, s47, 13
    v_add_u32 v1, s52, v1
    v_lshrrev_b32 v4, 1, v4
    v_xor_b32 v3, 0, v4
    v_lshl_add_u32 v12, v3, 6, v1
    v_add_u32 v10, 0x10000, v12
    v_add_u32 v220, 0x20000, v12
    v_xor_b32 v3, 1, v4
    v_lshl_add_u32 v13, v3, 6, v1
    v_add_u32 v11, 0x10000, v13
    v_add_u32 v221, 0x20000, v13
    s_lshr_b32 s52, s42, 1
    s_lshl_b32 s52, s52, 13
    s_add_u32 s52, s52, 16384
    v_add_u32 v15, s52, v14
    v_add_u32 v9, 0x10000, v15
    v_add_u32 v222, 0x20000, v15
    v_mov_b32 v248, 0
    v_mov_b32 v249, 0
    v_mov_b32 v250, 0
    v_mov_b32 v251, 0
    s_lshr_b32 s48, s42, 1
    s_lshl_b32 s52, s40, 1
    s_add_u32 s48, s48, s52
    v_and_b32 v3, 31, v2
    v_lshrrev_b32 v4, 5, v2
    s_lshl_b32 s52, s48, 15
    s_lshl_b32 s53, s41, 7
    s_add_u32 s52, s52, s53
    s_lshl_b32 s53, s47, 6
    s_add_u32 s52, s52, s53
    v_lshlrev_b32 v5, 10, v3
    v_add_u32 v5, s52, v5
    v_lshl_add_u32 v6, v4, 3, v5
    v_mov_b32 v24, v6
    s_mov_b32 s32, s66
    s_mov_b32 s33, s67
    s_mov_b32 s34, 1835008
    s_mov_b32 s35, 0x20000
    s_add_u32 s28, s78, 54788096
    s_addc_u32 s29, s79, 0
    s_mov_b32 s30, 57344
    s_mov_b32 s31, 0x20000
    s_add_u32 s24, s78, 54919168
    s_addc_u32 s25, s79, 0
    s_mov_b32 s26, 22656
    s_mov_b32 s27, 0x20000
    s_cmp_ge_u32 s2, 28
    s_cselect_b32 s52, 1, 0
    s_mul_i32 s53, s52, 28
    s_sub_u32 s53, s2, s53
    s_lshl_b32 s54, s52, 8
    s_lshl_b32 s55, s42, 6
    s_add_u32 s54, s54, s55
    s_mul_i32 s54, s54, 3584
    s_lshl_b32 s55, s53, 7
    s_add_u32 s54, s54, s55
    s_lshl_b32 s52, s52, 2
    s_add_u32 s52, s52, s42
    s_mul_i32 s52, s52, 7168
    s_lshl_b32 s53, s53, 8
    s_add_u32 s60, s52, s53
    s_cmp_ge_u32 s2, 56
    s_cselect_b32 s54, 0x7000000, s54
    s_cselect_b32 s60, 0x7000000, s60
    v_lshrrev_b32 v1, 3, v2
    v_and_b32 v6, 7, v2
    v_mul_u32_u24 v1, 3584, v1
    v_lshl_add_u32 v1, v6, 4, v1
    v_mov_b32 v25, v1
    s_mov_b32 s50, s54
    s_add_u32 s16, s78, 52428800
    s_addc_u32 s17, s79, 0
    s_mov_b32 s18, 2097152
    s_mov_b32 s19, 0x20000
    s_add_u32 s20, s78, 54525952
    s_addc_u32 s21, s79, 0
    s_mov_b32 s22, 262144
    s_mov_b32 s23, 0x20000
    s_add_u32 s36, s78, 75497472
    s_addc_u32 s37, s79, 0
    s_mov_b32 s38, 8388608
    s_mov_b32 s39, 0x20000
    s_getreg_b32 s52, hwreg(HW_REG_XCC_ID, 0, 4)
    s_mul_i32 s53, s52, s52
    s_lshl_b32 s53, s53, 8
    s_add_u32 s53, s53, s52
    s_add_u32 s53, s53, 0x1000000
    s_lshl_b32 s49, s53, 3
    s_cmp_lg_u32 s42, 0
    s_cbranch_scc1 KC_PLC
    s_add_u32 s52, s40, 145
    s_lshl_b32 s52, s52, 7
    v_mov_b32 v248, s53
    v_mov_b32 v251, s52
    s_mov_b64 exec, 1
    buffer_atomic_add v248, v251, s[24:27], 0 offen
    s_mov_b64 exec, -1
KC_PLC:
    s_waitcnt vmcnt(8)
    s_barrier
    ds_read_b64_tr_b16 v[48:49], v12 offset:0
    ds_read_b64_tr_b16 v[50:51], v12 offset:1024
    ds_read_b64_tr_b16 v[52:53], v13 offset:0
    ds_read_b64_tr_b16 v[54:55], v13 offset:1024
    ds_read_b128 v[32:35], v15 offset:0
    ds_read_b128 v[36:39], v15 offset:4096
    s_waitcnt lgkmcnt(1)
    v_mfma_f32_32x32x16_bf16 v[64:79], v[48:51], v[32:35], 0
    ds_read_b64_tr_b16 v[56:57], v12 offset:2048
    ds_read_b64_tr_b16 v[58:59], v12 offset:3072
    s_add_u32 m0, s44, 65536
    s_add_u32 s56, s43, 16384
    v_mfma_f32_32x32x16_bf16 v[80:95], v[52:55], v[32:35], 0
    ds_read_b64_tr_b16 v[60:61], v13 offset:2048
    ds_read_b64_tr_b16 v[62:63], v13 offset:3072
    buffer_load_dwordx4 v8, s[4:7], s56 offen lds
    s_waitcnt lgkmcnt(4)
    v_mfma_f32_32x32x16_bf16 v[96:111], v[48:51], v[36:39], 0
    ds_read_b128 v[40:43], v15 offset:1024
    ds_read_b128 v[44:47], v15 offset:5120
    buffer_load_dwordx4 v8, s[4:7], s56 offen offset:1024 lds
    v_mfma_f32_32x32x16_bf16 v[112:127], v[52:55], v[36:39], 0
    buffer_load_dwordx4 v8, s[4:7], s56 offen offset:2048 lds
    s_waitcnt lgkmcnt(1)
    v_mfma_f32_32x32x16_bf16 v[64:79], v[56:59], v[40:43], v[64:79]
    ds_read_b64_tr_b16 v[48:49], v12 offset:4096
    ds_read_b64_tr_b16 v[50:51], v12 offset:5120
    buffer_load_dwordx4 v8, s[4:7], s56 offen offset:3072 lds
    v_mfma_f32_32x32x16_bf16 v[80:95], v[60:63], v[40:43], v[80:95]
    ds_read_b64_tr_b16 v[52:53], v13 offset:4096
    ds_read_b64_tr_b16 v[54:55], v13 offset:5120
    s_add_u32 m0, s46, 65536
    s_add_u32 s57, s45, 8192
    s_waitcnt lgkmcnt(4)
    v_mfma_f32_32x32x16_bf16 v[96:111], v[56:59], v[44:47], v[96:111]
    ds_read_b128 v[32:35], v15 offset:2048
    ds_read_b128 v[36:39], v15 offset:6144
    buffer_load_dwordx4 v14, s[8:11], s57 offen lds
    v_mfma_f32_32x32x16_bf16 v[112:127], v[60:63], v[44:47], v[112:127]
    buffer_load_dwordx4 v14, s[8:11], s57 offen offset:1024 lds
    s_waitcnt lgkmcnt(1)
    v_mfma_f32_32x32x16_bf16 v[64:79], v[48:51], v[32:35], v[64:79]
    ds_read_b64_tr_b16 v[56:57], v12 offset:6144
    ds_read_b64_tr_b16 v[58:59], v12 offset:7168
    v_mfma_f32_32x32x16_bf16 v[80:95], v[52:55], v[32:35], v[80:95]
    ds_read_b64_tr_b16 v[60:61], v13 offset:6144
    ds_read_b64_tr_b16 v[62:63], v13 offset:7168
    buffer_load_dwordx4 v14, s[8:11], s57 offen offset:2048 lds
    s_waitcnt lgkmcnt(4)
    v_mfma_f32_32x32x16_bf16 v[96:111], v[48:51], v[36:39], v[96:111]
    ds_read_b128 v[40:43], v15 offset:3072
    ds_read_b128 v[44:47], v15 offset:7168
    buffer_load_dwordx4 v14, s[8:11], s57 offen offset:3072 lds
    v_mfma_f32_32x32x16_bf16 v[112:127], v[52:55], v[36:39], v[112:127]
    s_waitcnt lgkmcnt(1)
    v_mfma_f32_32x32x16_bf16 v[64:79], v[56:59], v[40:43], v[64:79]
    s_waitcnt vmcnt(8)
    s_barrier
    ds_read_b64_tr_b16 v[48:49], v12 offset:32768
    ds_read_b64_tr_b16 v[50:51], v12 offset:33792
    v_mfma_f32_32x32x16_bf16 v[80:95], v[60:63], v[40:43], v[80:95]
    ds_read_b64_tr_b16 v[52:53], v13 offset:32768
    ds_read_b64_tr_b16 v[54:55], v13 offset:33792
    s_add_u32 m0, s44, 98304
    s_add_u32 s56, s43, 24576
    buffer_load_dwordx2 v[16:17], v24, s[12:15], 0 offen
    s_waitcnt lgkmcnt(4)
    v_mfma_f32_32x32x16_bf16 v[96:111], v[56:59], v[44:47], v[96:111]
    ds_read_b128 v[32:35], v15 offset:32768
    ds_read_b128 v[36:39], v15 offset:36864
    buffer_load_dwordx4 v8, s[4:7], s56 offen lds
    buffer_load_dwordx2 v[18:19], v24, s[12:15], 0 offen offset:16
    v_mfma_f32_32x32x16_bf16 v[112:127], v[60:63], v[44:47], v[112:127]
    buffer_load_dwordx4 v8, s[4:7], s56 offen offset:1024 lds
    buffer_load_dwordx2 v[20:21], v24, s[12:15], 0 offen offset:32
    s_waitcnt lgkmcnt(1)
    v_mfma_f32_32x32x16_bf16 v[64:79], v[48:51], v[32:35], v[64:79]
    ds_read_b64_tr_b16 v[56:57], v12 offset:34816
    ds_read_b64_tr_b16 v[58:59], v12 offset:35840
    buffer_load_dwordx4 v8, s[4:7], s56 offen offset:2048 lds
    v_mfma_f32_32x32x16_bf16 v[80:95], v[52:55], v[32:35], v[80:95]
    ds_read_b64_tr_b16 v[60:61], v13 offset:34816
    ds_read_b64_tr_b16 v[62:63], v13 offset:35840
    buffer_load_dwordx4 v8, s[4:7], s56 offen offset:3072 lds
    buffer_load_dwordx2 v[22:23], v24, s[12:15], 0 offen offset:48
    s_waitcnt lgkmcnt(4)
    v_mfma_f32_32x32x16_bf16 v[96:111], v[48:51], v[36:39], v[96:111]
    ds_read_b128 v[40:43], v15 offset:33792
    ds_read_b128 v[44:47], v15 offset:37888
    s_add_u32 m0, s46, 98304
    s_add_u32 s57, s45, 12288
    buffer_load_dwordx4 v[128:131], v25, s[32:35], s50 offen
    s_add_u32 s50, s50, 28672
    v_mfma_f32_32x32x16_bf16 v[112:127], v[52:55], v[36:39], v[112:127]
    buffer_load_dwordx4 v14, s[8:11], s57 offen lds
    buffer_load_dwordx4 v[132:135], v25, s[32:35], s50 offen
    s_add_u32 s50, s50, 28672
    s_waitcnt lgkmcnt(1)
    v_mfma_f32_32x32x16_bf16 v[64:79], v[56:59], v[40:43], v[64:79]
    ds_read_b64_tr_b16 v[48:49], v12 offset:36864
    ds_read_b64_tr_b16 v[50:51], v12 offset:37888
    v_mfma_f32_32x32x16_bf16 v[80:95], v[60:63], v[40:43], v[80:95]
    ds_read_b64_tr_b16 v[52:53], v13 offset:36864
    ds_read_b64_tr_b16 v[54:55], v13 offset:37888
    buffer_load_dwordx4 v14, s[8:11], s57 offen offset:1024 lds
    buffer_load_dwordx4 v[136:139], v25, s[32:35], s50 offen
    s_add_u32 s50, s50, 28672
    s_waitcnt lgkmcnt(4)
    v_mfma_f32_32x32x16_bf16 v[96:111], v[56:59], v[44:47], v[96:111]
    ds_read_b128 v[32:35], v15 offset:34816
    ds_read_b128 v[36:39], v15 offset:38912
    buffer_load_dwordx4 v14, s[8:11], s57 offen offset:2048 lds
    buffer_load_dwordx4 v[140:143], v25, s[32:35], s50 offen
    s_add_u32 s50, s50, 28672
    v_mfma_f32_32x32x16_bf16 v[112:127], v[60:63], v[44:47], v[112:127]
    buffer_load_dwordx4 v14, s[8:11], s57 offen offset:3072 lds
    buffer_load_dwordx4 v[144:147], v25, s[32:35], s50 offen
    s_add_u32 s50, s50, 28672
    s_waitcnt lgkmcnt(1)
    v_mfma_f32_32x32x16_bf16 v[64:79], v[48:51], v[32:35], v[64:79]
    ds_read_b64_tr_b16 v[56:57], v12 offset:38912
    ds_read_b64_tr_b16 v[58:59], v12 offset:39936
    v_mfma_f32_32x32x16_bf16 v[80:95], v[52:55], v[32:35], v[80:95]
    ds_read_b64_tr_b16 v[60:61], v13 offset:38912
    ds_read_b64_tr_b16 v[62:63], v13 offset:39936
    buffer_load_dwordx4 v[148:151], v25, s[32:35], s50 offen
    s_add_u32 s50, s50, 28672
    s_waitcnt lgkmcnt(4)
    v_mfma_f32_32x32x16_bf16 v[96:111], v[48:51], v[36:39], v[96:111]
    ds_read_b128 v[40:43], v15 offset:35840
    ds_read_b128 v[44:47], v15 offset:39936
    buffer_load_dwordx4 v[152:155], v25, s[32:35], s50 offen
    s_add_u32 s50, s50, 28672
    v_mfma_f32_32x32x16_bf16 v[112:127], v[52:55], v[36:39], v[112:127]
    buffer_load_dwordx4 v[156:159], v25, s[32:35], s50 offen
    s_add_u32 s50, s50, 28672
    s_waitcnt lgkmcnt(1)
    v_mfma_f32_32x32x16_bf16 v[64:79], v[56:59], v[40:43], v[64:79]
    s_waitcnt vmcnt(20)
    s_barrier
    ds_read_b64_tr_b16 v[48:49], v10 offset:0
    ds_read_b64_tr_b16 v[50:51], v10 offset:1024
    v_mfma_f32_32x32x16_bf16 v[80:95], v[60:63], v[40:43], v[80:95]
    ds_read_b64_tr_b16 v[52:53], v11 offset:0
    ds_read_b64_tr_b16 v[54:55], v11 offset:1024
    s_add_u32 m0, s44, 0
    s_add_u32 s56, s43, 32768
    s_waitcnt lgkmcnt(4)
    v_mfma_f32_32x32x16_bf16 v[96:111], v[56:59], v[44:47], v[96:111]
    ds_read_b128 v[32:35], v9 offset:0
    ds_read_b128 v[36:39], v9 offset:4096
    buffer_load_dwordx4 v8, s[4:7], s56 offen lds
    v_mfma_f32_32x32x16_bf16 v[112:127], v[60:63], v[44:47], v[112:127]
    buffer_load_dwordx4 v8, s[4:7], s56 offen offset:1024 lds
    s_waitcnt lgkmcnt(1)
    v_mfma_f32_32x32x16_bf16 v[64:79], v[48:51], v[32:35], v[64:79]
    ds_read_b64_tr_b16 v[56:57], v10 offset:2048
    ds_read_b64_tr_b16 v[58:59], v10 offset:3072
    buffer_load_dwordx4 v8, s[4:7], s56 offen offset:2048 lds
    v_mfma_f32_32x32x16_bf16 v[80:95], v[52:55], v[32:35], v[80:95]
    ds_read_b64_tr_b16 v[60:61], v11 offset:2048
    ds_read_b64_tr_b16 v[62:63], v11 offset:3072
    buffer_load_dwordx4 v8, s[4:7], s56 offen offset:3072 lds
    s_waitcnt lgkmcnt(4)
    v_mfma_f32_32x32x16_bf16 v[96:111], v[48:51], v[36:39], v[96:111]
    ds_read_b128 v[40:43], v9 offset:1024
    ds_read_b128 v[44:47], v9 offset:5120
    s_add_u32 m0, s46, 0
    s_add_u32 s57, s45, 16384
    v_mfma_f32_32x32x16_bf16 v[112:127], v[52:55], v[36:39], v[112:127]
    buffer_load_dwordx4 v14, s[8:11], s57 offen lds
    s_waitcnt lgkmcnt(1)
    v_mfma_f32_32x32x16_bf16 v[64:79], v[56:59], v[40:43], v[64:79]
    ds_read_b64_tr_b16 v[48:49], v10 offset:4096
    ds_read_b64_tr_b16 v[50:51], v10 offset:5120
    v_mfma_f32_32x32x16_bf16 v[80:95], v[60:63], v[40:43], v[80:95]
    ds_read_b64_tr_b16 v[52:53], v11 offset:4096
    ds_read_b64_tr_b16 v[54:55], v11 offset:5120
    buffer_load_dwordx4 v14, s[8:11], s57 offen offset:1024 lds
    s_waitcnt lgkmcnt(4)
    v_mfma_f32_32x32x16_bf16 v[96:111], v[56:59], v[44:47], v[96:111]
    ds_read_b128 v[32:35], v9 offset:2048
    ds_read_b128 v[36:39], v9 offset:6144
    buffer_load_dwordx4 v14, s[8:11], s57 offen offset:2048 lds
    v_mfma_f32_32x32x16_bf16 v[112:127], v[60:63], v[44:47], v[112:127]
    buffer_load_dwordx4 v14, s[8:11], s57 offen offset:3072 lds
    s_waitcnt lgkmcnt(1)
    v_mfma_f32_32x32x16_bf16 v[64:79], v[48:51], v[32:35], v[64:79]
    ds_read_b64_tr_b16 v[56:57], v10 offset:6144
    ds_read_b64_tr_b16 v[58:59], v10 offset:7168
    v_mfma_f32_32x32x16_bf16 v[80:95], v[52:55], v[32:35], v[80:95]
    ds_read_b64_tr_b16 v[60:61], v11 offset:6144
    ds_read_b64_tr_b16 v[62:63], v11 offset:7168
    s_waitcnt lgkmcnt(4)
    v_mfma_f32_32x32x16_bf16 v[96:111], v[48:51], v[36:39], v[96:111]
    ds_read_b128 v[40:43], v9 offset:3072
    ds_read_b128 v[44:47], v9 offset:7168
    v_mfma_f32_32x32x16_bf16 v[112:127], v[52:55], v[36:39], v[112:127]
    s_waitcnt lgkmcnt(1)
    v_mfma_f32_32x32x16_bf16 v[64:79], v[56:59], v[40:43], v[64:79]
    s_waitcnt vmcnt(12)
    s_barrier
    ds_read_b64_tr_b16 v[48:49], v10 offset:32768
    ds_read_b64_tr_b16 v[50:51], v10 offset:33792
    v_mfma_f32_32x32x16_bf16 v[80:95], v[60:63], v[40:43], v[80:95]
    ds_read_b64_tr_b16 v[52:53], v11 offset:32768
    ds_read_b64_tr_b16 v[54:55], v11 offset:33792
    s_add_u32 m0, s44, 32768
    s_add_u32 s56, s43, 40960
    s_waitcnt lgkmcnt(4)
    v_mfma_f32_32x32x16_bf16 v[96:111], v[56:59], v[44:47], v[96:111]
    ds_read_b128 v[32:35], v9 offset:32768
    ds_read_b128 v[36:39], v9 offset:36864
    buffer_load_dwordx4 v8, s[4:7], s56 offen lds
    v_mfma_f32_32x32x16_bf16 v[112:127], v[60:63], v[44:47], v[112:127]
    buffer_load_dwordx4 v8, s[4:7], s56 offen offset:1024 lds
    s_waitcnt lgkmcnt(1)
    v_mfma_f32_32x32x16_bf16 v[64:79], v[48:51], v[32:35], v[64:79]
    ds_read_b64_tr_b16 v[56:57], v10 offset:34816
    ds_read_b64_tr_b16 v[58:59], v10 offset:35840
    buffer_load_dwordx4 v8, s[4:7], s56 offen offset:2048 lds
    v_lshlrev_b32 v170, 16, v128
    v_mfma_f32_32x32x16_bf16 v[80:95], v[52:55], v[32:35], v[80:95]
    ds_read_b64_tr_b16 v[60:61], v11 offset:34816
    ds_read_b64_tr_b16 v[62:63], v11 offset:35840
    buffer_load_dwordx4 v8, s[4:7], s56 offen offset:3072 lds
    v_and_b32 v171, 0xffff0000, v128
    s_waitcnt lgkmcnt(4)
    v_mfma_f32_32x32x16_bf16 v[96:111], v[48:51], v[36:39], v[96:111]
    ds_read_b128 v[40:43], v9 offset:33792
    ds_read_b128 v[44:47], v9 offset:37888
    s_add_u32 m0, s46, 32768
    s_add_u32 s57, s45, 20480
    v_mfma_f32_32x32x16_bf16 v[112:127], v[52:55], v[36:39], v[112:127]
    buffer_load_dwordx4 v14, s[8:11], s57 offen lds
    v_lshlrev_b32 v172, 16, v129
    v_and_b32 v173, 0xffff0000, v129
    v_lshlrev_b32 v174, 16, v130
    s_waitcnt lgkmcnt(1)
    v_mfma_f32_32x32x16_bf16 v[64:79], v[56:59], v[40:43], v[64:79]
    ds_read_b64_tr_b16 v[48:49], v10 offset:36864
    ds_read_b64_tr_b16 v[50:51], v10 offset:37888
    v_and_b32 v175, 0xffff0000, v130
    v_lshlrev_b32 v176, 16, v131
    v_mfma_f32_32x32x16_bf16 v[80:95], v[60:63], v[40:43], v[80:95]
    ds_read_b64_tr_b16 v[52:53], v11 offset:36864
    ds_read_b64_tr_b16 v[54:55], v11 offset:37888
    buffer_load_dwordx4 v14, s[8:11], s57 offen offset:1024 lds
    v_and_b32 v177, 0xffff0000, v131
    s_waitcnt lgkmcnt(4)
    v_mfma_f32_32x32x16_bf16 v[96:111], v[56:59], v[44:47], v[96:111]
    ds_read_b128 v[32:35], v9 offset:34816
    ds_read_b128 v[36:39], v9 offset:38912
    buffer_load_dwordx4 v14, s[8:11], s57 offen offset:2048 lds
    v_lshlrev_b32 v180, 16, v132
    v_mfma_f32_32x32x16_bf16 v[112:127], v[60:63], v[44:47], v[112:127]
    buffer_load_dwordx4 v14, s[8:11], s57 offen offset:3072 lds
    v_and_b32 v181, 0xffff0000, v132
    v_add_f32 v170, v170, v180
    v_add_f32 v171, v171, v181
    s_waitcnt lgkmcnt(1)
    v_mfma_f32_32x32x16_bf16 v[64:79], v[48:51], v[32:35], v[64:79]
    ds_read_b64_tr_b16 v[56:57], v10 offset:38912
    ds_read_b64_tr_b16 v[58:59], v10 offset:39936
    v_lshlrev_b32 v180, 16, v133
    v_and_b32 v181, 0xffff0000, v133
    v_mfma_f32_32x32x16_bf16 v[80:95], v[52:55], v[32:35], v[80:95]
    ds_read_b64_tr_b16 v[60:61], v11 offset:38912
    ds_read_b64_tr_b16 v[62:63], v11 offset:39936
    v_add_f32 v172, v172, v180
    v_add_f32 v173, v173, v181
    s_waitcnt lgkmcnt(4)
    v_mfma_f32_32x32x16_bf16 v[96:111], v[48:51], v[36:39], v[96:111]
    ds_read_b128 v[40:43], v9 offset:35840
    ds_read_b128 v[44:47], v9 offset:39936
    v_lshlrev_b32 v180, 16, v134
    v_and_b32 v181, 0xffff0000, v134
    v_mfma_f32_32x32x16_bf16 v[112:127], v[52:55], v[36:39], v[112:127]
    v_add_f32 v174, v174, v180
    v_add_f32 v175, v175, v181
    v_lshlrev_b32 v180, 16, v135
    v_and_b32 v181, 0xffff0000, v135
    s_waitcnt lgkmcnt(1)
    v_mfma_f32_32x32x16_bf16 v[64:79], v[56:59], v[40:43], v[64:79]
    s_waitcnt vmcnt(8)
    s_barrier
    ds_read_b64_tr_b16 v[48:49], v12 offset:0
    ds_read_b64_tr_b16 v[50:51], v12 offset:1024
    v_mfma_f32_32x32x16_bf16 v[80:95], v[60:63], v[40:43], v[80:95]
    ds_read_b64_tr_b16 v[52:53], v13 offset:0
    ds_read_b64_tr_b16 v[54:55], v13 offset:1024
    s_add_u32 m0, s44, 65536
    s_add_u32 s56, s43, 49152
    s_waitcnt lgkmcnt(4)
    v_mfma_f32_32x32x16_bf16 v[96:111], v[56:59], v[44:47], v[96:111]
    ds_read_b128 v[32:35], v15 offset:0
    ds_read_b128 v[36:39], v15 offset:4096
    buffer_load_dwordx4 v8, s[4:7], s56 offen lds
    v_add_f32 v176, v176, v180
    v_mfma_f32_32x32x16_bf16 v[112:127], v[60:63], v[44:47], v[112:127]
    buffer_load_dwordx4 v8, s[4:7], s56 offen offset:1024 lds
    v_add_f32 v177, v177, v181
    v_lshlrev_b32 v180, 16, v136
    v_and_b32 v181, 0xffff0000, v136
    s_waitcnt lgkmcnt(1)
    v_mfma_f32_32x32x16_bf16 v[64:79], v[48:51], v[32:35], v[64:79]
    ds_read_b64_tr_b16 v[56:57], v12 offset:2048
    ds_read_b64_tr_b16 v[58:59], v12 offset:3072
    buffer_load_dwordx4 v8, s[4:7], s56 offen offset:2048 lds
    v_add_f32 v170, v170, v180
    v_mfma_f32_32x32x16_bf16 v[80:95], v[52:55], v[32:35], v[80:95]
    ds_read_b64_tr_b16 v[60:61], v13 offset:2048
    ds_read_b64_tr_b16 v[62:63], v13 offset:3072
    buffer_load_dwordx4 v8, s[4:7], s56 offen offset:3072 lds
    v_add_f32 v171, v171, v181
    s_waitcnt lgkmcnt(4)
    v_mfma_f32_32x32x16_bf16 v[96:111], v[48:51], v[36:39], v[96:111]
    ds_read_b128 v[40:43], v15 offset:1024
    ds_read_b128 v[44:47], v15 offset:5120
    s_add_u32 m0, s46, 65536
    s_add_u32 s57, s45, 24576
    v_mfma_f32_32x32x16_bf16 v[112:127], v[52:55], v[36:39], v[112:127]
    buffer_load_dwordx4 v14, s[8:11], s57 offen lds
    v_lshlrev_b32 v180, 16, v137
    v_and_b32 v181, 0xffff0000, v137
    v_add_f32 v172, v172, v180
    s_waitcnt lgkmcnt(1)
    v_mfma_f32_32x32x16_bf16 v[64:79], v[56:59], v[40:43], v[64:79]
    ds_read_b64_tr_b16 v[48:49], v12 offset:4096
    ds_read_b64_tr_b16 v[50:51], v12 offset:5120
    v_add_f32 v173, v173, v181
    v_lshlrev_b32 v180, 16, v138
    v_mfma_f32_32x32x16_bf16 v[80:95], v[60:63], v[40:43], v[80:95]
    ds_read_b64_tr_b16 v[52:53], v13 offset:4096
    ds_read_b64_tr_b16 v[54:55], v13 offset:5120
    buffer_load_dwordx4 v14, s[8:11], s57 offen offset:1024 lds
    v_and_b32 v181, 0xffff0000, v138
    s_waitcnt lgkmcnt(4)
    v_mfma_f32_32x32x16_bf16 v[96:111], v[56:59], v[44:47], v[96:111]
    ds_read_b128 v[32:35], v15 offset:2048
    ds_read_b128 v[36:39], v15 offset:6144
    buffer_load_dwordx4 v14, s[8:11], s57 offen offset:2048 lds
    v_add_f32 v174, v174, v180
    v_mfma_f32_32x32x16_bf16 v[112:127], v[60:63], v[44:47], v[112:127]
    buffer_load_dwordx4 v14, s[8:11], s57 offen offset:3072 lds
    v_add_f32 v175, v175, v181
    v_lshlrev_b32 v180, 16, v139
    v_and_b32 v181, 0xffff0000, v139
    s_waitcnt lgkmcnt(1)
    v_mfma_f32_32x32x16_bf16 v[64:79], v[48:51], v[32:35], v[64:79]
    ds_read_b64_tr_b16 v[56:57], v12 offset:6144
    ds_read_b64_tr_b16 v[58:59], v12 offset:7168
    v_add_f32 v176, v176, v180
    v_add_f32 v177, v177, v181
    v_mfma_f32_32x32x16_bf16 v[80:95], v[52:55], v[32:35], v[80:95]
    ds_read_b64_tr_b16 v[60:61], v13 offset:6144
    ds_read_b64_tr_b16 v[62:63], v13 offset:7168
    v_lshlrev_b32 v180, 16, v140
    v_and_b32 v181, 0xffff0000, v140
    s_waitcnt lgkmcnt(4)
    v_mfma_f32_32x32x16_bf16 v[96:111], v[48:51], v[36:39], v[96:111]
    ds_read_b128 v[40:43], v15 offset:3072
    ds_read_b128 v[44:47], v15 offset:7168
    v_add_f32 v170, v170, v180
    v_add_f32 v171, v171, v181
    v_lshlrev_b32 v180, 16, v141
    v_mfma_f32_32x32x16_bf16 v[112:127], v[52:55], v[36:39], v[112:127]
    v_and_b32 v181, 0xffff0000, v141
    v_add_f32 v172, v172, v180
    v_add_f32 v173, v173, v181
    v_lshlrev_b32 v180, 16, v142
    v_and_b32 v181, 0xffff0000, v142
    s_waitcnt lgkmcnt(1)
    v_mfma_f32_32x32x16_bf16 v[64:79], v[56:59], v[40:43], v[64:79]
    s_waitcnt vmcnt(8)
    s_barrier
    ds_read_b64_tr_b16 v[48:49], v12 offset:32768
    ds_read_b64_tr_b16 v[50:51], v12 offset:33792
    v_add_f32 v174, v174, v180
    v_mfma_f32_32x32x16_bf16 v[80:95], v[60:63], v[40:43], v[80:95]
    ds_read_b64_tr_b16 v[52:53], v13 offset:32768
    ds_read_b64_tr_b16 v[54:55], v13 offset:33792
    s_add_u32 m0, s44, 98304
    s_add_u32 s56, s43, 57344
    v_add_f32 v175, v175, v181
    s_waitcnt lgkmcnt(4)
    v_mfma_f32_32x32x16_bf16 v[96:111], v[56:59], v[44:47], v[96:111]
    ds_read_b128 v[32:35], v15 offset:32768
    ds_read_b128 v[36:39], v15 offset:36864
    buffer_load_dwordx4 v8, s[4:7], s56 offen lds
    v_lshlrev_b32 v180, 16, v143
    v_and_b32 v181, 0xffff0000, v143
    v_mfma_f32_32x32x16_bf16 v[112:127], v[60:63], v[44:47], v[112:127]
    buffer_load_dwordx4 v8, s[4:7], s56 offen offset:1024 lds
    v_add_f32 v176, v176, v180
    v_add_f32 v177, v177, v181
    v_lshlrev_b32 v180, 16, v144
    v_and_b32 v181, 0xffff0000, v144
    s_waitcnt lgkmcnt(1)
    v_mfma_f32_32x32x16_bf16 v[64:79], v[48:51], v[32:35], v[64:79]
    ds_read_b64_tr_b16 v[56:57], v12 offset:34816
    ds_read_b64_tr_b16 v[58:59], v12 offset:35840
    buffer_load_dwordx4 v8, s[4:7], s56 offen offset:2048 lds
    v_add_f32 v170, v170, v180
    v_add_f32 v171, v171, v181
    v_mfma_f32_32x32x16_bf16 v[80:95], v[52:55], v[32:35], v[80:95]
    ds_read_b64_tr_b16 v[60:61], v13 offset:34816
    ds_read_b64_tr_b16 v[62:63], v13 offset:35840
    buffer_load_dwordx4 v8, s[4:7], s56 offen offset:3072 lds
    v_lshlrev_b32 v180, 16, v145
    v_and_b32 v181, 0xffff0000, v145
    s_waitcnt lgkmcnt(4)
    v_mfma_f32_32x32x16_bf16 v[96:111], v[48:51], v[36:39], v[96:111]
    ds_read_b128 v[40:43], v15 offset:33792
    ds_read_b128 v[44:47], v15 offset:37888
    s_add_u32 m0, s46, 98304
    s_add_u32 s57, s45, 28672
    v_add_f32 v172, v172, v180
    v_mfma_f32_32x32x16_bf16 v[112:127], v[52:55], v[36:39], v[112:127]
    buffer_load_dwordx4 v14, s[8:11], s57 offen lds
    v_add_f32 v173, v173, v181
    v_lshlrev_b32 v180, 16, v146
    v_and_b32 v181, 0xffff0000, v146
    v_add_f32 v174, v174, v180
    s_waitcnt lgkmcnt(1)
    v_mfma_f32_32x32x16_bf16 v[64:79], v[56:59], v[40:43], v[64:79]
    ds_read_b64_tr_b16 v[48:49], v12 offset:36864
    ds_read_b64_tr_b16 v[50:51], v12 offset:37888
    v_add_f32 v175, v175, v181
    v_lshlrev_b32 v180, 16, v147
    v_and_b32 v181, 0xffff0000, v147
    v_mfma_f32_32x32x16_bf16 v[80:95], v[60:63], v[40:43], v[80:95]
    ds_read_b64_tr_b16 v[52:53], v13 offset:36864
    ds_read_b64_tr_b16 v[54:55], v13 offset:37888
    buffer_load_dwordx4 v14, s[8:11], s57 offen offset:1024 lds
    v_add_f32 v176, v176, v180
    v_add_f32 v177, v177, v181
    s_waitcnt lgkmcnt(4)
    v_mfma_f32_32x32x16_bf16 v[96:111], v[56:59], v[44:47], v[96:111]
    ds_read_b128 v[32:35], v15 offset:34816
    ds_read_b128 v[36:39], v15 offset:38912
    buffer_load_dwordx4 v14, s[8:11], s57 offen offset:2048 lds
    v_lshlrev_b32 v180, 16, v148
    v_and_b32 v181, 0xffff0000, v148
    v_mfma_f32_32x32x16_bf16 v[112:127], v[60:63], v[44:47], v[112:127]
    buffer_load_dwordx4 v14, s[8:11], s57 offen offset:3072 lds
    v_add_f32 v170, v170, v180
    v_add_f32 v171, v171, v181
    v_lshlrev_b32 v180, 16, v149
    v_and_b32 v181, 0xffff0000, v149
    s_waitcnt lgkmcnt(1)
    v_mfma_f32_32x32x16_bf16 v[64:79], v[48:51], v[32:35], v[64:79]
    ds_read_b64_tr_b16 v[56:57], v12 offset:38912
    ds_read_b64_tr_b16 v[58:59], v12 offset:39936
    v_add_f32 v172, v172, v180
    v_add_f32 v173, v173, v181
    v_lshlrev_b32 v180, 16, v150
    v_mfma_f32_32x32x16_bf16 v[80:95], v[52:55], v[32:35], v[80:95]
    ds_read_b64_tr_b16 v[60:61], v13 offset:38912
    ds_read_b64_tr_b16 v[62:63], v13 offset:39936
    v_and_b32 v181, 0xffff0000, v150
    v_add_f32 v174, v174, v180
    v_add_f32 v175, v175, v181
    s_waitcnt lgkmcnt(4)
    v_mfma_f32_32x32x16_bf16 v[96:111], v[48:51], v[36:39], v[96:111]
    ds_read_b128 v[40:43], v15 offset:35840
    ds_read_b128 v[44:47], v15 offset:39936
    v_lshlrev_b32 v180, 16, v151
    v_and_b32 v181, 0xffff0000, v151
    v_add_f32 v176, v176, v180
    v_mfma_f32_32x32x16_bf16 v[112:127], v[52:55], v[36:39], v[112:127]
    v_add_f32 v177, v177, v181
    v_lshlrev_b32 v180, 16, v152
    v_and_b32 v181, 0xffff0000, v152
    v_add_f32 v170, v170, v180
    v_add_f32 v171, v171, v181
    s_waitcnt lgkmcnt(1)
    v_mfma_f32_32x32x16_bf16 v[64:79], v[56:59], v[40:43], v[64:79]
    s_waitcnt vmcnt(8)
    s_barrier
    ds_read_b64_tr_b16 v[48:49], v10 offset:0
    ds_read_b64_tr_b16 v[50:51], v10 offset:1024
    v_lshlrev_b32 v180, 16, v153
    v_mfma_f32_32x32x16_bf16 v[80:95], v[60:63], v[40:43], v[80:95]
    ds_read_b64_tr_b16 v[52:53], v11 offset:0
    ds_read_b64_tr_b16 v[54:55], v11 offset:1024
    s_add_u32 m0, s44, 0
    s_add_u32 s56, s43, 65536
    v_and_b32 v181, 0xffff0000, v153
    s_waitcnt lgkmcnt(4)
    v_mfma_f32_32x32x16_bf16 v[96:111], v[56:59], v[44:47], v[96:111]
    ds_read_b128 v[32:35], v9 offset:0
    ds_read_b128 v[36:39], v9 offset:4096
    buffer_load_dwordx4 v8, s[4:7], s56 offen lds
    v_add_f32 v172, v172, v180
    v_add_f32 v173, v173, v181
    v_mfma_f32_32x32x16_bf16 v[112:127], v[60:63], v[44:47], v[112:127]
    buffer_load_dwordx4 v8, s[4:7], s56 offen offset:1024 lds
    v_lshlrev_b32 v180, 16, v154
    v_and_b32 v181, 0xffff0000, v154
    v_add_f32 v174, v174, v180
    v_add_f32 v175, v175, v181
    s_waitcnt lgkmcnt(1)
    v_mfma_f32_32x32x16_bf16 v[64:79], v[48:51], v[32:35], v[64:79]
    ds_read_b64_tr_b16 v[56:57], v10 offset:2048
    ds_read_b64_tr_b16 v[58:59], v10 offset:3072
    buffer_load_dwordx4 v8, s[4:7], s56 offen offset:2048 lds
    v_lshlrev_b32 v180, 16, v155
    v_and_b32 v181, 0xffff0000, v155
    v_mfma_f32_32x32x16_bf16 v[80:95], v[52:55], v[32:35], v[80:95]
    ds_read_b64_tr_b16 v[60:61], v11 offset:2048
    ds_read_b64_tr_b16 v[62:63], v11 offset:3072
    buffer_load_dwordx4 v8, s[4:7], s56 offen offset:3072 lds
    v_add_f32 v176, v176, v180
    v_add_f32 v177, v177, v181
    s_waitcnt lgkmcnt(4)
    v_mfma_f32_32x32x16_bf16 v[96:111], v[48:51], v[36:39], v[96:111]
    ds_read_b128 v[40:43], v9 offset:1024
    ds_read_b128 v[44:47], v9 offset:5120
    s_add_u32 m0, s46, 0
    s_add_u32 s57, s45, 32768
    v_lshlrev_b32 v180, 16, v156
    v_mfma_f32_32x32x16_bf16 v[112:127], v[52:55], v[36:39], v[112:127]
    buffer_load_dwordx4 v14, s[8:11], s57 offen lds
    v_and_b32 v181, 0xffff0000, v156
    v_add_f32 v170, v170, v180
    v_add_f32 v171, v171, v181
    v_lshlrev_b32 v180, 16, v157
    s_waitcnt lgkmcnt(1)
    v_mfma_f32_32x32x16_bf16 v[64:79], v[56:59], v[40:43], v[64:79]
    ds_read_b64_tr_b16 v[48:49], v10 offset:4096
    ds_read_b64_tr_b16 v[50:51], v10 offset:5120
    v_and_b32 v181, 0xffff0000, v157
    v_add_f32 v172, v172, v180
    v_add_f32 v173, v173, v181
    v_mfma_f32_32x32x16_bf16 v[80:95], v[60:63], v[40:43], v[80:95]
    ds_read_b64_tr_b16 v[52:53], v11 offset:4096
    ds_read_b64_tr_b16 v[54:55], v11 offset:5120
    buffer_load_dwordx4 v14, s[8:11], s57 offen offset:1024 lds
    v_lshlrev_b32 v180, 16, v158
    v_and_b32 v181, 0xffff0000, v158
    s_waitcnt lgkmcnt(4)
    v_mfma_f32_32x32x16_bf16 v[96:111], v[56:59], v[44:47], v[96:111]
    ds_read_b128 v[32:35], v9 offset:2048
    ds_read_b128 v[36:39], v9 offset:6144
    buffer_load_dwordx4 v14, s[8:11], s57 offen offset:2048 lds
    v_add_f32 v174, v174, v180
    v_add_f32 v175, v175, v181
    v_mfma_f32_32x32x16_bf16 v[112:127], v[60:63], v[44:47], v[112:127]
    buffer_load_dwordx4 v14, s[8:11], s57 offen offset:3072 lds
    v_lshlrev_b32 v180, 16, v159
    v_and_b32 v181, 0xffff0000, v159
    v_add_f32 v176, v176, v180
    v_add_f32 v177, v177, v181
    s_waitcnt lgkmcnt(1)
    v_mfma_f32_32x32x16_bf16 v[64:79], v[48:51], v[32:35], v[64:79]
    ds_read_b64_tr_b16 v[56:57], v10 offset:6144
    ds_read_b64_tr_b16 v[58:59], v10 offset:7168
    v_mfma_f32_32x32x16_bf16 v[80:95], v[52:55], v[32:35], v[80:95]
    ds_read_b64_tr_b16 v[60:61], v11 offset:6144
    ds_read_b64_tr_b16 v[62:63], v11 offset:7168
    s_waitcnt lgkmcnt(4)
    v_mfma_f32_32x32x16_bf16 v[96:111], v[48:51], v[36:39], v[96:111]
    ds_read_b128 v[40:43], v9 offset:3072
    ds_read_b128 v[44:47], v9 offset:7168
    v_mfma_f32_32x32x16_bf16 v[112:127], v[52:55], v[36:39], v[112:127]
    ds_swizzle_b32 v182, v170 offset:8223
    ds_swizzle_b32 v183, v171 offset:8223
    ds_swizzle_b32 v184, v172 offset:8223
    ds_swizzle_b32 v185, v173 offset:8223
    ds_swizzle_b32 v186, v174 offset:8223
    ds_swizzle_b32 v187, v175 offset:8223
    ds_swizzle_b32 v188, v176 offset:8223
    ds_swizzle_b32 v189, v177 offset:8223
    s_waitcnt lgkmcnt(9)
    v_mfma_f32_32x32x16_bf16 v[64:79], v[56:59], v[40:43], v[64:79]
    s_waitcnt vmcnt(8)
    s_barrier
    ds_read_b64_tr_b16 v[48:49], v10 offset:32768
    ds_read_b64_tr_b16 v[50:51], v10 offset:33792
    v_mfma_f32_32x32x16_bf16 v[80:95], v[60:63], v[40:43], v[80:95]
    ds_read_b64_tr_b16 v[52:53], v11 offset:32768
    ds_read_b64_tr_b16 v[54:55], v11 offset:33792
    s_add_u32 m0, s44, 32768
    s_add_u32 s56, s43, 73728
    s_waitcnt lgkmcnt(12)
    v_mfma_f32_32x32x16_bf16 v[96:111], v[56:59], v[44:47], v[96:111]
    ds_read_b128 v[32:35], v9 offset:32768
    ds_read_b128 v[36:39], v9 offset:36864
    buffer_load_dwordx4 v8, s[4:7], s56 offen lds
    v_mfma_f32_32x32x16_bf16 v[112:127], v[60:63], v[44:47], v[112:127]
    buffer_load_dwordx4 v8, s[4:7], s56 offen offset:1024 lds
    s_waitcnt lgkmcnt(1)
    v_mfma_f32_32x32x16_bf16 v[64:79], v[48:51], v[32:35], v[64:79]
    ds_read_b64_tr_b16 v[56:57], v10 offset:34816
    ds_read_b64_tr_b16 v[58:59], v10 offset:35840
    buffer_load_dwordx4 v8, s[4:7], s56 offen offset:2048 lds
    v_mfma_f32_32x32x16_bf16 v[80:95], v[52:55], v[32:35], v[80:95]
    ds_read_b64_tr_b16 v[60:61], v11 offset:34816
    ds_read_b64_tr_b16 v[62:63], v11 offset:35840
    buffer_load_dwordx4 v8, s[4:7], s56 offen offset:3072 lds
    s_waitcnt lgkmcnt(4)
    v_mfma_f32_32x32x16_bf16 v[96:111], v[48:51], v[36:39], v[96:111]
    ds_read_b128 v[40:43], v9 offset:33792
    ds_read_b128 v[44:47], v9 offset:37888
    s_add_u32 m0, s46, 32768
    s_add_u32 s57, s45, 36864
    v_mfma_f32_32x32x16_bf16 v[112:127], v[52:55], v[36:39], v[112:127]
    buffer_load_dwordx4 v14, s[8:11], s57 offen lds
    v_add_f32 v170, v170, v182
    v_add_f32 v171, v171, v183
    v_add_f32 v172, v172, v184
    v_add_f32 v173, v173, v185
    v_add_f32 v174, v174, v186
    v_add_f32 v175, v175, v187
    v_add_f32 v176, v176, v188
    v_add_f32 v177, v177, v189
    ds_swizzle_b32 v182, v170 offset:16415
    ds_swizzle_b32 v183, v171 offset:16415
    ds_swizzle_b32 v184, v172 offset:16415
    ds_swizzle_b32 v185, v173 offset:16415
    ds_swizzle_b32 v186, v174 offset:16415
    ds_swizzle_b32 v187, v175 offset:16415
    ds_swizzle_b32 v188, v176 offset:16415
    ds_swizzle_b32 v189, v177 offset:16415
    s_waitcnt lgkmcnt(9)
    v_mfma_f32_32x32x16_bf16 v[64:79], v[56:59], v[40:43], v[64:79]
    ds_read_b64_tr_b16 v[48:49], v10 offset:36864
    ds_read_b64_tr_b16 v[50:51], v10 offset:37888
    v_mfma_f32_32x32x16_bf16 v[80:95], v[60:63], v[40:43], v[80:95]
    ds_read_b64_tr_b16 v[52:53], v11 offset:36864
    ds_read_b64_tr_b16 v[54:55], v11 offset:37888
    buffer_load_dwordx4 v14, s[8:11], s57 offen offset:1024 lds
    s_waitcnt lgkmcnt(12)
    v_mfma_f32_32x32x16_bf16 v[96:111], v[56:59], v[44:47], v[96:111]
    ds_read_b128 v[32:35], v9 offset:34816
    ds_read_b128 v[36:39], v9 offset:38912
    buffer_load_dwordx4 v14, s[8:11], s57 offen offset:2048 lds
    v_mfma_f32_32x32x16_bf16 v[112:127], v[60:63], v[44:47], v[112:127]
    buffer_load_dwordx4 v14, s[8:11], s57 offen offset:3072 lds
    s_waitcnt lgkmcnt(1)
    v_mfma_f32_32x32x16_bf16 v[64:79], v[48:51], v[32:35], v[64:79]
    ds_read_b64_tr_b16 v[56:57], v10 offset:38912
    ds_read_b64_tr_b16 v[58:59], v10 offset:39936
    v_mfma_f32_32x32x16_bf16 v[80:95], v[52:55], v[32:35], v[80:95]
    ds_read_b64_tr_b16 v[60:61], v11 offset:38912
    ds_read_b64_tr_b16 v[62:63], v11 offset:39936
    s_waitcnt lgkmcnt(4)
    v_mfma_f32_32x32x16_bf16 v[96:111], v[48:51], v[36:39], v[96:111]
    ds_read_b128 v[40:43], v9 offset:35840
    ds_read_b128 v[44:47], v9 offset:39936
    v_mfma_f32_32x32x16_bf16 v[112:127], v[52:55], v[36:39], v[112:127]
    v_add_f32 v170, v170, v182
    v_add_f32 v171, v171, v183
    v_add_f32 v172, v172, v184
    v_add_f32 v173, v173, v185
    v_add_f32 v174, v174, v186
    v_add_f32 v175, v175, v187
    v_add_f32 v176, v176, v188
    v_add_f32 v177, v177, v189
    s_waitcnt lgkmcnt(1)
    v_mfma_f32_32x32x16_bf16 v[64:79], v[56:59], v[40:43], v[64:79]
    s_waitcnt vmcnt(8)
    s_barrier
    ds_read_b64_tr_b16 v[48:49], v12 offset:0
    ds_read_b64_tr_b16 v[50:51], v12 offset:1024
    v_mfma_f32_32x32x16_bf16 v[80:95], v[60:63], v[40:43], v[80:95]
    ds_read_b64_tr_b16 v[52:53], v13 offset:0
    ds_read_b64_tr_b16 v[54:55], v13 offset:1024
    s_add_u32 m0, s44, 65536
    s_add_u32 s56, s43, 81920
    s_waitcnt lgkmcnt(4)
    v_mfma_f32_32x32x16_bf16 v[96:111], v[56:59], v[44:47], v[96:111]
    ds_read_b128 v[32:35], v15 offset:0
    ds_read_b128 v[36:39], v15 offset:4096
    buffer_load_dwordx4 v8, s[4:7], s56 offen lds
    v_mfma_f32_32x32x16_bf16 v[112:127], v[60:63], v[44:47], v[112:127]
    buffer_load_dwordx4 v8, s[4:7], s56 offen offset:1024 lds
    v_mov_b32 v182, v170
    v_mov_b32 v183, v171
    s_waitcnt lgkmcnt(1)
    v_mfma_f32_32x32x16_bf16 v[64:79], v[48:51], v[32:35], v[64:79]
    ds_read_b64_tr_b16 v[56:57], v12 offset:2048
    ds_read_b64_tr_b16 v[58:59], v12 offset:3072
    buffer_load_dwordx4 v8, s[4:7], s56 offen offset:2048 lds
    v_mfma_f32_32x32x16_bf16 v[80:95], v[52:55], v[32:35], v[80:95]
    ds_read_b64_tr_b16 v[60:61], v13 offset:2048
    ds_read_b64_tr_b16 v[62:63], v13 offset:3072
    buffer_load_dwordx4 v8, s[4:7], s56 offen offset:3072 lds
    s_waitcnt lgkmcnt(4)
    v_mfma_f32_32x32x16_bf16 v[96:111], v[48:51], v[36:39], v[96:111]
    ds_read_b128 v[40:43], v15 offset:1024
    ds_read_b128 v[44:47], v15 offset:5120
    s_add_u32 m0, s46, 65536
    s_add_u32 s57, s45, 40960
    v_mfma_f32_32x32x16_bf16 v[112:127], v[52:55], v[36:39], v[112:127]
    buffer_load_dwordx4 v14, s[8:11], s57 offen lds
    v_mov_b32 v184, v172
    v_mov_b32 v185, v173
    s_waitcnt lgkmcnt(1)
    v_mfma_f32_32x32x16_bf16 v[64:79], v[56:59], v[40:43], v[64:79]
    ds_read_b64_tr_b16 v[48:49], v12 offset:4096
    ds_read_b64_tr_b16 v[50:51], v12 offset:5120
    v_mov_b32 v186, v174
    v_mfma_f32_32x32x16_bf16 v[80:95], v[60:63], v[40:43], v[80:95]
    ds_read_b64_tr_b16 v[52:53], v13 offset:4096
    ds_read_b64_tr_b16 v[54:55], v13 offset:5120
    buffer_load_dwordx4 v14, s[8:11], s57 offen offset:1024 lds
    v_mov_b32 v187, v175
    s_waitcnt lgkmcnt(4)
    v_mfma_f32_32x32x16_bf16 v[96:111], v[56:59], v[44:47], v[96:111]
    ds_read_b128 v[32:35], v15 offset:2048
    ds_read_b128 v[36:39], v15 offset:6144
    buffer_load_dwordx4 v14, s[8:11], s57 offen offset:2048 lds
    v_mov_b32 v188, v176
    v_mfma_f32_32x32x16_bf16 v[112:127], v[60:63], v[44:47], v[112:127]
    buffer_load_dwordx4 v14, s[8:11], s57 offen offset:3072 lds
    v_mov_b32 v189, v177
    s_nop 1
    s_waitcnt lgkmcnt(1)
    v_mfma_f32_32x32x16_bf16 v[64:79], v[48:51], v[32:35], v[64:79]
    ds_read_b64_tr_b16 v[56:57], v12 offset:6144
    ds_read_b64_tr_b16 v[58:59], v12 offset:7168
    v_permlane32_swap_b32 v170, v182
    v_permlane32_swap_b32 v171, v183
    v_mfma_f32_32x32x16_bf16 v[80:95], v[52:55], v[32:35], v[80:95]
    ds_read_b64_tr_b16 v[60:61], v13 offset:6144
    ds_read_b64_tr_b16 v[62:63], v13 offset:7168
    v_permlane32_swap_b32 v172, v184
    v_permlane32_swap_b32 v173, v185
    s_waitcnt lgkmcnt(4)
    v_mfma_f32_32x32x16_bf16 v[96:111], v[48:51], v[36:39], v[96:111]
    ds_read_b128 v[40:43], v15 offset:3072
    ds_read_b128 v[44:47], v15 offset:7168
    v_permlane32_swap_b32 v174, v186
    v_permlane32_swap_b32 v175, v187
    v_mfma_f32_32x32x16_bf16 v[112:127], v[52:55], v[36:39], v[112:127]
    v_permlane32_swap_b32 v176, v188
    v_permlane32_swap_b32 v177, v189
    s_nop 1
    s_waitcnt lgkmcnt(1)
    v_mfma_f32_32x32x16_bf16 v[64:79], v[56:59], v[40:43], v[64:79]
    s_waitcnt vmcnt(8)
    s_barrier
    ds_read_b64_tr_b16 v[48:49], v12 offset:32768
    ds_read_b64_tr_b16 v[50:51], v12 offset:33792
    v_mfma_f32_32x32x16_bf16 v[80:95], v[60:63], v[40:43], v[80:95]
    ds_read_b64_tr_b16 v[52:53], v13 offset:32768
    ds_read_b64_tr_b16 v[54:55], v13 offset:33792
    s_add_u32 m0, s44, 98304
    s_add_u32 s56, s43, 90112
    s_waitcnt lgkmcnt(4)
    v_mfma_f32_32x32x16_bf16 v[96:111], v[56:59], v[44:47], v[96:111]
    ds_read_b128 v[32:35], v15 offset:32768
    ds_read_b128 v[36:39], v15 offset:36864
    buffer_load_dwordx4 v8, s[4:7], s56 offen lds
    v_mfma_f32_32x32x16_bf16 v[112:127], v[60:63], v[44:47], v[112:127]
    buffer_load_dwordx4 v8, s[4:7], s56 offen offset:1024 lds
    v_add_f32 v170, v170, v182
    v_add_f32 v171, v171, v183
    v_add_f32 v172, v172, v184
    s_waitcnt lgkmcnt(1)
    v_mfma_f32_32x32x16_bf16 v[64:79], v[48:51], v[32:35], v[64:79]
    ds_read_b64_tr_b16 v[56:57], v12 offset:34816
    ds_read_b64_tr_b16 v[58:59], v12 offset:35840
    buffer_load_dwordx4 v8, s[4:7], s56 offen offset:2048 lds
    v_add_f32 v173, v173, v185
    v_mfma_f32_32x32x16_bf16 v[80:95], v[52:55], v[32:35], v[80:95]
    ds_read_b64_tr_b16 v[60:61], v13 offset:34816
    ds_read_b64_tr_b16 v[62:63], v13 offset:35840
    buffer_load_dwordx4 v8, s[4:7], s56 offen offset:3072 lds
    v_add_f32 v174, v174, v186
    s_waitcnt lgkmcnt(4)
    v_mfma_f32_32x32x16_bf16 v[96:111], v[48:51], v[36:39], v[96:111]
    ds_read_b128 v[40:43], v15 offset:33792
    ds_read_b128 v[44:47], v15 offset:37888
    s_add_u32 m0, s46, 98304
    s_add_u32 s57, s45, 45056
    v_mfma_f32_32x32x16_bf16 v[112:127], v[52:55], v[36:39], v[112:127]
    buffer_load_dwordx4 v14, s[8:11], s57 offen lds
    v_add_f32 v175, v175, v187
    v_add_f32 v176, v176, v188
    v_add_f32 v177, v177, v189
    s_waitcnt lgkmcnt(1)
    v_mfma_f32_32x32x16_bf16 v[64:79], v[56:59], v[40:43], v[64:79]
    ds_read_b64_tr_b16 v[48:49], v12 offset:36864
    ds_read_b64_tr_b16 v[50:51], v12 offset:37888
    v_mfma_f32_32x32x16_bf16 v[80:95], v[60:63], v[40:43], v[80:95]
    ds_read_b64_tr_b16 v[52:53], v13 offset:36864
    ds_read_b64_tr_b16 v[54:55], v13 offset:37888
    buffer_load_dwordx4 v14, s[8:11], s57 offen offset:1024 lds
    s_waitcnt lgkmcnt(4)
    v_mfma_f32_32x32x16_bf16 v[96:111], v[56:59], v[44:47], v[96:111]
    ds_read_b128 v[32:35], v15 offset:34816
    ds_read_b128 v[36:39], v15 offset:38912
    buffer_load_dwordx4 v14, s[8:11], s57 offen offset:2048 lds
    v_mfma_f32_32x32x16_bf16 v[112:127], v[60:63], v[44:47], v[112:127]
    buffer_load_dwordx4 v14, s[8:11], s57 offen offset:3072 lds
    v_lshlrev_b32 v6, 5, v2
    s_mov_b64 exec, 0xff
    buffer_store_dwordx4 v[170:173], v6, s[28:31], s60 offen sc1
    buffer_store_dwordx4 v[174:177], v6, s[28:31], s60 offen offset:16 sc1
    s_mov_b64 exec, -1
    s_waitcnt lgkmcnt(1)
    v_mfma_f32_32x32x16_bf16 v[64:79], v[48:51], v[32:35], v[64:79]
    ds_read_b64_tr_b16 v[56:57], v12 offset:38912
    ds_read_b64_tr_b16 v[58:59], v12 offset:39936
    v_mfma_f32_32x32x16_bf16 v[80:95], v[52:55], v[32:35], v[80:95]
    ds_read_b64_tr_b16 v[60:61], v13 offset:38912
    ds_read_b64_tr_b16 v[62:63], v13 offset:39936
    s_waitcnt lgkmcnt(4)
    v_mfma_f32_32x32x16_bf16 v[96:111], v[48:51], v[36:39], v[96:111]
    ds_read_b128 v[40:43], v15 offset:35840
    ds_read_b128 v[44:47], v15 offset:39936
    v_mfma_f32_32x32x16_bf16 v[112:127], v[52:55], v[36:39], v[112:127]
    s_waitcnt lgkmcnt(1)
    v_mfma_f32_32x32x16_bf16 v[64:79], v[56:59], v[40:43], v[64:79]
    s_waitcnt vmcnt(10)
    s_barrier
    ds_read_b64_tr_b16 v[48:49], v10 offset:0
    ds_read_b64_tr_b16 v[50:51], v10 offset:1024
    v_mfma_f32_32x32x16_bf16 v[80:95], v[60:63], v[40:43], v[80:95]
    ds_read_b64_tr_b16 v[52:53], v11 offset:0
    ds_read_b64_tr_b16 v[54:55], v11 offset:1024
    s_add_u32 m0, s44, 0
    s_add_u32 s56, s43, 98304
    s_waitcnt lgkmcnt(4)
    v_mfma_f32_32x32x16_bf16 v[96:111], v[56:59], v[44:47], v[96:111]
    ds_read_b128 v[32:35], v9 offset:0
    ds_read_b128 v[36:39], v9 offset:4096
    buffer_load_dwordx4 v8, s[4:7], s56 offen lds
    v_mfma_f32_32x32x16_bf16 v[112:127], v[60:63], v[44:47], v[112:127]
    buffer_load_dwordx4 v8, s[4:7], s56 offen offset:1024 lds
    s_waitcnt lgkmcnt(1)
    v_mfma_f32_32x32x16_bf16 v[64:79], v[48:51], v[32:35], v[64:79]
    ds_read_b64_tr_b16 v[56:57], v10 offset:2048
    ds_read_b64_tr_b16 v[58:59], v10 offset:3072
    buffer_load_dwordx4 v8, s[4:7], s56 offen offset:2048 lds
    v_mfma_f32_32x32x16_bf16 v[80:95], v[52:55], v[32:35], v[80:95]
    ds_read_b64_tr_b16 v[60:61], v11 offset:2048
    ds_read_b64_tr_b16 v[62:63], v11 offset:3072
    buffer_load_dwordx4 v8, s[4:7], s56 offen offset:3072 lds
    s_waitcnt lgkmcnt(4)
    v_mfma_f32_32x32x16_bf16 v[96:111], v[48:51], v[36:39], v[96:111]
    ds_read_b128 v[40:43], v9 offset:1024
    ds_read_b128 v[44:47], v9 offset:5120
    s_add_u32 m0, s46, 0
    s_add_u32 s57, s45, 49152
    v_mfma_f32_32x32x16_bf16 v[112:127], v[52:55], v[36:39], v[112:127]
    buffer_load_dwordx4 v14, s[8:11], s57 offen lds
    s_waitcnt lgkmcnt(1)
    v_mfma_f32_32x32x16_bf16 v[64:79], v[56:59], v[40:43], v[64:79]
    ds_read_b64_tr_b16 v[48:49], v10 offset:4096
    ds_read_b64_tr_b16 v[50:51], v10 offset:5120
    v_mfma_f32_32x32x16_bf16 v[80:95], v[60:63], v[40:43], v[80:95]
    ds_read_b64_tr_b16 v[52:53], v11 offset:4096
    ds_read_b64_tr_b16 v[54:55], v11 offset:5120
    buffer_load_dwordx4 v14, s[8:11], s57 offen offset:1024 lds
    s_waitcnt lgkmcnt(4)
    v_mfma_f32_32x32x16_bf16 v[96:111], v[56:59], v[44:47], v[96:111]
    ds_read_b128 v[32:35], v9 offset:2048
    ds_read_b128 v[36:39], v9 offset:6144
    buffer_load_dwordx4 v14, s[8:11], s57 offen offset:2048 lds
    v_mfma_f32_32x32x16_bf16 v[112:127], v[60:63], v[44:47], v[112:127]
    buffer_load_dwordx4 v14, s[8:11], s57 offen offset:3072 lds
    s_waitcnt lgkmcnt(1)
    v_mfma_f32_32x32x16_bf16 v[64:79], v[48:51], v[32:35], v[64:79]
    ds_read_b64_tr_b16 v[56:57], v10 offset:6144
    ds_read_b64_tr_b16 v[58:59], v10 offset:7168
    v_mfma_f32_32x32x16_bf16 v[80:95], v[52:55], v[32:35], v[80:95]
    ds_read_b64_tr_b16 v[60:61], v11 offset:6144
    ds_read_b64_tr_b16 v[62:63], v11 offset:7168
    s_waitcnt lgkmcnt(4)
    v_mfma_f32_32x32x16_bf16 v[96:111], v[48:51], v[36:39], v[96:111]
    ds_read_b128 v[40:43], v9 offset:3072
    ds_read_b128 v[44:47], v9 offset:7168
    v_mfma_f32_32x32x16_bf16 v[112:127], v[52:55], v[36:39], v[112:127]
    s_waitcnt lgkmcnt(1)
    v_mfma_f32_32x32x16_bf16 v[64:79], v[56:59], v[40:43], v[64:79]
    s_waitcnt vmcnt(10)
    s_barrier
    ds_read_b64_tr_b16 v[48:49], v10 offset:32768
    ds_read_b64_tr_b16 v[50:51], v10 offset:33792
    v_mfma_f32_32x32x16_bf16 v[80:95], v[60:63], v[40:43], v[80:95]
    ds_read_b64_tr_b16 v[52:53], v11 offset:32768
    ds_read_b64_tr_b16 v[54:55], v11 offset:33792
    s_add_u32 m0, s44, 32768
    s_add_u32 s56, s43, 106496
    s_waitcnt lgkmcnt(4)
    v_mfma_f32_32x32x16_bf16 v[96:111], v[56:59], v[44:47], v[96:111]
    ds_read_b128 v[32:35], v9 offset:32768
    ds_read_b128 v[36:39], v9 offset:36864
    buffer_load_dwordx4 v8, s[4:7], s56 offen lds
    v_mfma_f32_32x32x16_bf16 v[112:127], v[60:63], v[44:47], v[112:127]
    buffer_load_dwordx4 v8, s[4:7], s56 offen offset:1024 lds
    s_waitcnt lgkmcnt(1)
    v_mfma_f32_32x32x16_bf16 v[64:79], v[48:51], v[32:35], v[64:79]
    ds_read_b64_tr_b16 v[56:57], v10 offset:34816
    ds_read_b64_tr_b16 v[58:59], v10 offset:35840
    buffer_load_dwordx4 v8, s[4:7], s56 offen offset:2048 lds
    v_mfma_f32_32x32x16_bf16 v[80:95], v[52:55], v[32:35], v[80:95]
    ds_read_b64_tr_b16 v[60:61], v11 offset:34816
    ds_read_b64_tr_b16 v[62:63], v11 offset:35840
    buffer_load_dwordx4 v8, s[4:7], s56 offen offset:3072 lds
    s_waitcnt lgkmcnt(4)
    v_mfma_f32_32x32x16_bf16 v[96:111], v[48:51], v[36:39], v[96:111]
    ds_read_b128 v[40:43], v9 offset:33792
    ds_read_b128 v[44:47], v9 offset:37888
    s_add_u32 m0, s46, 32768
    s_add_u32 s57, s45, 53248
    v_mfma_f32_32x32x16_bf16 v[112:127], v[52:55], v[36:39], v[112:127]
    buffer_load_dwordx4 v14, s[8:11], s57 offen lds
    s_waitcnt lgkmcnt(1)
    v_mfma_f32_32x32x16_bf16 v[64:79], v[56:59], v[40:43], v[64:79]
    ds_read_b64_tr_b16 v[48:49], v10 offset:36864
    ds_read_b64_tr_b16 v[50:51], v10 offset:37888
    v_mfma_f32_32x32x16_bf16 v[80:95], v[60:63], v[40:43], v[80:95]
    ds_read_b64_tr_b16 v[52:53], v11 offset:36864
    ds_read_b64_tr_b16 v[54:55], v11 offset:37888
    buffer_load_dwordx4 v14, s[8:11], s57 offen offset:1024 lds
    s_waitcnt lgkmcnt(4)
    v_mfma_f32_32x32x16_bf16 v[96:111], v[56:59], v[44:47], v[96:111]
    ds_read_b128 v[32:35], v9 offset:34816
    ds_read_b128 v[36:39], v9 offset:38912
    buffer_load_dwordx4 v14, s[8:11], s57 offen offset:2048 lds
    v_mfma_f32_32x32x16_bf16 v[112:127], v[60:63], v[44:47], v[112:127]
    buffer_load_dwordx4 v14, s[8:11], s57 offen offset:3072 lds
    s_waitcnt lgkmcnt(1)
    v_mfma_f32_32x32x16_bf16 v[64:79], v[48:51], v[32:35], v[64:79]
    ds_read_b64_tr_b16 v[56:57], v10 offset:38912
    ds_read_b64_tr_b16 v[58:59], v10 offset:39936
    v_mfma_f32_32x32x16_bf16 v[80:95], v[52:55], v[32:35], v[80:95]
    ds_read_b64_tr_b16 v[60:61], v11 offset:38912
    ds_read_b64_tr_b16 v[62:63], v11 offset:39936
    s_waitcnt lgkmcnt(4)
    v_mfma_f32_32x32x16_bf16 v[96:111], v[48:51], v[36:39], v[96:111]
    ds_read_b128 v[40:43], v9 offset:35840
    ds_read_b128 v[44:47], v9 offset:39936
    v_mfma_f32_32x32x16_bf16 v[112:127], v[52:55], v[36:39], v[112:127]
    s_waitcnt lgkmcnt(1)
    v_mfma_f32_32x32x16_bf16 v[64:79], v[56:59], v[40:43], v[64:79]
    s_waitcnt vmcnt(8)
    s_barrier
    ds_read_b64_tr_b16 v[48:49], v12 offset:0
    ds_read_b64_tr_b16 v[50:51], v12 offset:1024
    v_mfma_f32_32x32x16_bf16 v[80:95], v[60:63], v[40:43], v[80:95]
    ds_read_b64_tr_b16 v[52:53], v13 offset:0
    ds_read_b64_tr_b16 v[54:55], v13 offset:1024
    s_add_u32 m0, s44, 65536
    s_add_u32 s56, s43, 114688
    s_waitcnt lgkmcnt(4)
    v_mfma_f32_32x32x16_bf16 v[96:111], v[56:59], v[44:47], v[96:111]
    ds_read_b128 v[32:35], v15 offset:0
    ds_read_b128 v[36:39], v15 offset:4096
    buffer_load_dwordx4 v8, s[4:7], s56 offen lds
    v_mfma_f32_32x32x16_bf16 v[112:127], v[60:63], v[44:47], v[112:127]
    buffer_load_dwordx4 v8, s[4:7], s56 offen offset:1024 lds
    s_waitcnt lgkmcnt(1)
    v_mfma_f32_32x32x16_bf16 v[64:79], v[48:51], v[32:35], v[64:79]
    ds_read_b64_tr_b16 v[56:57], v12 offset:2048
    ds_read_b64_tr_b16 v[58:59], v12 offset:3072
    buffer_load_dwordx4 v8, s[4:7], s56 offen offset:2048 lds
    v_mfma_f32_32x32x16_bf16 v[80:95], v[52:55], v[32:35], v[80:95]
    ds_read_b64_tr_b16 v[60:61], v13 offset:2048
    ds_read_b64_tr_b16 v[62:63], v13 offset:3072
    buffer_load_dwordx4 v8, s[4:7], s56 offen offset:3072 lds
    s_waitcnt lgkmcnt(4)
    v_mfma_f32_32x32x16_bf16 v[96:111], v[48:51], v[36:39], v[96:111]
    ds_read_b128 v[40:43], v15 offset:1024
    ds_read_b128 v[44:47], v15 offset:5120
    s_add_u32 m0, s46, 65536
    s_add_u32 s57, s45, 57344
    v_mfma_f32_32x32x16_bf16 v[112:127], v[52:55], v[36:39], v[112:127]
    buffer_load_dwordx4 v14, s[8:11], s57 offen lds
    s_waitcnt vmcnt(21)
    s_cmp_ge_u32 s2, 56
    s_cbranch_scc1 KC_CSS
    v_mov_b32 v248, 1
    v_mov_b32 v250, 10240
    s_mov_b64 exec, 1
    buffer_atomic_add v248, v250, s[24:27], 0 offen
    s_mov_b64 exec, -1
KC_CSS:
    s_waitcnt lgkmcnt(1)
    v_mfma_f32_32x32x16_bf16 v[64:79], v[56:59], v[40:43], v[64:79]
    ds_read_b64_tr_b16 v[48:49], v12 offset:4096
    ds_read_b64_tr_b16 v[50:51], v12 offset:5120
    v_mfma_f32_32x32x16_bf16 v[80:95], v[60:63], v[40:43], v[80:95]
    ds_read_b64_tr_b16 v[52:53], v13 offset:4096
    ds_read_b64_tr_b16 v[54:55], v13 offset:5120
    buffer_load_dwordx4 v14, s[8:11], s57 offen offset:1024 lds
    s_waitcnt lgkmcnt(4)
    v_mfma_f32_32x32x16_bf16 v[96:111], v[56:59], v[44:47], v[96:111]
    ds_read_b128 v[32:35], v15 offset:2048
    ds_read_b128 v[36:39], v15 offset:6144
    buffer_load_dwordx4 v14, s[8:11], s57 offen offset:2048 lds
    v_mfma_f32_32x32x16_bf16 v[112:127], v[60:63], v[44:47], v[112:127]
    buffer_load_dwordx4 v14, s[8:11], s57 offen offset:3072 lds
    s_waitcnt lgkmcnt(1)
    v_mfma_f32_32x32x16_bf16 v[64:79], v[48:51], v[32:35], v[64:79]
    ds_read_b64_tr_b16 v[56:57], v12 offset:6144
    ds_read_b64_tr_b16 v[58:59], v12 offset:7168
    v_mfma_f32_32x32x16_bf16 v[80:95], v[52:55], v[32:35], v[80:95]
    ds_read_b64_tr_b16 v[60:61], v13 offset:6144
    ds_read_b64_tr_b16 v[62:63], v13 offset:7168
    s_waitcnt lgkmcnt(4)
    v_mfma_f32_32x32x16_bf16 v[96:111], v[48:51], v[36:39], v[96:111]
    ds_read_b128 v[40:43], v15 offset:3072
    ds_read_b128 v[44:47], v15 offset:7168
    v_mfma_f32_32x32x16_bf16 v[112:127], v[52:55], v[36:39], v[112:127]
    s_waitcnt lgkmcnt(1)
    v_mfma_f32_32x32x16_bf16 v[64:79], v[56:59], v[40:43], v[64:79]
    s_waitcnt vmcnt(8)
    s_barrier
    ds_read_b64_tr_b16 v[48:49], v12 offset:32768
    ds_read_b64_tr_b16 v[50:51], v12 offset:33792
    v_mfma_f32_32x32x16_bf16 v[80:95], v[60:63], v[40:43], v[80:95]
    ds_read_b64_tr_b16 v[52:53], v13 offset:32768
    ds_read_b64_tr_b16 v[54:55], v13 offset:33792
    s_add_u32 m0, s44, 98304
    s_add_u32 s56, s43, 122880
    s_waitcnt lgkmcnt(4)
    v_mfma_f32_32x32x16_bf16 v[96:111], v[56:59], v[44:47], v[96:111]
    ds_read_b128 v[32:35], v15 offset:32768
    ds_read_b128 v[36:39], v15 offset:36864
    buffer_load_dwordx4 v8, s[4:7], s56 offen lds
    v_mfma_f32_32x32x16_bf16 v[112:127], v[60:63], v[44:47], v[112:127]
    buffer_load_dwordx4 v8, s[4:7], s56 offen offset:1024 lds
    s_waitcnt lgkmcnt(1)
    v_mfma_f32_32x32x16_bf16 v[64:79], v[48:51], v[32:35], v[64:79]
    ds_read_b64_tr_b16 v[56:57], v12 offset:34816
    ds_read_b64_tr_b16 v[58:59], v12 offset:35840
    buffer_load_dwordx4 v8, s[4:7], s56 offen offset:2048 lds
    v_mfma_f32_32x32x16_bf16 v[80:95], v[52:55], v[32:35], v[80:95]
    ds_read_b64_tr_b16 v[60:61], v13 offset:34816
    ds_read_b64_tr_b16 v[62:63], v13 offset:35840
    buffer_load_dwordx4 v8, s[4:7], s56 offen offset:3072 lds
    s_waitcnt lgkmcnt(4)
    v_mfma_f32_32x32x16_bf16 v[96:111], v[48:51], v[36:39], v[96:111]
    ds_read_b128 v[40:43], v15 offset:33792
    ds_read_b128 v[44:47], v15 offset:37888
    s_add_u32 m0, s46, 98304
    s_add_u32 s57, s45, 61440
    v_mfma_f32_32x32x16_bf16 v[112:127], v[52:55], v[36:39], v[112:127]
    buffer_load_dwordx4 v14, s[8:11], s57 offen lds
    s_cmp_lg_u32 s42, 0
    s_cbranch_scc1 KC_PL0
    buffer_load_dword v249, v251, s[24:27], 0 offen sc1
KC_PL0:
    s_waitcnt lgkmcnt(1)
    v_mfma_f32_32x32x16_bf16 v[64:79], v[56:59], v[40:43], v[64:79]
    ds_read_b64_tr_b16 v[48:49], v12 offset:36864
    ds_read_b64_tr_b16 v[50:51], v12 offset:37888
    v_mfma_f32_32x32x16_bf16 v[80:95], v[60:63], v[40:43], v[80:95]
    ds_read_b64_tr_b16 v[52:53], v13 offset:36864
    ds_read_b64_tr_b16 v[54:55], v13 offset:37888
    buffer_load_dwordx4 v14, s[8:11], s57 offen offset:1024 lds
    s_waitcnt lgkmcnt(4)
    v_mfma_f32_32x32x16_bf16 v[96:111], v[56:59], v[44:47], v[96:111]
    ds_read_b128 v[32:35], v15 offset:34816
    ds_read_b128 v[36:39], v15 offset:38912
    buffer_load_dwordx4 v14, s[8:11], s57 offen offset:2048 lds
    v_mfma_f32_32x32x16_bf16 v[112:127], v[60:63], v[44:47], v[112:127]
    buffer_load_dwordx4 v14, s[8:11], s57 offen offset:3072 lds
    s_waitcnt lgkmcnt(1)
    v_mfma_f32_32x32x16_bf16 v[64:79], v[48:51], v[32:35], v[64:79]
    ds_read_b64_tr_b16 v[56:57], v12 offset:38912
    ds_read_b64_tr_b16 v[58:59], v12 offset:39936
    v_mfma_f32_32x32x16_bf16 v[80:95], v[52:55], v[32:35], v[80:95]
    ds_read_b64_tr_b16 v[60:61], v13 offset:38912
    ds_read_b64_tr_b16 v[62:63], v13 offset:39936
    s_waitcnt lgkmcnt(4)
    v_mfma_f32_32x32x16_bf16 v[96:111], v[48:51], v[36:39], v[96:111]
    ds_read_b128 v[40:43], v15 offset:35840
    ds_read_b128 v[44:47], v15 offset:39936
    v_mfma_f32_32x32x16_bf16 v[112:127], v[52:55], v[36:39], v[112:127]
    s_waitcnt lgkmcnt(1)
    v_mfma_f32_32x32x16_bf16 v[64:79], v[56:59], v[40:43], v[64:79]
    s_waitcnt vmcnt(8)
    s_barrier
    ds_read_b64_tr_b16 v[48:49], v10 offset:0
    ds_read_b64_tr_b16 v[50:51], v10 offset:1024
    v_mfma_f32_32x32x16_bf16 v[80:95], v[60:63], v[40:43], v[80:95]
    ds_read_b64_tr_b16 v[52:53], v11 offset:0
    ds_read_b64_tr_b16 v[54:55], v11 offset:1024
    s_waitcnt lgkmcnt(4)
    v_mfma_f32_32x32x16_bf16 v[96:111], v[56:59], v[44:47], v[96:111]
    ds_read_b128 v[32:35], v9 offset:0
    ds_read_b128 v[36:39], v9 offset:4096
    v_mfma_f32_32x32x16_bf16 v[112:127], v[60:63], v[44:47], v[112:127]
    s_waitcnt lgkmcnt(1)
    v_mfma_f32_32x32x16_bf16 v[64:79], v[48:51], v[32:35], v[64:79]
    ds_read_b64_tr_b16 v[56:57], v10 offset:2048
    ds_read_b64_tr_b16 v[58:59], v10 offset:3072
    v_mfma_f32_32x32x16_bf16 v[80:95], v[52:55], v[32:35], v[80:95]
    ds_read_b64_tr_b16 v[60:61], v11 offset:2048
    ds_read_b64_tr_b16 v[62:63], v11 offset:3072
    s_waitcnt lgkmcnt(4)
    v_mfma_f32_32x32x16_bf16 v[96:111], v[48:51], v[36:39], v[96:111]
    ds_read_b128 v[40:43], v9 offset:1024
    ds_read_b128 v[44:47], v9 offset:5120
    v_mfma_f32_32x32x16_bf16 v[112:127], v[52:55], v[36:39], v[112:127]
    s_waitcnt lgkmcnt(1)
    v_mfma_f32_32x32x16_bf16 v[64:79], v[56:59], v[40:43], v[64:79]
    ds_read_b64_tr_b16 v[48:49], v10 offset:4096
    ds_read_b64_tr_b16 v[50:51], v10 offset:5120
    v_mfma_f32_32x32x16_bf16 v[80:95], v[60:63], v[40:43], v[80:95]
    ds_read_b64_tr_b16 v[52:53], v11 offset:4096
    ds_read_b64_tr_b16 v[54:55], v11 offset:5120
    s_waitcnt lgkmcnt(4)
    v_mfma_f32_32x32x16_bf16 v[96:111], v[56:59], v[44:47], v[96:111]
    ds_read_b128 v[32:35], v9 offset:2048
    ds_read_b128 v[36:39], v9 offset:6144
    v_mfma_f32_32x32x16_bf16 v[112:127], v[60:63], v[44:47], v[112:127]
    s_waitcnt lgkmcnt(1)
    v_mfma_f32_32x32x16_bf16 v[64:79], v[48:51], v[32:35], v[64:79]
    ds_read_b64_tr_b16 v[56:57], v10 offset:6144
    ds_read_b64_tr_b16 v[58:59], v10 offset:7168
    v_mfma_f32_32x32x16_bf16 v[80:95], v[52:55], v[32:35], v[80:95]
    ds_read_b64_tr_b16 v[60:61], v11 offset:6144
    ds_read_b64_tr_b16 v[62:63], v11 offset:7168
    s_waitcnt lgkmcnt(4)
    v_mfma_f32_32x32x16_bf16 v[96:111], v[48:51], v[36:39], v[96:111]
    ds_read_b128 v[40:43], v9 offset:3072
    ds_read_b128 v[44:47], v9 offset:7168
    v_mfma_f32_32x32x16_bf16 v[112:127], v[52:55], v[36:39], v[112:127]
    s_waitcnt lgkmcnt(1)
    v_mfma_f32_32x32x16_bf16 v[64:79], v[56:59], v[40:43], v[64:79]
    s_waitcnt vmcnt(0)
    s_barrier
    ds_read_b64_tr_b16 v[48:49], v10 offset:32768
    ds_read_b64_tr_b16 v[50:51], v10 offset:33792
    v_mfma_f32_32x32x16_bf16 v[80:95], v[60:63], v[40:43], v[80:95]
    ds_read_b64_tr_b16 v[52:53], v11 offset:32768
    ds_read_b64_tr_b16 v[54:55], v11 offset:33792
    s_waitcnt lgkmcnt(4)
    v_mfma_f32_32x32x16_bf16 v[96:111], v[56:59], v[44:47], v[96:111]
    ds_read_b128 v[32:35], v9 offset:32768
    ds_read_b128 v[36:39], v9 offset:36864
    v_mfma_f32_32x32x16_bf16 v[112:127], v[60:63], v[44:47], v[112:127]
    s_waitcnt lgkmcnt(1)
    v_mfma_f32_32x32x16_bf16 v[64:79], v[48:51], v[32:35], v[64:79]
    ds_read_b64_tr_b16 v[56:57], v10 offset:34816
    ds_read_b64_tr_b16 v[58:59], v10 offset:35840
    v_mfma_f32_32x32x16_bf16 v[80:95], v[52:55], v[32:35], v[80:95]
    ds_read_b64_tr_b16 v[60:61], v11 offset:34816
    ds_read_b64_tr_b16 v[62:63], v11 offset:35840
    s_waitcnt lgkmcnt(4)
    v_mfma_f32_32x32x16_bf16 v[96:111], v[48:51], v[36:39], v[96:111]
    ds_read_b128 v[40:43], v9 offset:33792
    ds_read_b128 v[44:47], v9 offset:37888
    v_mfma_f32_32x32x16_bf16 v[112:127], v[52:55], v[36:39], v[112:127]
    s_waitcnt lgkmcnt(1)
    v_mfma_f32_32x32x16_bf16 v[64:79], v[56:59], v[40:43], v[64:79]
    ds_read_b64_tr_b16 v[48:49], v10 offset:36864
    ds_read_b64_tr_b16 v[50:51], v10 offset:37888
    v_mfma_f32_32x32x16_bf16 v[80:95], v[60:63], v[40:43], v[80:95]
    ds_read_b64_tr_b16 v[52:53], v11 offset:36864
    ds_read_b64_tr_b16 v[54:55], v11 offset:37888
    s_waitcnt lgkmcnt(4)
    v_mfma_f32_32x32x16_bf16 v[96:111], v[56:59], v[44:47], v[96:111]
    ds_read_b128 v[32:35], v9 offset:34816
    ds_read_b128 v[36:39], v9 offset:38912
    v_mfma_f32_32x32x16_bf16 v[112:127], v[60:63], v[44:47], v[112:127]
    s_waitcnt lgkmcnt(1)
    v_mfma_f32_32x32x16_bf16 v[64:79], v[48:51], v[32:35], v[64:79]
    ds_read_b64_tr_b16 v[56:57], v10 offset:38912
    ds_read_b64_tr_b16 v[58:59], v10 offset:39936
    v_mfma_f32_32x32x16_bf16 v[80:95], v[52:55], v[32:35], v[80:95]
    ds_read_b64_tr_b16 v[60:61], v11 offset:38912
    ds_read_b64_tr_b16 v[62:63], v11 offset:39936
    s_waitcnt lgkmcnt(4)
    v_mfma_f32_32x32x16_bf16 v[96:111], v[48:51], v[36:39], v[96:111]
    ds_read_b128 v[40:43], v9 offset:35840
    ds_read_b128 v[44:47], v9 offset:39936
    v_mfma_f32_32x32x16_bf16 v[112:127], v[52:55], v[36:39], v[112:127]
    s_waitcnt lgkmcnt(1)
    v_mfma_f32_32x32x16_bf16 v[64:79], v[56:59], v[40:43], v[64:79]
    v_mfma_f32_32x32x16_bf16 v[80:95], v[60:63], v[40:43], v[80:95]
    s_waitcnt lgkmcnt(0)
    v_mfma_f32_32x32x16_bf16 v[96:111], v[56:59], v[44:47], v[96:111]
    v_mfma_f32_32x32x16_bf16 v[112:127], v[60:63], v[44:47], v[112:127]
    s_cmp_lg_u32 s42, 0
    s_cbranch_scc1 KC_CK0
    s_waitcnt vmcnt(3)
    v_readfirstlane_b32 s52, v249
    s_nop 0
    s_cmp_eq_u32 s52, s49
    s_cselect_b32 s49, 1, 0
KC_CK0:
    s_nop 7
    s_lshl_b32 s52, s51, 4
    s_lshl_b32 s53, s42, 2
    s_add_u32 s52, s52, s53
    s_add_u32 s52, s52, s63
    s_lshl_b32 s52, s52, 13
    s_cmp_eq_u32 s42, s63
    s_cbranch_scc1 KC_OWN
    v_cvt_pk_bf16_f32 v32, v64, v65
    v_cvt_pk_bf16_f32 v33, v66, v67
    v_cvt_pk_bf16_f32 v34, v68, v69
    v_cvt_pk_bf16_f32 v35, v70, v71
    v_cvt_pk_bf16_f32 v36, v72, v73
    v_cvt_pk_bf16_f32 v37, v74, v75
    v_cvt_pk_bf16_f32 v38, v76, v77
    v_cvt_pk_bf16_f32 v39, v78, v79
    s_add_u32 s53, s52, 0
    buffer_store_dwordx4 v[32:35], v14, s[36:39], s53 offen sc1
    buffer_store_dwordx4 v[36:39], v14, s[36:39], s53 offen offset:1024 sc1
    v_cvt_pk_bf16_f32 v40, v80, v81
    v_cvt_pk_bf16_f32 v41, v82, v83
    v_cvt_pk_bf16_f32 v42, v84, v85
    v_cvt_pk_bf16_f32 v43, v86, v87
    v_cvt_pk_bf16_f32 v44, v88, v89
    v_cvt_pk_bf16_f32 v45, v90, v91
    v_cvt_pk_bf16_f32 v46, v92, v93
    v_cvt_pk_bf16_f32 v47, v94, v95
    s_add_u32 s53, s52, 2048
    buffer_store_dwordx4 v[40:43], v14, s[36:39], s53 offen sc1
    buffer_store_dwordx4 v[44:47], v14, s[36:39], s53 offen offset:1024 sc1
    v_cvt_pk_bf16_f32 v32, v96, v97
    v_cvt_pk_bf16_f32 v33, v98, v99
    v_cvt_pk_bf16_f32 v34, v100, v101
    v_cvt_pk_bf16_f32 v35, v102, v103
    v_cvt_pk_bf16_f32 v36, v104, v105
    v_cvt_pk_bf16_f32 v37, v106, v107
    v_cvt_pk_bf16_f32 v38, v108, v109
    v_cvt_pk_bf16_f32 v39, v110, v111
    s_add_u32 s53, s52, 4096
    buffer_store_dwordx4 v[32:35], v14, s[36:39], s53 offen sc1
    buffer_store_dwordx4 v[36:39], v14, s[36:39], s53 offen offset:1024 sc1
    v_cvt_pk_bf16_f32 v40, v112, v113
    v_cvt_pk_bf16_f32 v41, v114, v115
    v_cvt_pk_bf16_f32 v42, v116, v117
    v_cvt_pk_bf16_f32 v43, v118, v119
    v_cvt_pk_bf16_f32 v44, v120, v121
    v_cvt_pk_bf16_f32 v45, v122, v123
    v_cvt_pk_bf16_f32 v46, v124, v125
    v_cvt_pk_bf16_f32 v47, v126, v127
    s_add_u32 s53, s52, 6144
    buffer_store_dwordx4 v[40:43], v14, s[36:39], s53 offen sc1
    buffer_store_dwordx4 v[44:47], v14, s[36:39], s53 offen offset:1024 sc1
    s_branch KC_OWN_D
KC_OWN:
    v_add_u32 v6, 131072, v14
    ds_write_b128 v6, v[64:67] offset:0
    ds_write_b128 v6, v[68:71] offset:1024
    ds_write_b128 v6, v[72:75] offset:2048
    ds_write_b128 v6, v[76:79] offset:3072
    ds_write_b128 v6, v[80:83] offset:4096
    ds_write_b128 v6, v[84:87] offset:5120
    ds_write_b128 v6, v[88:91] offset:6144
    ds_write_b128 v6, v[92:95] offset:7168
    ds_write_b128 v6, v[96:99] offset:8192
    ds_write_b128 v6, v[100:103] offset:9216
    ds_write_b128 v6, v[104:107] offset:10240
    ds_write_b128 v6, v[108:111] offset:11264
    ds_write_b128 v6, v[112:115] offset:12288
    ds_write_b128 v6, v[116:119] offset:13312
    ds_write_b128 v6, v[120:123] offset:14336
    ds_write_b128 v6, v[124:127] offset:15360
KC_OWN_D:
    s_barrier
    s_mul_i32 s44, s42, 24576
    v_lshrrev_b32 v1, 3, v2
    v_bfe_u32 v3, v2, 2, 1
    v_bfe_u32 v4, v2, 4, 1
    v_xor_b32 v3, v3, v4
    v_and_b32 v4, 3, v2
    v_lshl_add_u32 v3, v3, 2, v4
    v_lshlrev_b32 v3, 4, v3
    v_mul_u32_u24 v1, 3584, v1
    v_add_u32 v3, v3, v1
    v_add_u32 v8, 0, v3
    v_add_u32 v9, 27648, v3
    v_add_u32 v10, 55296, v3
    v_add_u32 v11, 82944, v3
    v_and_b32 v3, 15, v2
    v_lshrrev_b32 v4, 2, v3
    v_and_b32 v3, 3, v3
    v_bfe_u32 v6, v2, 4, 1
    v_lshrrev_b32 v7, 5, v2
    v_lshl_add_u32 v1, v7, 2, v4
    v_lshlrev_b32 v1, 7, v1
    v_lshl_add_u32 v1, v6, 5, v1
    v_lshl_add_u32 v1, v3, 3, v1
    v_add_u32 v1, s44, v1
    v_lshrrev_b32 v4, 1, v4
    v_xor_b32 v3, 0, v4
    v_lshl_add_u32 v12, v3, 6, v1
    v_xor_b32 v3, 1, v4
    v_lshl_add_u32 v13, v3, 6, v1
    s_mov_b32 s4, s66
    s_mov_b32 s5, s67
    s_mov_b32 s6, 1835008
    s_mov_b32 s7, 0x20000
    s_mul_i32 s60, s41, 224
    s_lshl_b32 s52, s42, 6
    s_add_u32 s60, s60, s52
    s_lshl_b32 s43, s60, 1
    s_add_u32 m0, s44, 0
    s_nop 0
    buffer_load_dwordx4 v8, s[4:7], s43 offen lds
    buffer_load_dwordx4 v9, s[4:7], s43 offen offset:1024 lds
    buffer_load_dwordx4 v10, s[4:7], s43 offen offset:2048 lds
    buffer_load_dwordx4 v11, s[4:7], s43 offen offset:3072 lds
    s_add_u32 s43, s43, 114688
    s_add_u32 m0, s44, 4096
    s_nop 0
    buffer_load_dwordx4 v8, s[4:7], s43 offen lds
    buffer_load_dwordx4 v9, s[4:7], s43 offen offset:1024 lds
    buffer_load_dwordx4 v10, s[4:7], s43 offen offset:2048 lds
    buffer_load_dwordx4 v11, s[4:7], s43 offen offset:3072 lds
    s_add_u32 s43, s43, 114688
    s_add_u32 m0, s44, 8192
    s_nop 0
    buffer_load_dwordx4 v8, s[4:7], s43 offen lds
    buffer_load_dwordx4 v9, s[4:7], s43 offen offset:1024 lds
    buffer_load_dwordx4 v10, s[4:7], s43 offen offset:2048 lds
    buffer_load_dwordx4 v11, s[4:7], s43 offen offset:3072 lds
    s_add_u32 s43, s43, 114688
    s_add_u32 m0, s44, 12288
    s_nop 0
    buffer_load_dwordx4 v8, s[4:7], s43 offen lds
    buffer_load_dwordx4 v9, s[4:7], s43 offen offset:1024 lds
    buffer_load_dwordx4 v10, s[4:7], s43 offen offset:2048 lds
    buffer_load_dwordx4 v11, s[4:7], s43 offen offset:3072 lds
    s_add_u32 s43, s43, 114688
    s_add_u32 m0, s44, 16384
    s_nop 0
    buffer_load_dwordx4 v8, s[4:7], s43 offen lds
    buffer_load_dwordx4 v9, s[4:7], s43 offen offset:1024 lds
    buffer_load_dwordx4 v10, s[4:7], s43 offen offset:2048 lds
    buffer_load_dwordx4 v11, s[4:7], s43 offen offset:3072 lds
    s_add_u32 s43, s43, 114688
    s_waitcnt vmcnt(20) lgkmcnt(0)
    s_barrier
    s_cmp_lg_u32 s42, 0
    s_cbranch_scc1 KC_PUBP
    s_add_u32 s52, s51, 81
    s_lshl_b32 s52, s52, 7
    s_lshl_b32 s53, s63, 2
    s_add_u32 s52, s52, s53
    s_add_u32 s52, s52, 0
    v_mov_b32 v248, 1
    v_mov_b32 v250, s52
    s_mov_b64 exec, 1
    buffer_store_dword v248, v250, s[24:27], 0 offen sc1
    s_mov_b64 exec, -1
KC_PUBP:
    s_add_u32 s52, s51, 81
    s_lshl_b32 s52, s52, 7
    v_and_b32 v6, 3, v2
    v_lshlrev_b32 v6, 2, v6
    v_add_u32 v250, s52, v6
    s_cmp_lg_u32 s42, 0
    s_cbranch_scc1 KC_PLP
    buffer_load_dword v249, v250, s[24:27], 0 offen sc1
KC_PLP:
    s_cmp_lg_u32 s42, 0
    s_cbranch_scc1 KC_CKP
    s_waitcnt vmcnt(0)
    v_cmp_gt_u32 vcc, 1, v249
    s_nop 0
    s_cbranch_vccnz KC_SPP
KC_SPP_R:
KC_CKP:
    s_barrier
    s_lshl_b32 s52, s42, 12
    s_add_u32 s52, s52, 131072
    v_add_u32 v6, s52, v14
    ds_read_b128 v[64:67], v6 offset:0
    ds_read_b128 v[68:71], v6 offset:1024
    ds_read_b128 v[72:75], v6 offset:2048
    ds_read_b128 v[76:79], v6 offset:3072
    s_lshl_b32 s52, s51, 4
    s_lshl_b32 s53, s63, 2
    s_add_u32 s52, s52, s53
    s_lshl_b32 s52, s52, 13
    s_lshl_b32 s53, s42, 11
    s_add_u32 s52, s52, s53
    s_add_u32 s53, s52, 0
    s_cmp_eq_u32 s63, 0
    s_cselect_b32 s53, 0x7000000, s53
    buffer_load_dwordx4 v[80:83], v14, s[36:39], s53 offen sc1
    buffer_load_dwordx4 v[84:87], v14, s[36:39], s53 offen offset:1024 sc1
    s_add_u32 s53, s52, 8192
    s_cmp_eq_u32 s63, 1
    s_cselect_b32 s53, 0x7000000, s53
    buffer_load_dwordx4 v[88:91], v14, s[36:39], s53 offen sc1
    buffer_load_dwordx4 v[92:95], v14, s[36:39], s53 offen offset:1024 sc1
    s_add_u32 s53, s52, 16384
    s_cmp_eq_u32 s63, 2
    s_cselect_b32 s53, 0x7000000, s53
    buffer_load_dwordx4 v[96:99], v14, s[36:39], s53 offen sc1
    buffer_load_dwordx4 v[100:103], v14, s[36:39], s53 offen offset:1024 sc1
    s_add_u32 s53, s52, 24576
    s_cmp_eq_u32 s63, 3
    s_cselect_b32 s53, 0x7000000, s53
    buffer_load_dwordx4 v[104:107], v14, s[36:39], s53 offen sc1
    buffer_load_dwordx4 v[108:111], v14, s[36:39], s53 offen offset:1024 sc1
    v_lshlrev_b32 v32, 16, v16
    v_and_b32 v33, 0xffff0000, v16
    s_waitcnt lgkmcnt(3)
    v_pk_add_f32 v[64:65], v[64:65], v[32:33]
    v_lshlrev_b32 v34, 16, v17
    v_and_b32 v35, 0xffff0000, v17
    v_pk_add_f32 v[66:67], v[66:67], v[34:35]
    v_lshlrev_b32 v36, 16, v18
    v_and_b32 v37, 0xffff0000, v18
    s_waitcnt lgkmcnt(2)
    v_pk_add_f32 v[68:69], v[68:69], v[36:37]
    v_lshlrev_b32 v32, 16, v19
    v_and_b32 v33, 0xffff0000, v19
    v_pk_add_f32 v[70:71], v[70:71], v[32:33]
    v_lshlrev_b32 v34, 16, v20
    v_and_b32 v35, 0xffff0000, v20
    s_waitcnt lgkmcnt(1)
    v_pk_add_f32 v[72:73], v[72:73], v[34:35]
    v_lshlrev_b32 v36, 16, v21
    v_and_b32 v37, 0xffff0000, v21
    v_pk_add_f32 v[74:75], v[74:75], v[36:37]
    v_lshlrev_b32 v32, 16, v22
    v_and_b32 v33, 0xffff0000, v22
    s_waitcnt lgkmcnt(0)
    v_pk_add_f32 v[76:77], v[76:77], v[32:33]
    v_lshlrev_b32 v34, 16, v23
    v_and_b32 v35, 0xffff0000, v23
    v_pk_add_f32 v[78:79], v[78:79], v[34:35]
    s_waitcnt vmcnt(7)
    v_lshlrev_b32 v32, 16, v80
    v_and_b32 v33, 0xffff0000, v80
    v_pk_add_f32 v[64:65], v[64:65], v[32:33]
    v_lshlrev_b32 v34, 16, v81
    v_and_b32 v35, 0xffff0000, v81
    v_pk_add_f32 v[66:67], v[66:67], v[34:35]
    v_lshlrev_b32 v36, 16, v82
    v_and_b32 v37, 0xffff0000, v82
    v_pk_add_f32 v[68:69], v[68:69], v[36:37]
    v_lshlrev_b32 v32, 16, v83
    v_and_b32 v33, 0xffff0000, v83
    v_pk_add_f32 v[70:71], v[70:71], v[32:33]
    s_waitcnt vmcnt(6)
    v_lshlrev_b32 v34, 16, v84
    v_and_b32 v35, 0xffff0000, v84
    v_pk_add_f32 v[72:73], v[72:73], v[34:35]
    v_lshlrev_b32 v36, 16, v85
    v_and_b32 v37, 0xffff0000, v85
    v_pk_add_f32 v[74:75], v[74:75], v[36:37]
    v_lshlrev_b32 v32, 16, v86
    v_and_b32 v33, 0xffff0000, v86
    v_pk_add_f32 v[76:77], v[76:77], v[32:33]
    v_lshlrev_b32 v34, 16, v87
    v_and_b32 v35, 0xffff0000, v87
    v_pk_add_f32 v[78:79], v[78:79], v[34:35]
    s_waitcnt vmcnt(5)
    v_lshlrev_b32 v32, 16, v88
    v_and_b32 v33, 0xffff0000, v88
    v_pk_add_f32 v[64:65], v[64:65], v[32:33]
    v_lshlrev_b32 v34, 16, v89
    v_and_b32 v35, 0xffff0000, v89
    v_pk_add_f32 v[66:67], v[66:67], v[34:35]
    v_lshlrev_b32 v36, 16, v90
    v_and_b32 v37, 0xffff0000, v90
    v_pk_add_f32 v[68:69], v[68:69], v[36:37]
    v_lshlrev_b32 v32, 16, v91
    v_and_b32 v33, 0xffff0000, v91
    v_pk_add_f32 v[70:71], v[70:71], v[32:33]
    s_waitcnt vmcnt(4)
    v_lshlrev_b32 v34, 16, v92
    v_and_b32 v35, 0xffff0000, v92
    v_pk_add_f32 v[72:73], v[72:73], v[34:35]
    v_lshlrev_b32 v36, 16, v93
    v_and_b32 v37, 0xffff0000, v93
    v_pk_add_f32 v[74:75], v[74:75], v[36:37]
    v_lshlrev_b32 v32, 16, v94
    v_and_b32 v33, 0xffff0000, v94
    v_pk_add_f32 v[76:77], v[76:77], v[32:33]
    v_lshlrev_b32 v34, 16, v95
    v_and_b32 v35, 0xffff0000, v95
    v_pk_add_f32 v[78:79], v[78:79], v[34:35]
    s_waitcnt vmcnt(3)
    v_lshlrev_b32 v32, 16, v96
    v_and_b32 v33, 0xffff0000, v96
    v_pk_add_f32 v[64:65], v[64:65], v[32:33]
    v_lshlrev_b32 v34, 16, v97
    v_and_b32 v35, 0xffff0000, v97
    v_pk_add_f32 v[66:67], v[66:67], v[34:35]
    v_lshlrev_b32 v36, 16, v98
    v_and_b32 v37, 0xffff0000, v98
    v_pk_add_f32 v[68:69], v[68:69], v[36:37]
    v_lshlrev_b32 v32, 16, v99
    v_and_b32 v33, 0xffff0000, v99
    v_pk_add_f32 v[70:71], v[70:71], v[32:33]
    s_waitcnt vmcnt(2)
    v_lshlrev_b32 v34, 16, v100
    v_and_b32 v35, 0xffff0000, v100
    v_pk_add_f32 v[72:73], v[72:73], v[34:35]
    v_lshlrev_b32 v36, 16, v101
    v_and_b32 v37, 0xffff0000, v101
    v_pk_add_f32 v[74:75], v[74:75], v[36:37]
    v_lshlrev_b32 v32, 16, v102
    v_and_b32 v33, 0xffff0000, v102
    v_pk_add_f32 v[76:77], v[76:77], v[32:33]
    v_lshlrev_b32 v34, 16, v103
    v_and_b32 v35, 0xffff0000, v103
    v_pk_add_f32 v[78:79], v[78:79], v[34:35]
    s_waitcnt vmcnt(1)
    v_lshlrev_b32 v32, 16, v104
    v_and_b32 v33, 0xffff0000, v104
    v_pk_add_f32 v[64:65], v[64:65], v[32:33]
    v_lshlrev_b32 v34, 16, v105
    v_and_b32 v35, 0xffff0000, v105
    v_pk_add_f32 v[66:67], v[66:67], v[34:35]
    v_lshlrev_b32 v36, 16, v106
    v_and_b32 v37, 0xffff0000, v106
    v_pk_add_f32 v[68:69], v[68:69], v[36:37]
    v_lshlrev_b32 v32, 16, v107
    v_and_b32 v33, 0xffff0000, v107
    v_pk_add_f32 v[70:71], v[70:71], v[32:33]
    s_waitcnt vmcnt(0)
    v_lshlrev_b32 v34, 16, v108
    v_and_b32 v35, 0xffff0000, v108
    v_pk_add_f32 v[72:73], v[72:73], v[34:35]
    v_lshlrev_b32 v36, 16, v109
    v_and_b32 v37, 0xffff0000, v109
    v_pk_add_f32 v[74:75], v[74:75], v[36:37]
    v_lshlrev_b32 v32, 16, v110
    v_and_b32 v33, 0xffff0000, v110
    v_pk_add_f32 v[76:77], v[76:77], v[32:33]
    v_lshlrev_b32 v34, 16, v111
    v_and_b32 v35, 0xffff0000, v111
    v_pk_add_f32 v[78:79], v[78:79], v[34:35]
    v_pk_add_f32 v[36:37], v[64:65], v[66:67]
    v_pk_mul_f32 v[38:39], v[64:65], v[64:65]
    v_pk_fma_f32 v[38:39], v[66:67], v[66:67], v[38:39]
    v_pk_add_f32 v[36:37], v[36:37], v[68:69]
    v_pk_fma_f32 v[38:39], v[68:69], v[68:69], v[38:39]
    v_pk_add_f32 v[36:37], v[36:37], v[70:71]
    v_pk_fma_f32 v[38:39], v[70:71], v[70:71], v[38:39]
    v_pk_add_f32 v[36:37], v[36:37], v[72:73]
    v_pk_fma_f32 v[38:39], v[72:73], v[72:73], v[38:39]
    v_pk_add_f32 v[36:37], v[36:37], v[74:75]
    v_pk_fma_f32 v[38:39], v[74:75], v[74:75], v[38:39]
    v_pk_add_f32 v[36:37], v[36:37], v[76:77]
    v_pk_fma_f32 v[38:39], v[76:77], v[76:77], v[38:39]
    v_pk_add_f32 v[36:37], v[36:37], v[78:79]
    v_pk_fma_f32 v[38:39], v[78:79], v[78:79], v[38:39]
    v_add_f32 v34, v36, v37
    v_add_f32 v35, v38, v39
    v_cvt_pk_bf16_f32 v240, v64, v65
    v_cvt_pk_bf16_f32 v241, v66, v67
    v_cvt_pk_bf16_f32 v242, v68, v69
    v_cvt_pk_bf16_f32 v243, v70, v71
    v_cvt_pk_bf16_f32 v244, v72, v73
    v_cvt_pk_bf16_f32 v245, v74, v75
    v_cvt_pk_bf16_f32 v246, v76, v77
    v_cvt_pk_bf16_f32 v247, v78, v79
    s_lshl_b32 s52, s48, 15
    s_lshl_b32 s53, s41, 12
    s_add_u32 s52, s52, s53
    s_lshl_b32 s53, s47, 11
    s_add_u32 s52, s52, s53
    buffer_store_dwordx4 v[240:243], v14, s[16:19], s52 offen sc1
    buffer_store_dwordx4 v[244:247], v14, s[16:19], s52 offen offset:1024 sc1
    v_mov_b32 v36, v34
    v_mov_b32 v37, v35
    s_nop 1
    v_permlane32_swap_b32 v34, v36
    v_permlane32_swap_b32 v35, v37
    s_nop 1
    v_add_f32 v34, v34, v36
    v_add_f32 v35, v35, v37
    s_lshl_b32 s52, s48, 12
    s_lshl_b32 s53, s41, 9
    s_add_u32 s52, s52, s53
    s_lshl_b32 s53, s47, 8
    s_add_u32 s52, s52, s53
    v_and_b32 v3, 31, v2
    v_lshlrev_b32 v6, 3, v3
    s_mov_b32 exec_hi, 0
    buffer_store_dwordx2 v[34:35], v6, s[20:23], s52 offen sc1
    s_mov_b64 exec, -1
    s_waitcnt vmcnt(0)
    s_barrier
    s_cmp_lg_u32 s42, 0
    s_cbranch_scc1 KC_PUBC
    s_add_u32 s52, s40, 48
    s_lshl_b32 s52, s52, 7
    s_lshl_b32 s53, s41, 2
    s_add_u32 s52, s52, s53
    s_add_u32 s52, s52, 0
    v_mov_b32 v248, 1
    v_mov_b32 v250, s52
    s_mov_b64 exec, 1
    s_cmp_eq_u32 s49, 1
    s_cbranch_scc1 KC_PUBCF
    buffer_store_dword v248, v250, s[24:27], 0 offen sc1
    s_branch KC_PUBCD
KC_PUBCF:
    buffer_store_dword v248, v250, s[24:27], 0 offen
KC_PUBCD:
    s_mov_b64 exec, -1
KC_PUBC:
    s_mov_b32 s32, s70
    s_mov_b32 s33, s71
    s_mov_b32 s34, 3584
    s_mov_b32 s35, 0x20000
    s_add_u32 s36, s78, 55574528
    s_addc_u32 s37, s79, 0
    s_mov_b32 s38, 7340032
    s_mov_b32 s39, 0x20000
    v_add_u32 v15, 98304, v14
    v_lshlrev_b32 v3, 1, v2
    s_lshl_b32 s53, s60, 1
    buffer_load_ushort v136, v3, s[32:35], s53 offen
    s_add_u32 s52, s40, 48
    s_lshl_b32 s52, s52, 7
    v_mov_b32 v250, 10240
    v_and_b32 v6, 7, v2
    v_lshlrev_b32 v6, 2, v6
    v_add_u32 v7, s52, v6
    v_cmp_gt_u32 vcc, 32, v2
    v_mov_b32 v1, 224
    v_mov_b32 v6, 1
    v_cndmask_b32 v250, v250, v7, vcc
    v_cndmask_b32 v1, v1, v6, vcc
    s_cmp_lg_u32 s42, 0
    s_cbranch_scc1 KC_PL1
    buffer_load_dword v249, v250, s[24:27], 0 offen sc1
KC_PL1:
    s_cmp_lg_u32 s42, 0
    s_cbranch_scc1 KC_CK1
    s_waitcnt vmcnt(0)
    v_cmp_gt_u32 vcc, v1, v249
    s_nop 0
    s_cbranch_vccnz KC_SP1
KC_SP1_R:
KC_CK1:
    s_barrier
    s_lshr_b32 s52, s42, 1
    s_and_b32 s53, s42, 1
    s_lshl_b32 s46, s52, 15
    s_lshl_b32 s53, s53, 12
    s_add_u32 s46, s46, s53
    s_lshl_b32 s45, s40, 16
    s_add_u32 s45, s45, s46
    s_add_u32 s46, s46, 98304
    s_add_u32 m0, s46, 0
    s_add_u32 s52, s45, 0
    buffer_load_dwordx4 v14, s[16:19], s52 offen sc1 lds
    buffer_load_dwordx4 v14, s[16:19], s52 offen offset:1024 sc1 lds
    buffer_load_dwordx4 v14, s[16:19], s52 offen offset:2048 sc1 lds
    buffer_load_dwordx4 v14, s[16:19], s52 offen offset:3072 sc1 lds
    s_add_u32 m0, s46, 8192
    s_add_u32 s52, s45, 8192
    buffer_load_dwordx4 v14, s[16:19], s52 offen sc1 lds
    buffer_load_dwordx4 v14, s[16:19], s52 offen offset:1024 sc1 lds
    buffer_load_dwordx4 v14, s[16:19], s52 offen offset:2048 sc1 lds
    buffer_load_dwordx4 v14, s[16:19], s52 offen offset:3072 sc1 lds
    s_add_u32 m0, s46, 16384
    s_add_u32 s52, s45, 16384
    buffer_load_dwordx4 v14, s[16:19], s52 offen sc1 lds
    buffer_load_dwordx4 v14, s[16:19], s52 offen offset:1024 sc1 lds
    buffer_load_dwordx4 v14, s[16:19], s52 offen offset:2048 sc1 lds
    buffer_load_dwordx4 v14, s[16:19], s52 offen offset:3072 sc1 lds
    s_add_u32 m0, s46, 24576
    s_add_u32 s52, s45, 24576
    buffer_load_dwordx4 v14, s[16:19], s52 offen sc1 lds
    buffer_load_dwordx4 v14, s[16:19], s52 offen offset:1024 sc1 lds
    buffer_load_dwordx4 v14, s[16:19], s52 offen offset:2048 sc1 lds
    buffer_load_dwordx4 v14, s[16:19], s52 offen offset:3072 sc1 lds
    s_waitcnt vmcnt(12)
    s_barrier
    ds_read_b64_tr_b16 v[48:49], v12 offset:0
    ds_read_b64_tr_b16 v[50:51], v12 offset:1024
    ds_read_b64_tr_b16 v[52:53], v13 offset:0
    ds_read_b64_tr_b16 v[54:55], v13 offset:1024
    ds_read_b128 v[32:35], v15 offset:0
    ds_read_b128 v[36:39], v15 offset:32768
    s_waitcnt lgkmcnt(1)
    v_mfma_f32_32x32x16_bf16 v[64:79], v[48:51], v[32:35], 0
    ds_read_b64_tr_b16 v[56:57], v12 offset:2048
    ds_read_b64_tr_b16 v[58:59], v12 offset:3072
    s_add_u32 m0, s44, 20480
    s_nop 0
    buffer_load_dwordx4 v8, s[4:7], s43 offen lds
    v_mfma_f32_32x32x16_bf16 v[80:95], v[52:55], v[32:35], 0
    ds_read_b64_tr_b16 v[60:61], v13 offset:2048
    ds_read_b64_tr_b16 v[62:63], v13 offset:3072
    s_waitcnt lgkmcnt(4)
    v_mfma_f32_32x32x16_bf16 v[96:111], v[48:51], v[36:39], 0
    ds_read_b128 v[40:43], v15 offset:1024
    ds_read_b128 v[44:47], v15 offset:33792
    buffer_load_dwordx4 v9, s[4:7], s43 offen offset:1024 lds
    v_mfma_f32_32x32x16_bf16 v[112:127], v[52:55], v[36:39], 0
    v_lshlrev_b32 v3, 2, v2
    s_lshl_b32 s58, s60, 2
    buffer_load_dword v128, v3, s[28:31], s58 offen sc1
    s_add_u32 s58, s58, 7168
    buffer_load_dword v129, v3, s[28:31], s58 offen sc1
    s_add_u32 s58, s58, 7168
    s_waitcnt lgkmcnt(1)
    v_mfma_f32_32x32x16_bf16 v[64:79], v[56:59], v[40:43], v[64:79]
    s_waitcnt vmcnt(44)
    ds_read_b64_tr_b16 v[48:49], v12 offset:4096
    ds_read_b64_tr_b16 v[50:51], v12 offset:5120
    buffer_load_dwordx4 v10, s[4:7], s43 offen offset:2048 lds
    v_mfma_f32_32x32x16_bf16 v[80:95], v[60:63], v[40:43], v[80:95]
    ds_read_b64_tr_b16 v[52:53], v13 offset:4096
    ds_read_b64_tr_b16 v[54:55], v13 offset:5120
    s_waitcnt lgkmcnt(4)
    v_mfma_f32_32x32x16_bf16 v[96:111], v[56:59], v[44:47], v[96:111]
    ds_read_b128 v[32:35], v15 offset:2048
    ds_read_b128 v[36:39], v15 offset:34816
    buffer_load_dwordx4 v11, s[4:7], s43 offen offset:3072 lds
    s_add_u32 s43, s43, 114688
    v_mfma_f32_32x32x16_bf16 v[112:127], v[60:63], v[44:47], v[112:127]
    buffer_load_dword v130, v3, s[28:31], s58 offen sc1
    s_add_u32 s58, s58, 7168
    buffer_load_dword v131, v3, s[28:31], s58 offen sc1
    s_add_u32 s58, s58, 7168
    buffer_load_dword v132, v3, s[28:31], s58 offen sc1
    s_add_u32 s58, s58, 7168
    s_waitcnt lgkmcnt(1)
    v_mfma_f32_32x32x16_bf16 v[64:79], v[48:51], v[32:35], v[64:79]
    ds_read_b64_tr_b16 v[56:57], v12 offset:6144
    ds_read_b64_tr_b16 v[58:59], v12 offset:7168
    s_add_u32 m0, s44, 0
    s_nop 0
    buffer_load_dwordx4 v8, s[4:7], s43 offen lds
    v_mfma_f32_32x32x16_bf16 v[80:95], v[52:55], v[32:35], v[80:95]
    ds_read_b64_tr_b16 v[60:61], v13 offset:6144
    ds_read_b64_tr_b16 v[62:63], v13 offset:7168
    s_waitcnt lgkmcnt(4)
    v_mfma_f32_32x32x16_bf16 v[96:111], v[48:51], v[36:39], v[96:111]
    ds_read_b128 v[40:43], v15 offset:3072
    ds_read_b128 v[44:47], v15 offset:35840
    buffer_load_dwordx4 v9, s[4:7], s43 offen offset:1024 lds
    v_mfma_f32_32x32x16_bf16 v[112:127], v[52:55], v[36:39], v[112:127]
    buffer_load_dword v133, v3, s[28:31], s58 offen sc1
    s_add_u32 s58, s58, 7168
    buffer_load_dword v134, v3, s[28:31], s58 offen sc1
    s_add_u32 s58, s58, 7168
    buffer_load_dword v135, v3, s[28:31], s58 offen sc1
    s_add_u32 s58, s58, 7168
    s_waitcnt lgkmcnt(1)
    v_mfma_f32_32x32x16_bf16 v[64:79], v[56:59], v[40:43], v[64:79]
    s_waitcnt vmcnt(50)
    ds_read_b64_tr_b16 v[48:49], v12 offset:8192
    ds_read_b64_tr_b16 v[50:51], v12 offset:9216
    buffer_load_dwordx4 v10, s[4:7], s43 offen offset:2048 lds
    v_mfma_f32_32x32x16_bf16 v[80:95], v[60:63], v[40:43], v[80:95]
    ds_read_b64_tr_b16 v[52:53], v13 offset:8192
    ds_read_b64_tr_b16 v[54:55], v13 offset:9216
    s_waitcnt lgkmcnt(4)
    v_mfma_f32_32x32x16_bf16 v[96:111], v[56:59], v[44:47], v[96:111]
    ds_read_b128 v[32:35], v15 offset:4096
    ds_read_b128 v[36:39], v15 offset:36864
    buffer_load_dwordx4 v11, s[4:7], s43 offen offset:3072 lds
    s_add_u32 s43, s43, 114688
    v_mfma_f32_32x32x16_bf16 v[112:127], v[60:63], v[44:47], v[112:127]
    v_and_b32 v3, 31, v2
    v_lshrrev_b32 v4, 5, v2
    v_lshlrev_b32 v3, 3, v3
    v_lshl_add_u32 v3, v4, 11, v3
    s_lshl_b32 s58, s40, 13
    buffer_load_dwordx2 v[140:141], v3, s[20:23], s58 offen sc1
    buffer_load_dwordx2 v[142:143], v3, s[20:23], s58 offen offset:256 sc1
    s_waitcnt lgkmcnt(1)
    v_mfma_f32_32x32x16_bf16 v[64:79], v[48:51], v[32:35], v[64:79]
    ds_read_b64_tr_b16 v[56:57], v12 offset:10240
    ds_read_b64_tr_b16 v[58:59], v12 offset:11264
    s_add_u32 m0, s44, 4096
    s_nop 0
    buffer_load_dwordx4 v8, s[4:7], s43 offen lds
    v_mfma_f32_32x32x16_bf16 v[80:95], v[52:55], v[32:35], v[80:95]
    ds_read_b64_tr_b16 v[60:61], v13 offset:10240
    ds_read_b64_tr_b16 v[62:63], v13 offset:11264
    s_waitcnt lgkmcnt(4)
    v_mfma_f32_32x32x16_bf16 v[96:111], v[48:51], v[36:39], v[96:111]
    ds_read_b128 v[40:43], v15 offset:5120
    ds_read_b128 v[44:47], v15 offset:37888
    buffer_load_dwordx4 v9, s[4:7], s43 offen offset:1024 lds
    v_mfma_f32_32x32x16_bf16 v[112:127], v[52:55], v[36:39], v[112:127]
    buffer_load_dwordx2 v[144:145], v3, s[20:23], s58 offen offset:512 sc1
    buffer_load_dwordx2 v[146:147], v3, s[20:23], s58 offen offset:768 sc1
    buffer_load_dwordx2 v[148:149], v3, s[20:23], s58 offen offset:1024 sc1
    s_waitcnt lgkmcnt(1)
    v_mfma_f32_32x32x16_bf16 v[64:79], v[56:59], v[40:43], v[64:79]
    s_waitcnt vmcnt(55)
    ds_read_b64_tr_b16 v[48:49], v12 offset:12288
    ds_read_b64_tr_b16 v[50:51], v12 offset:13312
    buffer_load_dwordx4 v10, s[4:7], s43 offen offset:2048 lds
    v_mfma_f32_32x32x16_bf16 v[80:95], v[60:63], v[40:43], v[80:95]
    ds_read_b64_tr_b16 v[52:53], v13 offset:12288
    ds_read_b64_tr_b16 v[54:55], v13 offset:13312
    s_waitcnt lgkmcnt(4)
    v_mfma_f32_32x32x16_bf16 v[96:111], v[56:59], v[44:47], v[96:111]
    ds_read_b128 v[32:35], v15 offset:6144
    ds_read_b128 v[36:39], v15 offset:38912
    buffer_load_dwordx4 v11, s[4:7], s43 offen offset:3072 lds
    s_add_u32 s43, s43, 114688
    v_mfma_f32_32x32x16_bf16 v[112:127], v[60:63], v[44:47], v[112:127]
    buffer_load_dwordx2 v[150:151], v3, s[20:23], s58 offen offset:1280 sc1
    buffer_load_dwordx2 v[152:153], v3, s[20:23], s58 offen offset:1536 sc1
    buffer_load_dwordx2 v[154:155], v3, s[20:23], s58 offen offset:1792 sc1
    s_add_u32 s58, s58, 4096
    s_waitcnt lgkmcnt(1)
    v_mfma_f32_32x32x16_bf16 v[64:79], v[48:51], v[32:35], v[64:79]
    ds_read_b64_tr_b16 v[56:57], v12 offset:14336
    ds_read_b64_tr_b16 v[58:59], v12 offset:15360
    s_add_u32 m0, s44, 8192
    s_nop 0
    buffer_load_dwordx4 v8, s[4:7], s43 offen lds
    v_mfma_f32_32x32x16_bf16 v[80:95], v[52:55], v[32:35], v[80:95]
    ds_read_b64_tr_b16 v[60:61], v13 offset:14336
    ds_read_b64_tr_b16 v[62:63], v13 offset:15360
    s_waitcnt lgkmcnt(4)
    v_mfma_f32_32x32x16_bf16 v[96:111], v[48:51], v[36:39], v[96:111]
    ds_read_b128 v[40:43], v15 offset:7168
    ds_read_b128 v[44:47], v15 offset:39936
    buffer_load_dwordx4 v9, s[4:7], s43 offen offset:1024 lds
    v_mfma_f32_32x32x16_bf16 v[112:127], v[52:55], v[36:39], v[112:127]
    buffer_load_dwordx2 v[156:157], v3, s[20:23], s58 offen sc1
    buffer_load_dwordx2 v[158:159], v3, s[20:23], s58 offen offset:256 sc1
    buffer_load_dwordx2 v[160:161], v3, s[20:23], s58 offen offset:512 sc1
    s_waitcnt lgkmcnt(1)
    v_mfma_f32_32x32x16_bf16 v[64:79], v[56:59], v[40:43], v[64:79]
    s_waitcnt vmcnt(41)
    s_barrier
    s_waitcnt vmcnt(61)
    ds_read_b64_tr_b16 v[48:49], v12 offset:16384
    ds_read_b64_tr_b16 v[50:51], v12 offset:17408
    buffer_load_dwordx4 v10, s[4:7], s43 offen offset:2048 lds
    v_mfma_f32_32x32x16_bf16 v[80:95], v[60:63], v[40:43], v[80:95]
    ds_read_b64_tr_b16 v[52:53], v13 offset:16384
    ds_read_b64_tr_b16 v[54:55], v13 offset:17408
    s_waitcnt lgkmcnt(4)
    v_mfma_f32_32x32x16_bf16 v[96:111], v[56:59], v[44:47], v[96:111]
    ds_read_b128 v[32:35], v15 offset:8192
    ds_read_b128 v[36:39], v15 offset:40960
    buffer_load_dwordx4 v11, s[4:7], s43 offen offset:3072 lds
    s_add_u32 s43, s43, 114688
    v_mfma_f32_32x32x16_bf16 v[112:127], v[60:63], v[44:47], v[112:127]
    buffer_load_dwordx2 v[162:163], v3, s[20:23], s58 offen offset:768 sc1
    buffer_load_dwordx2 v[164:165], v3, s[20:23], s58 offen offset:1024 sc1
    buffer_load_dwordx2 v[166:167], v3, s[20:23], s58 offen offset:1280 sc1
    s_waitcnt lgkmcnt(1)
    v_mfma_f32_32x32x16_bf16 v[64:79], v[48:51], v[32:35], v[64:79]
    ds_read_b64_tr_b16 v[56:57], v12 offset:18432
    ds_read_b64_tr_b16 v[58:59], v12 offset:19456
    s_add_u32 m0, s44, 12288
    s_nop 0
    buffer_load_dwordx4 v8, s[4:7], s43 offen lds
    v_mfma_f32_32x32x16_bf16 v[80:95], v[52:55], v[32:35], v[80:95]
    ds_read_b64_tr_b16 v[60:61], v13 offset:18432
    ds_read_b64_tr_b16 v[62:63], v13 offset:19456
    s_waitcnt lgkmcnt(4)
    v_mfma_f32_32x32x16_bf16 v[96:111], v[48:51], v[36:39], v[96:111]
    ds_read_b128 v[40:43], v15 offset:9216
    ds_read_b128 v[44:47], v15 offset:41984
    buffer_load_dwordx4 v9, s[4:7], s43 offen offset:1024 lds
    v_mfma_f32_32x32x16_bf16 v[112:127], v[52:55], v[36:39], v[112:127]
    buffer_load_dwordx2 v[168:169], v3, s[20:23], s58 offen offset:1536 sc1
    buffer_load_dwordx2 v[170:171], v3, s[20:23], s58 offen offset:1792 sc1
    s_add_u32 s58, s58, 4096
    s_waitcnt lgkmcnt(1)
    v_mfma_f32_32x32x16_bf16 v[64:79], v[56:59], v[40:43], v[64:79]
    s_waitcnt vmcnt(36)
    ds_read_b64_tr_b16 v[48:49], v12 offset:20480
    ds_read_b64_tr_b16 v[50:51], v12 offset:21504
    buffer_load_dwordx4 v10, s[4:7], s43 offen offset:2048 lds
    v_mfma_f32_32x32x16_bf16 v[80:95], v[60:63], v[40:43], v[80:95]
    ds_read_b64_tr_b16 v[52:53], v13 offset:20480
    ds_read_b64_tr_b16 v[54:55], v13 offset:21504
    s_waitcnt lgkmcnt(4)
    v_mfma_f32_32x32x16_bf16 v[96:111], v[56:59], v[44:47], v[96:111]
    ds_read_b128 v[32:35], v15 offset:10240
    ds_read_b128 v[36:39], v15 offset:43008
    buffer_load_dwordx4 v11, s[4:7], s43 offen offset:3072 lds
    s_add_u32 s43, s43, 114688
    v_mfma_f32_32x32x16_bf16 v[112:127], v[60:63], v[44:47], v[112:127]
    s_waitcnt lgkmcnt(1)
    v_mfma_f32_32x32x16_bf16 v[64:79], v[48:51], v[32:35], v[64:79]
    ds_read_b64_tr_b16 v[56:57], v12 offset:22528
    ds_read_b64_tr_b16 v[58:59], v12 offset:23552
    s_add_u32 m0, s44, 16384
    s_nop 0
    buffer_load_dwordx4 v8, s[4:7], s43 offen lds
    v_mfma_f32_32x32x16_bf16 v[80:95], v[52:55], v[32:35], v[80:95]
    ds_read_b64_tr_b16 v[60:61], v13 offset:22528
    ds_read_b64_tr_b16 v[62:63], v13 offset:23552
    s_waitcnt lgkmcnt(4)
    v_mfma_f32_32x32x16_bf16 v[96:111], v[48:51], v[36:39], v[96:111]
    ds_read_b128 v[40:43], v15 offset:11264
    ds_read_b128 v[44:47], v15 offset:44032
    buffer_load_dwordx4 v9, s[4:7], s43 offen offset:1024 lds
    v_mfma_f32_32x32x16_bf16 v[112:127], v[52:55], v[36:39], v[112:127]
    s_waitcnt lgkmcnt(1)
    v_mfma_f32_32x32x16_bf16 v[64:79], v[56:59], v[40:43], v[64:79]
    s_waitcnt vmcnt(30)
    ds_read_b64_tr_b16 v[48:49], v12 offset:0
    ds_read_b64_tr_b16 v[50:51], v12 offset:1024
    buffer_load_dwordx4 v10, s[4:7], s43 offen offset:2048 lds
    v_mfma_f32_32x32x16_bf16 v[80:95], v[60:63], v[40:43], v[80:95]
    ds_read_b64_tr_b16 v[52:53], v13 offset:0
    ds_read_b64_tr_b16 v[54:55], v13 offset:1024
    s_waitcnt lgkmcnt(4)
    v_mfma_f32_32x32x16_bf16 v[96:111], v[56:59], v[44:47], v[96:111]
    ds_read_b128 v[32:35], v15 offset:12288
    ds_read_b128 v[36:39], v15 offset:45056
    buffer_load_dwordx4 v11, s[4:7], s43 offen offset:3072 lds
    s_add_u32 s43, s43, 114688
    v_mfma_f32_32x32x16_bf16 v[112:127], v[60:63], v[44:47], v[112:127]
    s_waitcnt lgkmcnt(1)
    v_mfma_f32_32x32x16_bf16 v[64:79], v[48:51], v[32:35], v[64:79]
    ds_read_b64_tr_b16 v[56:57], v12 offset:2048
    ds_read_b64_tr_b16 v[58:59], v12 offset:3072
    s_add_u32 m0, s44, 20480
    s_nop 0
    buffer_load_dwordx4 v8, s[4:7], s43 offen lds
    v_mfma_f32_32x32x16_bf16 v[80:95], v[52:55], v[32:35], v[80:95]
    ds_read_b64_tr_b16 v[60:61], v13 offset:2048
    ds_read_b64_tr_b16 v[62:63], v13 offset:3072
    s_waitcnt lgkmcnt(4)
    v_mfma_f32_32x32x16_bf16 v[96:111], v[48:51], v[36:39], v[96:111]
    ds_read_b128 v[40:43], v15 offset:13312
    ds_read_b128 v[44:47], v15 offset:46080
    buffer_load_dwordx4 v9, s[4:7], s43 offen offset:1024 lds
    v_mfma_f32_32x32x16_bf16 v[112:127], v[52:55], v[36:39], v[112:127]
    s_waitcnt lgkmcnt(1)
    v_mfma_f32_32x32x16_bf16 v[64:79], v[56:59], v[40:43], v[64:79]
    s_waitcnt vmcnt(25)
    ds_read_b64_tr_b16 v[48:49], v12 offset:4096
    ds_read_b64_tr_b16 v[50:51], v12 offset:5120
    buffer_load_dwordx4 v10, s[4:7], s43 offen offset:2048 lds
    v_mfma_f32_32x32x16_bf16 v[80:95], v[60:63], v[40:43], v[80:95]
    ds_read_b64_tr_b16 v[52:53], v13 offset:4096
    ds_read_b64_tr_b16 v[54:55], v13 offset:5120
    s_waitcnt lgkmcnt(4)
    v_mfma_f32_32x32x16_bf16 v[96:111], v[56:59], v[44:47], v[96:111]
    ds_read_b128 v[32:35], v15 offset:14336
    ds_read_b128 v[36:39], v15 offset:47104
    buffer_load_dwordx4 v11, s[4:7], s43 offen offset:3072 lds
    s_add_u32 s43, s43, 114688
    v_mfma_f32_32x32x16_bf16 v[112:127], v[60:63], v[44:47], v[112:127]
    s_waitcnt lgkmcnt(1)
    v_mfma_f32_32x32x16_bf16 v[64:79], v[48:51], v[32:35], v[64:79]
    ds_read_b64_tr_b16 v[56:57], v12 offset:6144
    ds_read_b64_tr_b16 v[58:59], v12 offset:7168
    s_add_u32 m0, s44, 0
    s_nop 0
    buffer_load_dwordx4 v8, s[4:7], s43 offen lds
    v_mfma_f32_32x32x16_bf16 v[80:95], v[52:55], v[32:35], v[80:95]
    ds_read_b64_tr_b16 v[60:61], v13 offset:6144
    ds_read_b64_tr_b16 v[62:63], v13 offset:7168
    s_waitcnt lgkmcnt(4)
    v_mfma_f32_32x32x16_bf16 v[96:111], v[48:51], v[36:39], v[96:111]
    ds_read_b128 v[40:43], v15 offset:15360
    ds_read_b128 v[44:47], v15 offset:48128
    buffer_load_dwordx4 v9, s[4:7], s43 offen offset:1024 lds
    v_mfma_f32_32x32x16_bf16 v[112:127], v[52:55], v[36:39], v[112:127]
    v_add_f32 v128, v128, v129
    v_add_f32 v128, v128, v130
    v_add_f32 v128, v128, v131
    v_add_f32 v128, v128, v132
    v_add_f32 v128, v128, v133
    s_waitcnt lgkmcnt(1)
    v_mfma_f32_32x32x16_bf16 v[64:79], v[56:59], v[40:43], v[64:79]
    s_waitcnt vmcnt(58)
    s_barrier
    s_waitcnt vmcnt(19)
    ds_read_b64_tr_b16 v[48:49], v12 offset:8192
    ds_read_b64_tr_b16 v[50:51], v12 offset:9216
    buffer_load_dwordx4 v10, s[4:7], s43 offen offset:2048 lds
    v_mfma_f32_32x32x16_bf16 v[80:95], v[60:63], v[40:43], v[80:95]
    ds_read_b64_tr_b16 v[52:53], v13 offset:8192
    ds_read_b64_tr_b16 v[54:55], v13 offset:9216
    s_waitcnt lgkmcnt(4)
    v_mfma_f32_32x32x16_bf16 v[96:111], v[56:59], v[44:47], v[96:111]
    ds_read_b128 v[32:35], v15 offset:16384
    ds_read_b128 v[36:39], v15 offset:49152
    buffer_load_dwordx4 v11, s[4:7], s43 offen offset:3072 lds
    s_add_u32 s43, s43, 114688
    v_mfma_f32_32x32x16_bf16 v[112:127], v[60:63], v[44:47], v[112:127]
    v_add_f32 v128, v128, v134
    v_add_f32 v128, v128, v135
    v_lshlrev_b32 v136, 16, v136
    v_add_f32 v140, v140, v142
    v_add_f32 v141, v141, v143
    s_waitcnt lgkmcnt(1)
    v_mfma_f32_32x32x16_bf16 v[64:79], v[48:51], v[32:35], v[64:79]
    ds_read_b64_tr_b16 v[56:57], v12 offset:10240
    ds_read_b64_tr_b16 v[58:59], v12 offset:11264
    s_add_u32 m0, s44, 4096
    s_nop 0
    buffer_load_dwordx4 v8, s[4:7], s43 offen lds
    v_mfma_f32_32x32x16_bf16 v[80:95], v[52:55], v[32:35], v[80:95]
    ds_read_b64_tr_b16 v[60:61], v13 offset:10240
    ds_read_b64_tr_b16 v[62:63], v13 offset:11264
    s_waitcnt lgkmcnt(4)
    v_mfma_f32_32x32x16_bf16 v[96:111], v[48:51], v[36:39], v[96:111]
    ds_read_b128 v[40:43], v15 offset:17408
    ds_read_b128 v[44:47], v15 offset:50176
    buffer_load_dwordx4 v9, s[4:7], s43 offen offset:1024 lds
    v_mfma_f32_32x32x16_bf16 v[112:127], v[52:55], v[36:39], v[112:127]
    v_add_f32 v140, v140, v144
    v_add_f32 v141, v141, v145
    v_add_f32 v140, v140, v146
    v_add_f32 v141, v141, v147
    v_add_f32 v140, v140, v148
    s_waitcnt lgkmcnt(1)
    v_mfma_f32_32x32x16_bf16 v[64:79], v[56:59], v[40:43], v[64:79]
    s_waitcnt vmcnt(14)
    ds_read_b64_tr_b16 v[48:49], v12 offset:12288
    ds_read_b64_tr_b16 v[50:51], v12 offset:13312
    buffer_load_dwordx4 v10, s[4:7], s43 offen offset:2048 lds
    v_mfma_f32_32x32x16_bf16 v[80:95], v[60:63], v[40:43], v[80:95]
    ds_read_b64_tr_b16 v[52:53], v13 offset:12288
    ds_read_b64_tr_b16 v[54:55], v13 offset:13312
    s_waitcnt lgkmcnt(4)
    v_mfma_f32_32x32x16_bf16 v[96:111], v[56:59], v[44:47], v[96:111]
    ds_read_b128 v[32:35], v15 offset:18432
    ds_read_b128 v[36:39], v15 offset:51200
    buffer_load_dwordx4 v11, s[4:7], s43 offen offset:3072 lds
    s_add_u32 s43, s43, 114688
    v_mfma_f32_32x32x16_bf16 v[112:127], v[60:63], v[44:47], v[112:127]
    v_add_f32 v141, v141, v149
    v_add_f32 v140, v140, v150
    v_add_f32 v141, v141, v151
    v_add_f32 v140, v140, v152
    v_add_f32 v141, v141, v153
    s_waitcnt lgkmcnt(1)
    v_mfma_f32_32x32x16_bf16 v[64:79], v[48:51], v[32:35], v[64:79]
    ds_read_b64_tr_b16 v[56:57], v12 offset:14336
    ds_read_b64_tr_b16 v[58:59], v12 offset:15360
    s_add_u32 m0, s44, 8192
    s_nop 0
    buffer_load_dwordx4 v8, s[4:7], s43 offen lds
    v_mfma_f32_32x32x16_bf16 v[80:95], v[52:55], v[32:35], v[80:95]
    ds_read_b64_tr_b16 v[60:61], v13 offset:14336
    ds_read_b64_tr_b16 v[62:63], v13 offset:15360
    s_waitcnt lgkmcnt(4)
    v_mfma_f32_32x32x16_bf16 v[96:111], v[48:51], v[36:39], v[96:111]
    ds_read_b128 v[40:43], v15 offset:19456
    ds_read_b128 v[44:47], v15 offset:52224
    buffer_load_dwordx4 v9, s[4:7], s43 offen offset:1024 lds
    v_mfma_f32_32x32x16_bf16 v[112:127], v[52:55], v[36:39], v[112:127]
    v_add_f32 v140, v140, v154
    v_add_f32 v141, v141, v155
    v_mov_b32 v142, v140
    v_mov_b32 v143, v141
    s_nop 1
    s_waitcnt lgkmcnt(1)
    v_mfma_f32_32x32x16_bf16 v[64:79], v[56:59], v[40:43], v[64:79]
    s_waitcnt vmcnt(14)
    ds_read_b64_tr_b16 v[48:49], v12 offset:16384
    ds_read_b64_tr_b16 v[50:51], v12 offset:17408
    buffer_load_dwordx4 v10, s[4:7], s43 offen offset:2048 lds
    v_mfma_f32_32x32x16_bf16 v[80:95], v[60:63], v[40:43], v[80:95]
    ds_read_b64_tr_b16 v[52:53], v13 offset:16384
    ds_read_b64_tr_b16 v[54:55], v13 offset:17408
    s_waitcnt lgkmcnt(4)
    v_mfma_f32_32x32x16_bf16 v[96:111], v[56:59], v[44:47], v[96:111]
    ds_read_b128 v[32:35], v15 offset:20480
    ds_read_b128 v[36:39], v15 offset:53248
    buffer_load_dwordx4 v11, s[4:7], s43 offen offset:3072 lds
    s_add_u32 s43, s43, 114688
    v_mfma_f32_32x32x16_bf16 v[112:127], v[60:63], v[44:47], v[112:127]
    v_permlane32_swap_b32 v140, v142
    v_permlane32_swap_b32 v141, v143
    s_nop 1
    v_add_f32 v140, v140, v142
    v_add_f32 v141, v141, v143
    s_waitcnt lgkmcnt(1)
    v_mfma_f32_32x32x16_bf16 v[64:79], v[48:51], v[32:35], v[64:79]
    ds_read_b64_tr_b16 v[56:57], v12 offset:18432
    ds_read_b64_tr_b16 v[58:59], v12 offset:19456
    s_add_u32 m0, s44, 12288
    s_nop 0
    buffer_load_dwordx4 v8, s[4:7], s43 offen lds
    v_mfma_f32_32x32x16_bf16 v[80:95], v[52:55], v[32:35], v[80:95]
    ds_read_b64_tr_b16 v[60:61], v13 offset:18432
    ds_read_b64_tr_b16 v[62:63], v13 offset:19456
    s_waitcnt lgkmcnt(4)
    v_mfma_f32_32x32x16_bf16 v[96:111], v[48:51], v[36:39], v[96:111]
    ds_read_b128 v[40:43], v15 offset:21504
    ds_read_b128 v[44:47], v15 offset:54272
    buffer_load_dwordx4 v9, s[4:7], s43 offen offset:1024 lds
    v_mfma_f32_32x32x16_bf16 v[112:127], v[52:55], v[36:39], v[112:127]
    v_mul_f32 v140, 0x3b000000, v140
    v_mul_f32 v141, 0x3b000000, v141
    v_fma_f32 v141, -v140, v140, v141
    v_max_f32 v141, 0, v141
    v_add_f32 v141, 0x3727c5ac, v141
    s_waitcnt lgkmcnt(1)
    v_mfma_f32_32x32x16_bf16 v[64:79], v[56:59], v[40:43], v[64:79]
    s_waitcnt vmcnt(14)
    ds_read_b64_tr_b16 v[48:49], v12 offset:20480
    ds_read_b64_tr_b16 v[50:51], v12 offset:21504
    buffer_load_dwordx4 v10, s[4:7], s43 offen offset:2048 lds
    v_mfma_f32_32x32x16_bf16 v[80:95], v[60:63], v[40:43], v[80:95]
    ds_read_b64_tr_b16 v[52:53], v13 offset:20480
    ds_read_b64_tr_b16 v[54:55], v13 offset:21504
    s_waitcnt lgkmcnt(4)
    v_mfma_f32_32x32x16_bf16 v[96:111], v[56:59], v[44:47], v[96:111]
    ds_read_b128 v[32:35], v15 offset:22528
    ds_read_b128 v[36:39], v15 offset:55296
    buffer_load_dwordx4 v11, s[4:7], s43 offen offset:3072 lds
    s_add_u32 s43, s43, 114688
    v_mfma_f32_32x32x16_bf16 v[112:127], v[60:63], v[44:47], v[112:127]
    v_rsq_f32 v141, v141
    s_nop 0
    v_mul_f32 v140, v140, v141
    v_add_f32 v156, v156, v158
    v_add_f32 v157, v157, v159
    s_waitcnt lgkmcnt(1)
    v_mfma_f32_32x32x16_bf16 v[64:79], v[48:51], v[32:35], v[64:79]
    ds_read_b64_tr_b16 v[56:57], v12 offset:22528
    ds_read_b64_tr_b16 v[58:59], v12 offset:23552
    v_mfma_f32_32x32x16_bf16 v[80:95], v[52:55], v[32:35], v[80:95]
    ds_read_b64_tr_b16 v[60:61], v13 offset:22528
    ds_read_b64_tr_b16 v[62:63], v13 offset:23552
    s_waitcnt lgkmcnt(4)
    v_mfma_f32_32x32x16_bf16 v[96:111], v[48:51], v[36:39], v[96:111]
    ds_read_b128 v[40:43], v15 offset:23552
    ds_read_b128 v[44:47], v15 offset:56320
    v_mfma_f32_32x32x16_bf16 v[112:127], v[52:55], v[36:39], v[112:127]
    v_add_f32 v156, v156, v160
    v_add_f32 v157, v157, v161
    v_add_f32 v156, v156, v162
    v_add_f32 v157, v157, v163
    v_add_f32 v156, v156, v164
    s_waitcnt lgkmcnt(1)
    v_mfma_f32_32x32x16_bf16 v[64:79], v[56:59], v[40:43], v[64:79]
    s_waitcnt vmcnt(63)
    s_barrier
    s_waitcnt vmcnt(12)
    ds_read_b64_tr_b16 v[48:49], v12 offset:0
    ds_read_b64_tr_b16 v[50:51], v12 offset:1024
    v_mfma_f32_32x32x16_bf16 v[80:95], v[60:63], v[40:43], v[80:95]
    ds_read_b64_tr_b16 v[52:53], v13 offset:0
    ds_read_b64_tr_b16 v[54:55], v13 offset:1024
    s_waitcnt lgkmcnt(4)
    v_mfma_f32_32x32x16_bf16 v[96:111], v[56:59], v[44:47], v[96:111]
    ds_read_b128 v[32:35], v15 offset:24576
    ds_read_b128 v[36:39], v15 offset:57344
    v_mfma_f32_32x32x16_bf16 v[112:127], v[60:63], v[44:47], v[112:127]
    v_add_f32 v157, v157, v165
    v_add_f32 v156, v156, v166
    v_add_f32 v157, v157, v167
    v_add_f32 v156, v156, v168
    v_add_f32 v157, v157, v169
    s_waitcnt lgkmcnt(1)
    v_mfma_f32_32x32x16_bf16 v[64:79], v[48:51], v[32:35], v[64:79]
    ds_read_b64_tr_b16 v[56:57], v12 offset:2048
    ds_read_b64_tr_b16 v[58:59], v12 offset:3072
    v_mfma_f32_32x32x16_bf16 v[80:95], v[52:55], v[32:35], v[80:95]
    ds_read_b64_tr_b16 v[60:61], v13 offset:2048
    ds_read_b64_tr_b16 v[62:63], v13 offset:3072
    s_waitcnt lgkmcnt(4)
    v_mfma_f32_32x32x16_bf16 v[96:111], v[48:51], v[36:39], v[96:111]
    ds_read_b128 v[40:43], v15 offset:25600
    ds_read_b128 v[44:47], v15 offset:58368
    v_mfma_f32_32x32x16_bf16 v[112:127], v[52:55], v[36:39], v[112:127]
    v_add_f32 v156, v156, v170
    v_add_f32 v157, v157, v171
    v_mov_b32 v158, v156
    v_mov_b32 v159, v157
    s_nop 1
    s_waitcnt lgkmcnt(1)
    v_mfma_f32_32x32x16_bf16 v[64:79], v[56:59], v[40:43], v[64:79]
    s_waitcnt vmcnt(8)
    ds_read_b64_tr_b16 v[48:49], v12 offset:4096
    ds_read_b64_tr_b16 v[50:51], v12 offset:5120
    v_mfma_f32_32x32x16_bf16 v[80:95], v[60:63], v[40:43], v[80:95]
    ds_read_b64_tr_b16 v[52:53], v13 offset:4096
    ds_read_b64_tr_b16 v[54:55], v13 offset:5120
    s_waitcnt lgkmcnt(4)
    v_mfma_f32_32x32x16_bf16 v[96:111], v[56:59], v[44:47], v[96:111]
    ds_read_b128 v[32:35], v15 offset:26624
    ds_read_b128 v[36:39], v15 offset:59392
    v_mfma_f32_32x32x16_bf16 v[112:127], v[60:63], v[44:47], v[112:127]
    v_permlane32_swap_b32 v156, v158
    v_permlane32_swap_b32 v157, v159
    s_nop 1
    v_add_f32 v156, v156, v158
    v_add_f32 v157, v157, v159
    s_waitcnt lgkmcnt(1)
    v_mfma_f32_32x32x16_bf16 v[64:79], v[48:51], v[32:35], v[64:79]
    ds_read_b64_tr_b16 v[56:57], v12 offset:6144
    ds_read_b64_tr_b16 v[58:59], v12 offset:7168
    v_mfma_f32_32x32x16_bf16 v[80:95], v[52:55], v[32:35], v[80:95]
    ds_read_b64_tr_b16 v[60:61], v13 offset:6144
    ds_read_b64_tr_b16 v[62:63], v13 offset:7168
    s_waitcnt lgkmcnt(4)
    v_mfma_f32_32x32x16_bf16 v[96:111], v[48:51], v[36:39], v[96:111]
    ds_read_b128 v[40:43], v15 offset:27648
    ds_read_b128 v[44:47], v15 offset:60416
    v_mfma_f32_32x32x16_bf16 v[112:127], v[52:55], v[36:39], v[112:127]
    v_mul_f32 v156, 0x3b000000, v156
    v_mul_f32 v157, 0x3b000000, v157
    v_fma_f32 v157, -v156, v156, v157
    v_max_f32 v157, 0, v157
    v_add_f32 v157, 0x3727c5ac, v157
    s_waitcnt lgkmcnt(1)
    v_mfma_f32_32x32x16_bf16 v[64:79], v[56:59], v[40:43], v[64:79]
    s_waitcnt vmcnt(4)
    ds_read_b64_tr_b16 v[48:49], v12 offset:8192
    ds_read_b64_tr_b16 v[50:51], v12 offset:9216
    v_mfma_f32_32x32x16_bf16 v[80:95], v[60:63], v[40:43], v[80:95]
    ds_read_b64_tr_b16 v[52:53], v13 offset:8192
    ds_read_b64_tr_b16 v[54:55], v13 offset:9216
    s_waitcnt lgkmcnt(4)
    v_mfma_f32_32x32x16_bf16 v[96:111], v[56:59], v[44:47], v[96:111]
    ds_read_b128 v[32:35], v15 offset:28672
    ds_read_b128 v[36:39], v15 offset:61440
    v_mfma_f32_32x32x16_bf16 v[112:127], v[60:63], v[44:47], v[112:127]
    v_rsq_f32 v157, v157
    s_nop 0
    v_mul_f32 v156, v156, v157
    s_waitcnt lgkmcnt(1)
    v_mfma_f32_32x32x16_bf16 v[64:79], v[48:51], v[32:35], v[64:79]
    ds_read_b64_tr_b16 v[56:57], v12 offset:10240
    ds_read_b64_tr_b16 v[58:59], v12 offset:11264
    v_mfma_f32_32x32x16_bf16 v[80:95], v[52:55], v[32:35], v[80:95]
    ds_read_b64_tr_b16 v[60:61], v13 offset:10240
    ds_read_b64_tr_b16 v[62:63], v13 offset:11264
    s_waitcnt lgkmcnt(4)
    v_mfma_f32_32x32x16_bf16 v[96:111], v[48:51], v[36:39], v[96:111]
    ds_read_b128 v[40:43], v15 offset:29696
    ds_read_b128 v[44:47], v15 offset:62464
    v_mfma_f32_32x32x16_bf16 v[112:127], v[52:55], v[36:39], v[112:127]
    s_waitcnt lgkmcnt(1)
    v_mfma_f32_32x32x16_bf16 v[64:79], v[56:59], v[40:43], v[64:79]
    s_waitcnt vmcnt(0)
    ds_read_b64_tr_b16 v[48:49], v12 offset:12288
    ds_read_b64_tr_b16 v[50:51], v12 offset:13312
    v_mfma_f32_32x32x16_bf16 v[80:95], v[60:63], v[40:43], v[80:95]
    ds_read_b64_tr_b16 v[52:53], v13 offset:12288
    ds_read_b64_tr_b16 v[54:55], v13 offset:13312
    s_waitcnt lgkmcnt(4)
    v_mfma_f32_32x32x16_bf16 v[96:111], v[56:59], v[44:47], v[96:111]
    ds_read_b128 v[32:35], v15 offset:30720
    ds_read_b128 v[36:39], v15 offset:63488
    v_mfma_f32_32x32x16_bf16 v[112:127], v[60:63], v[44:47], v[112:127]
    s_waitcnt lgkmcnt(1)
    v_mfma_f32_32x32x16_bf16 v[64:79], v[48:51], v[32:35], v[64:79]
    ds_read_b64_tr_b16 v[56:57], v12 offset:14336
    ds_read_b64_tr_b16 v[58:59], v12 offset:15360
    v_mfma_f32_32x32x16_bf16 v[80:95], v[52:55], v[32:35], v[80:95]
    ds_read_b64_tr_b16 v[60:61], v13 offset:14336
    ds_read_b64_tr_b16 v[62:63], v13 offset:15360
    s_waitcnt lgkmcnt(4)
    v_mfma_f32_32x32x16_bf16 v[96:111], v[48:51], v[36:39], v[96:111]
    ds_read_b128 v[40:43], v15 offset:31744
    ds_read_b128 v[44:47], v15 offset:64512
    v_mfma_f32_32x32x16_bf16 v[112:127], v[52:55], v[36:39], v[112:127]
    s_waitcnt lgkmcnt(1)
    v_mfma_f32_32x32x16_bf16 v[64:79], v[56:59], v[40:43], v[64:79]
    v_mfma_f32_32x32x16_bf16 v[80:95], v[60:63], v[40:43], v[80:95]
    s_waitcnt lgkmcnt(0)
    v_mfma_f32_32x32x16_bf16 v[96:111], v[56:59], v[44:47], v[96:111]
    v_mfma_f32_32x32x16_bf16 v[112:127], v[60:63], v[44:47], v[112:127]
    s_nop 7
    v_lshlrev_b32 v3, 2, v2
    v_add_u32 v3, s44, v3
    ds_write_b32 v3, v128
    ds_write_b32 v3, v136 offset:256
    v_lshrrev_b32 v4, 5, v2
    v_lshlrev_b32 v4, 4, v4
    v_add_u32 v4, s44, v4
    s_waitcnt lgkmcnt(0)
    ds_read_b128 v[176:179], v4 offset:0
    ds_read_b128 v[208:211], v4 offset:256
    ds_read_b128 v[180:183], v4 offset:32
    ds_read_b128 v[212:215], v4 offset:288
    ds_read_b128 v[184:187], v4 offset:64
    ds_read_b128 v[216:219], v4 offset:320
    ds_read_b128 v[188:191], v4 offset:96
    ds_read_b128 v[220:223], v4 offset:352
    ds_read_b128 v[192:195], v4 offset:128
    ds_read_b128 v[224:227], v4 offset:384
    ds_read_b128 v[196:199], v4 offset:160
    ds_read_b128 v[228:231], v4 offset:416
    ds_read_b128 v[200:203], v4 offset:192
    ds_read_b128 v[232:235], v4 offset:448
    ds_read_b128 v[204:207], v4 offset:224
    ds_read_b128 v[236:239], v4 offset:480
    s_waitcnt lgkmcnt(0)
    s_barrier
    s_mul_i32 s44, s42, 40960
    v_lshrrev_b32 v1, 3, v2
    v_bfe_u32 v3, v2, 2, 1
    v_bfe_u32 v4, v2, 4, 1
    v_xor_b32 v3, v3, v4
    v_and_b32 v4, 3, v2
    v_lshl_add_u32 v3, v3, 2, v4
    v_lshlrev_b32 v3, 4, v3
    v_mul_u32_u24 v1, 128, v1
    v_add_u32 v3, v3, v1
    v_add_u32 v8, 0, v3
    v_add_u32 v9, 0, v3
    v_add_u32 v10, 0, v3
    v_add_u32 v11, 0, v3
    v_and_b32 v3, 15, v2
    v_lshrrev_b32 v4, 2, v3
    v_and_b32 v3, 3, v3
    v_bfe_u32 v6, v2, 4, 1
    v_lshrrev_b32 v7, 5, v2
    v_lshl_add_u32 v1, v7, 2, v4
    v_lshlrev_b32 v1, 7, v1
    v_lshl_add_u32 v1, v6, 5, v1
    v_lshl_add_u32 v1, v3, 3, v1
    v_add_u32 v1, s44, v1
    v_lshrrev_b32 v4, 1, v4
    v_xor_b32 v3, 0, v4
    v_lshl_add_u32 v12, v3, 6, v1
    v_xor_b32 v3, 1, v4
    v_lshl_add_u32 v13, v3, 6, v1
    s_add_u32 s4, s78, 71303168
    s_addc_u32 s5, s79, 0
    s_mov_b32 s6, 1835008
    s_mov_b32 s7, 0x20000
    s_add_u32 s8, s78, 55574528
    s_addc_u32 s9, s79, 0
    s_mov_b32 s10, 7340032
    s_mov_b32 s11, 0x20000
    s_mov_b32 s32, s72
    s_mov_b32 s33, s73
    s_mov_b32 s34, 1024
    s_mov_b32 s35, 0x20000
    s_mul_i32 s43, s42, 57344
    s_mul_i32 s52, s41, 229376
    s_add_u32 s43, s43, s52
    s_mul_i32 s45, s40, 229376
    s_mul_i32 s52, s42, 28672
    s_add_u32 s45, s45, s52
    s_add_u32 s46, s45, 114688
    s_lshl_b32 s54, s41, 7
    s_lshl_b32 s55, s47, 6
    s_add_u32 s54, s54, s55
    v_lshrrev_b32 v4, 5, v2
    v_lshlrev_b32 v6, 3, v4
    buffer_load_dwordx2 v[24:25], v6, s[32:35], s54 offen
    buffer_load_dwordx2 v[26:27], v6, s[32:35], s54 offen offset:16
    buffer_load_dwordx2 v[28:29], v6, s[32:35], s54 offen offset:32
    buffer_load_dwordx2 v[30:31], v6, s[32:35], s54 offen offset:48
    s_add_u32 m0, s44, 0
    s_nop 0
    buffer_load_dwordx4 v8, s[4:7], s43 offen lds
    buffer_load_dwordx4 v9, s[4:7], s43 offen offset:1024 lds
    buffer_load_dwordx4 v10, s[4:7], s43 offen offset:2048 lds
    buffer_load_dwordx4 v11, s[4:7], s43 offen offset:3072 lds
    s_add_u32 s43, s43, 4096
    s_mul_i32 s52, s40, 229376
    s_lshl_b32 s53, s60, 6
    s_add_u32 s52, s52, s53
    v_sub_f32 v48, 0, v140
    v_sub_f32 v49, 0, v140
    v_mov_b32 v50, v141
    v_mov_b32 v51, v141
    v_pk_fma_f32 v[52:53], v[48:49], v[176:177], v[208:209]
    v_pk_fma_f32 v[64:65], v[50:51], v[64:65], v[52:53]
    v_max_f32 v64, 0, v64
    v_max_f32 v65, 0, v65
    v_pk_mul_f32 v[64:65], v[64:65], v[64:65]
    v_pk_fma_f32 v[54:55], v[48:49], v[178:179], v[210:211]
    v_pk_fma_f32 v[66:67], v[50:51], v[66:67], v[54:55]
    v_max_f32 v66, 0, v66
    v_max_f32 v67, 0, v67
    v_pk_mul_f32 v[66:67], v[66:67], v[66:67]
    v_pk_fma_f32 v[56:57], v[48:49], v[180:181], v[212:213]
    v_pk_fma_f32 v[68:69], v[50:51], v[68:69], v[56:57]
    v_max_f32 v68, 0, v68
    v_max_f32 v69, 0, v69
    v_pk_mul_f32 v[68:69], v[68:69], v[68:69]
    v_pk_fma_f32 v[52:53], v[48:49], v[182:183], v[214:215]
    v_pk_fma_f32 v[70:71], v[50:51], v[70:71], v[52:53]
    v_max_f32 v70, 0, v70
    v_max_f32 v71, 0, v71
    v_pk_mul_f32 v[70:71], v[70:71], v[70:71]
    v_pk_fma_f32 v[54:55], v[48:49], v[184:185], v[216:217]
    v_pk_fma_f32 v[72:73], v[50:51], v[72:73], v[54:55]
    v_max_f32 v72, 0, v72
    v_max_f32 v73, 0, v73
    v_pk_mul_f32 v[72:73], v[72:73], v[72:73]
    v_pk_fma_f32 v[56:57], v[48:49], v[186:187], v[218:219]
    v_pk_fma_f32 v[74:75], v[50:51], v[74:75], v[56:57]
    v_max_f32 v74, 0, v74
    v_max_f32 v75, 0, v75
    v_pk_mul_f32 v[74:75], v[74:75], v[74:75]
    v_pk_fma_f32 v[52:53], v[48:49], v[188:189], v[220:221]
    v_pk_fma_f32 v[76:77], v[50:51], v[76:77], v[52:53]
    v_max_f32 v76, 0, v76
    v_max_f32 v77, 0, v77
    v_pk_mul_f32 v[76:77], v[76:77], v[76:77]
    v_pk_fma_f32 v[54:55], v[48:49], v[190:191], v[222:223]
    v_pk_fma_f32 v[78:79], v[50:51], v[78:79], v[54:55]
    v_max_f32 v78, 0, v78
    v_max_f32 v79, 0, v79
    v_pk_mul_f32 v[78:79], v[78:79], v[78:79]
    v_cvt_pk_bf16_f32 v36, v64, v65
    v_cvt_pk_bf16_f32 v37, v66, v67
    v_cvt_pk_bf16_f32 v38, v68, v69
    v_cvt_pk_bf16_f32 v39, v70, v71
    s_add_u32 s54, s52, 0
    buffer_store_dwordx4 v[36:39], v14, s[36:39], s54 offen sc1
    v_cvt_pk_bf16_f32 v40, v72, v73
    v_cvt_pk_bf16_f32 v41, v74, v75
    v_cvt_pk_bf16_f32 v42, v76, v77
    v_cvt_pk_bf16_f32 v43, v78, v79
    s_add_u32 s54, s52, 0
    buffer_store_dwordx4 v[40:43], v14, s[36:39], s54 offen offset:1024 sc1
    s_add_u32 m0, s44, 4096
    s_nop 0
    buffer_load_dwordx4 v8, s[4:7], s43 offen lds
    buffer_load_dwordx4 v9, s[4:7], s43 offen offset:1024 lds
    v_sub_f32 v48, 0, v156
    v_sub_f32 v49, 0, v156
    v_mov_b32 v50, v157
    v_mov_b32 v51, v157
    v_pk_fma_f32 v[52:53], v[48:49], v[176:177], v[208:209]
    v_pk_fma_f32 v[96:97], v[50:51], v[96:97], v[52:53]
    v_max_f32 v96, 0, v96
    v_max_f32 v97, 0, v97
    v_pk_mul_f32 v[96:97], v[96:97], v[96:97]
    v_pk_fma_f32 v[54:55], v[48:49], v[178:179], v[210:211]
    v_pk_fma_f32 v[98:99], v[50:51], v[98:99], v[54:55]
    v_max_f32 v98, 0, v98
    v_max_f32 v99, 0, v99
    v_pk_mul_f32 v[98:99], v[98:99], v[98:99]
    v_pk_fma_f32 v[56:57], v[48:49], v[180:181], v[212:213]
    v_pk_fma_f32 v[100:101], v[50:51], v[100:101], v[56:57]
    v_max_f32 v100, 0, v100
    v_max_f32 v101, 0, v101
    v_pk_mul_f32 v[100:101], v[100:101], v[100:101]
    v_pk_fma_f32 v[52:53], v[48:49], v[182:183], v[214:215]
    v_pk_fma_f32 v[102:103], v[50:51], v[102:103], v[52:53]
    v_max_f32 v102, 0, v102
    v_max_f32 v103, 0, v103
    v_pk_mul_f32 v[102:103], v[102:103], v[102:103]
    v_pk_fma_f32 v[54:55], v[48:49], v[184:185], v[216:217]
    v_pk_fma_f32 v[104:105], v[50:51], v[104:105], v[54:55]
    v_max_f32 v104, 0, v104
    v_max_f32 v105, 0, v105
    v_pk_mul_f32 v[104:105], v[104:105], v[104:105]
    v_pk_fma_f32 v[56:57], v[48:49], v[186:187], v[218:219]
    v_pk_fma_f32 v[106:107], v[50:51], v[106:107], v[56:57]
    v_max_f32 v106, 0, v106
    v_max_f32 v107, 0, v107
    v_pk_mul_f32 v[106:107], v[106:107], v[106:107]
    v_pk_fma_f32 v[52:53], v[48:49], v[188:189], v[220:221]
    v_pk_fma_f32 v[108:109], v[50:51], v[108:109], v[52:53]
    v_max_f32 v108, 0, v108
    v_max_f32 v109, 0, v109
    v_pk_mul_f32 v[108:109], v[108:109], v[108:109]
    v_pk_fma_f32 v[54:55], v[48:49], v[190:191], v[222:223]
    v_pk_fma_f32 v[110:111], v[50:51], v[110:111], v[54:55]
    v_max_f32 v110, 0, v110
    v_max_f32 v111, 0, v111
    v_pk_mul_f32 v[110:111], v[110:111], v[110:111]
    v_cvt_pk_bf16_f32 v44, v96, v97
    v_cvt_pk_bf16_f32 v45, v98, v99
    v_cvt_pk_bf16_f32 v46, v100, v101
    v_cvt_pk_bf16_f32 v47, v102, v103
    s_add_u32 s54, s52, 114688
    buffer_store_dwordx4 v[44:47], v14, s[36:39], s54 offen sc1
    v_cvt_pk_bf16_f32 v36, v104, v105
    v_cvt_pk_bf16_f32 v37, v106, v107
    v_cvt_pk_bf16_f32 v38, v108, v109
    v_cvt_pk_bf16_f32 v39, v110, v111
    s_add_u32 s54, s52, 114688
    buffer_store_dwordx4 v[36:39], v14, s[36:39], s54 offen offset:1024 sc1
    s_cmp_eq_u32 s42, 3
    s_cbranch_scc1 KC_D_DONE
    v_sub_f32 v48, 0, v140
    v_sub_f32 v49, 0, v140
    v_mov_b32 v50, v141
    v_mov_b32 v51, v141
    v_pk_fma_f32 v[52:53], v[48:49], v[192:193], v[224:225]
    v_pk_fma_f32 v[80:81], v[50:51], v[80:81], v[52:53]
    v_max_f32 v80, 0, v80
    v_max_f32 v81, 0, v81
    v_pk_mul_f32 v[80:81], v[80:81], v[80:81]
    v_pk_fma_f32 v[54:55], v[48:49], v[194:195], v[226:227]
    v_pk_fma_f32 v[82:83], v[50:51], v[82:83], v[54:55]
    v_max_f32 v82, 0, v82
    v_max_f32 v83, 0, v83
    v_pk_mul_f32 v[82:83], v[82:83], v[82:83]
    v_pk_fma_f32 v[56:57], v[48:49], v[196:197], v[228:229]
    v_pk_fma_f32 v[84:85], v[50:51], v[84:85], v[56:57]
    v_max_f32 v84, 0, v84
    v_max_f32 v85, 0, v85
    v_pk_mul_f32 v[84:85], v[84:85], v[84:85]
    v_pk_fma_f32 v[52:53], v[48:49], v[198:199], v[230:231]
    v_pk_fma_f32 v[86:87], v[50:51], v[86:87], v[52:53]
    v_max_f32 v86, 0, v86
    v_max_f32 v87, 0, v87
    v_pk_mul_f32 v[86:87], v[86:87], v[86:87]
    v_pk_fma_f32 v[54:55], v[48:49], v[200:201], v[232:233]
    v_pk_fma_f32 v[88:89], v[50:51], v[88:89], v[54:55]
    v_max_f32 v88, 0, v88
    v_max_f32 v89, 0, v89
    v_pk_mul_f32 v[88:89], v[88:89], v[88:89]
    v_pk_fma_f32 v[56:57], v[48:49], v[202:203], v[234:235]
    v_pk_fma_f32 v[90:91], v[50:51], v[90:91], v[56:57]
    v_max_f32 v90, 0, v90
    v_max_f32 v91, 0, v91
    v_pk_mul_f32 v[90:91], v[90:91], v[90:91]
    v_pk_fma_f32 v[52:53], v[48:49], v[204:205], v[236:237]
    v_pk_fma_f32 v[92:93], v[50:51], v[92:93], v[52:53]
    v_max_f32 v92, 0, v92
    v_max_f32 v93, 0, v93
    v_pk_mul_f32 v[92:93], v[92:93], v[92:93]
    v_pk_fma_f32 v[54:55], v[48:49], v[206:207], v[238:239]
    v_pk_fma_f32 v[94:95], v[50:51], v[94:95], v[54:55]
    v_max_f32 v94, 0, v94
    v_max_f32 v95, 0, v95
    v_pk_mul_f32 v[94:95], v[94:95], v[94:95]
    v_cvt_pk_bf16_f32 v40, v80, v81
    v_cvt_pk_bf16_f32 v41, v82, v83
    v_cvt_pk_bf16_f32 v42, v84, v85
    v_cvt_pk_bf16_f32 v43, v86, v87
    s_add_u32 s54, s52, 0
    buffer_store_dwordx4 v[40:43], v14, s[36:39], s54 offen offset:2048 sc1
    v_cvt_pk_bf16_f32 v44, v88, v89
    v_cvt_pk_bf16_f32 v45, v90, v91
    v_cvt_pk_bf16_f32 v46, v92, v93
    v_cvt_pk_bf16_f32 v47, v94, v95
    s_add_u32 s54, s52, 0
    buffer_store_dwordx4 v[44:47], v14, s[36:39], s54 offen offset:3072 sc1
    v_sub_f32 v48, 0, v156
    v_sub_f32 v49, 0, v156
    v_mov_b32 v50, v157
    v_mov_b32 v51, v157
    v_pk_fma_f32 v[52:53], v[48:49], v[192:193], v[224:225]
    v_pk_fma_f32 v[112:113], v[50:51], v[112:113], v[52:53]
    v_max_f32 v112, 0, v112
    v_max_f32 v113, 0, v113
    v_pk_mul_f32 v[112:113], v[112:113], v[112:113]
    v_pk_fma_f32 v[54:55], v[48:49], v[194:195], v[226:227]
    v_pk_fma_f32 v[114:115], v[50:51], v[114:115], v[54:55]
    v_max_f32 v114, 0, v114
    v_max_f32 v115, 0, v115
    v_pk_mul_f32 v[114:115], v[114:115], v[114:115]
    v_pk_fma_f32 v[56:57], v[48:49], v[196:197], v[228:229]
    v_pk_fma_f32 v[116:117], v[50:51], v[116:117], v[56:57]
    v_max_f32 v116, 0, v116
    v_max_f32 v117, 0, v117
    v_pk_mul_f32 v[116:117], v[116:117], v[116:117]
    v_pk_fma_f32 v[52:53], v[48:49], v[198:199], v[230:231]
    v_pk_fma_f32 v[118:119], v[50:51], v[118:119], v[52:53]
    v_max_f32 v118, 0, v118
    v_max_f32 v119, 0, v119
    v_pk_mul_f32 v[118:119], v[118:119], v[118:119]
    v_pk_fma_f32 v[54:55], v[48:49], v[200:201], v[232:233]
    v_pk_fma_f32 v[120:121], v[50:51], v[120:121], v[54:55]
    v_max_f32 v120, 0, v120
    v_max_f32 v121, 0, v121
    v_pk_mul_f32 v[120:121], v[120:121], v[120:121]
    v_pk_fma_f32 v[56:57], v[48:49], v[202:203], v[234:235]
    v_pk_fma_f32 v[122:123], v[50:51], v[122:123], v[56:57]
    v_max_f32 v122, 0, v122
    v_max_f32 v123, 0, v123
    v_pk_mul_f32 v[122:123], v[122:123], v[122:123]
    v_pk_fma_f32 v[52:53], v[48:49], v[204:205], v[236:237]
    v_pk_fma_f32 v[124:125], v[50:51], v[124:125], v[52:53]
    v_max_f32 v124, 0, v124
    v_max_f32 v125, 0, v125
    v_pk_mul_f32 v[124:125], v[124:125], v[124:125]
    v_pk_fma_f32 v[54:55], v[48:49], v[206:207], v[238:239]
    v_pk_fma_f32 v[126:127], v[50:51], v[126:127], v[54:55]
    v_max_f32 v126, 0, v126
    v_max_f32 v127, 0, v127
    v_pk_mul_f32 v[126:127], v[126:127], v[126:127]
    v_cvt_pk_bf16_f32 v36, v112, v113
    v_cvt_pk_bf16_f32 v37, v114, v115
    v_cvt_pk_bf16_f32 v38, v116, v117
    v_cvt_pk_bf16_f32 v39, v118, v119
    s_add_u32 s54, s52, 114688
    buffer_store_dwordx4 v[36:39], v14, s[36:39], s54 offen offset:2048 sc1
    v_cvt_pk_bf16_f32 v40, v120, v121
    v_cvt_pk_bf16_f32 v41, v122, v123
    v_cvt_pk_bf16_f32 v42, v124, v125
    v_cvt_pk_bf16_f32 v43, v126, v127
    s_add_u32 s54, s52, 114688
    buffer_store_dwordx4 v[40:43], v14, s[36:39], s54 offen offset:3072 sc1
KC_D_DONE:
    buffer_load_dwordx4 v10, s[4:7], s43 offen offset:2048 lds
    buffer_load_dwordx4 v11, s[4:7], s43 offen offset:3072 lds
    s_add_u32 s43, s43, 4096
    s_add_u32 m0, s44, 8192
    s_nop 0
    buffer_load_dwordx4 v8, s[4:7], s43 offen lds
    buffer_load_dwordx4 v9, s[4:7], s43 offen offset:1024 lds
    buffer_load_dwordx4 v10, s[4:7], s43 offen offset:2048 lds
    buffer_load_dwordx4 v11, s[4:7], s43 offen offset:3072 lds
    s_add_u32 s43, s43, 4096
    s_add_u32 m0, s44, 12288
    s_nop 0
    buffer_load_dwordx4 v8, s[4:7], s43 offen lds
    buffer_load_dwordx4 v9, s[4:7], s43 offen offset:1024 lds
    buffer_load_dwordx4 v10, s[4:7], s43 offen offset:2048 lds
    buffer_load_dwordx4 v11, s[4:7], s43 offen offset:3072 lds
    s_add_u32 s43, s43, 4096
    s_add_u32 m0, s44, 16384
    s_nop 0
    buffer_load_dwordx4 v8, s[4:7], s43 offen lds
    buffer_load_dwordx4 v9, s[4:7], s43 offen offset:1024 lds
    buffer_load_dwordx4 v10, s[4:7], s43 offen offset:2048 lds
    buffer_load_dwordx4 v11, s[4:7], s43 offen offset:3072 lds
    s_add_u32 s43, s43, 4096
    s_add_u32 m0, s44, 20480
    s_nop 0
    buffer_load_dwordx4 v8, s[4:7], s43 offen lds
    buffer_load_dwordx4 v9, s[4:7], s43 offen offset:1024 lds
    buffer_load_dwordx4 v10, s[4:7], s43 offen offset:2048 lds
    buffer_load_dwordx4 v11, s[4:7], s43 offen offset:3072 lds
    s_add_u32 s43, s43, 4096
    s_waitcnt vmcnt(18) lgkmcnt(0)
    s_barrier
    s_cmp_lg_u32 s42, 0
    s_cbranch_scc1 KC_PUBD
    s_add_u32 s52, s40, 48
    s_lshl_b32 s52, s52, 7
    s_lshl_b32 s53, s41, 2
    s_add_u32 s52, s52, s53
    s_add_u32 s52, s52, 32
    v_mov_b32 v248, 1
    v_mov_b32 v250, s52
    s_mov_b64 exec, 1
    s_cmp_eq_u32 s49, 1
    s_cbranch_scc1 KC_PUBDF
    buffer_store_dword v248, v250, s[24:27], 0 offen sc1
    s_branch KC_PUBDD
KC_PUBDF:
    buffer_store_dword v248, v250, s[24:27], 0 offen
KC_PUBDD:
    s_mov_b64 exec, -1
KC_PUBD:
    s_mov_b32 s36, s76
    s_mov_b32 s37, s77
    s_mov_b32 s38, 2097152
    s_mov_b32 s39, 0x20000
    s_add_u32 s52, s40, 48
    s_lshl_b32 s52, s52, 7
    s_add_u32 s52, s52, 32
    v_and_b32 v6, 7, v2
    v_lshlrev_b32 v6, 2, v6
    v_add_u32 v250, s52, v6
    s_cmp_lg_u32 s42, 0
    s_cbranch_scc1 KC_PL2
    buffer_load_dword v249, v250, s[24:27], 0 offen sc1
KC_PL2:
    s_cmp_lg_u32 s42, 0
    s_cbranch_scc1 KC_CK2
    s_waitcnt vmcnt(0)
    v_cmp_gt_u32 vcc, 1, v249
    s_nop 0
    s_cbranch_vccnz KC_SP2
KC_SP2_R:
KC_CK2:
    s_barrier
    s_add_u32 s56, s45, 0
    buffer_load_dwordx4 a[0:3], v14, s[8:11], s56 offen sc1
    v_lshlrev_b32 v192, 16, v240
    v_and_b32 v193, 0xffff0000, v240
    v_lshlrev_b32 v32, 16, v24
    v_and_b32 v33, 0xffff0000, v24
    v_pk_add_f32 v[192:193], v[192:193], v[32:33]
    s_add_u32 s57, s46, 0
    buffer_load_dwordx4 a[4:7], v14, s[8:11], s57 offen sc1
    v_lshlrev_b32 v194, 16, v241
    v_and_b32 v195, 0xffff0000, v241
    v_lshlrev_b32 v32, 16, v25
    v_and_b32 v33, 0xffff0000, v25
    v_pk_add_f32 v[194:195], v[194:195], v[32:33]
    buffer_load_dwordx4 a[8:11], v14, s[8:11], s56 offen offset:1024 sc1
    v_lshlrev_b32 v196, 16, v242
    v_and_b32 v197, 0xffff0000, v242
    v_lshlrev_b32 v32, 16, v26
    v_and_b32 v33, 0xffff0000, v26
    v_pk_add_f32 v[196:197], v[196:197], v[32:33]
    buffer_load_dwordx4 a[12:15], v14, s[8:11], s57 offen offset:1024 sc1
    v_lshlrev_b32 v198, 16, v243
    v_and_b32 v199, 0xffff0000, v243
    v_lshlrev_b32 v32, 16, v27
    v_and_b32 v33, 0xffff0000, v27
    v_pk_add_f32 v[198:199], v[198:199], v[32:33]
    s_add_u32 s56, s45, 0
    buffer_load_dwordx4 a[16:19], v14, s[8:11], s56 offen offset:2048 sc1
    v_lshlrev_b32 v200, 16, v244
    v_and_b32 v201, 0xffff0000, v244
    v_lshlrev_b32 v32, 16, v28
    v_and_b32 v33, 0xffff0000, v28
    v_pk_add_f32 v[200:201], v[200:201], v[32:33]
    s_add_u32 s57, s46, 0
    buffer_load_dwordx4 a[20:23], v14, s[8:11], s57 offen offset:2048 sc1
    v_lshlrev_b32 v202, 16, v245
    v_and_b32 v203, 0xffff0000, v245
    v_lshlrev_b32 v32, 16, v29
    v_and_b32 v33, 0xffff0000, v29
    v_pk_add_f32 v[202:203], v[202:203], v[32:33]
    buffer_load_dwordx4 a[24:27], v14, s[8:11], s56 offen offset:3072 sc1
    v_lshlrev_b32 v204, 16, v246
    v_and_b32 v205, 0xffff0000, v246
    v_lshlrev_b32 v32, 16, v30
    v_and_b32 v33, 0xffff0000, v30
    v_pk_add_f32 v[204:205], v[204:205], v[32:33]
    buffer_load_dwordx4 a[28:31], v14, s[8:11], s57 offen offset:3072 sc1
    v_lshlrev_b32 v206, 16, v247
    v_and_b32 v207, 0xffff0000, v247
    v_lshlrev_b32 v32, 16, v31
    v_and_b32 v33, 0xffff0000, v31
    v_pk_add_f32 v[206:207], v[206:207], v[32:33]
    s_add_u32 s56, s45, 4096
    buffer_load_dwordx4 a[32:35], v14, s[8:11], s56 offen sc1
    s_cmp_eq_u32 s42, 0
    s_cselect_b64 vcc, -1, 0
    v_cndmask_b32 v128, 0, v192, vcc
    v_cndmask_b32 v129, 0, v193, vcc
    v_cndmask_b32 v130, 0, v194, vcc
    s_add_u32 s57, s46, 4096
    buffer_load_dwordx4 a[36:39], v14, s[8:11], s57 offen sc1
    v_cndmask_b32 v131, 0, v195, vcc
    v_cndmask_b32 v132, 0, v196, vcc
    v_cndmask_b32 v133, 0, v197, vcc
    v_cndmask_b32 v134, 0, v198, vcc
    v_cndmask_b32 v135, 0, v199, vcc
    buffer_load_dwordx4 a[40:43], v14, s[8:11], s56 offen offset:1024 sc1
    v_cndmask_b32 v136, 0, v200, vcc
    v_cndmask_b32 v137, 0, v201, vcc
    v_cndmask_b32 v138, 0, v202, vcc
    v_cndmask_b32 v139, 0, v203, vcc
    v_cndmask_b32 v140, 0, v204, vcc
    buffer_load_dwordx4 a[44:47], v14, s[8:11], s57 offen offset:1024 sc1
    v_cndmask_b32 v141, 0, v205, vcc
    v_cndmask_b32 v142, 0, v206, vcc
    v_cndmask_b32 v143, 0, v207, vcc
    s_cmp_eq_u32 s42, 1
    s_cselect_b64 vcc, -1, 0
    s_add_u32 s56, s45, 4096
    buffer_load_dwordx4 a[48:51], v14, s[8:11], s56 offen offset:2048 sc1
    v_cndmask_b32 v144, 0, v192, vcc
    v_cndmask_b32 v145, 0, v193, vcc
    v_cndmask_b32 v146, 0, v194, vcc
    v_cndmask_b32 v147, 0, v195, vcc
    v_cndmask_b32 v148, 0, v196, vcc
    s_add_u32 s57, s46, 4096
    buffer_load_dwordx4 a[52:55], v14, s[8:11], s57 offen offset:2048 sc1
    v_cndmask_b32 v149, 0, v197, vcc
    v_cndmask_b32 v150, 0, v198, vcc
    v_cndmask_b32 v151, 0, v199, vcc
    v_cndmask_b32 v152, 0, v200, vcc
    v_cndmask_b32 v153, 0, v201, vcc
    buffer_load_dwordx4 a[56:59], v14, s[8:11], s56 offen offset:3072 sc1
    v_cndmask_b32 v154, 0, v202, vcc
    v_cndmask_b32 v155, 0, v203, vcc
    v_cndmask_b32 v156, 0, v204, vcc
    v_cndmask_b32 v157, 0, v205, vcc
    v_cndmask_b32 v158, 0, v206, vcc
    buffer_load_dwordx4 a[60:63], v14, s[8:11], s57 offen offset:3072 sc1
    v_cndmask_b32 v159, 0, v207, vcc
    s_cmp_eq_u32 s42, 2
    s_cselect_b64 vcc, -1, 0
    v_cndmask_b32 v160, 0, v192, vcc
    v_cndmask_b32 v161, 0, v193, vcc
    s_add_u32 s56, s45, 8192
    buffer_load_dwordx4 a[64:67], v14, s[8:11], s56 offen sc1
    v_cndmask_b32 v162, 0, v194, vcc
    v_cndmask_b32 v163, 0, v195, vcc
    v_cndmask_b32 v164, 0, v196, vcc
    v_cndmask_b32 v165, 0, v197, vcc
    v_cndmask_b32 v166, 0, v198, vcc
    s_add_u32 s57, s46, 8192
    buffer_load_dwordx4 a[68:71], v14, s[8:11], s57 offen sc1
    v_cndmask_b32 v167, 0, v199, vcc
    v_cndmask_b32 v168, 0, v200, vcc
    v_cndmask_b32 v169, 0, v201, vcc
    v_cndmask_b32 v170, 0, v202, vcc
    v_cndmask_b32 v171, 0, v203, vcc
    buffer_load_dwordx4 a[72:75], v14, s[8:11], s56 offen offset:1024 sc1
    v_cndmask_b32 v172, 0, v204, vcc
    v_cndmask_b32 v173, 0, v205, vcc
    v_cndmask_b32 v174, 0, v206, vcc
    v_cndmask_b32 v175, 0, v207, vcc
    buffer_load_dwordx4 a[76:79], v14, s[8:11], s57 offen offset:1024 sc1
    s_cmp_eq_u32 s42, 3
    s_cselect_b64 vcc, -1, 0
    v_cndmask_b32 v176, 0, v192, vcc
    v_cndmask_b32 v177, 0, v193, vcc
    v_cndmask_b32 v178, 0, v194, vcc
    s_add_u32 s56, s45, 8192
    buffer_load_dwordx4 a[80:83], v14, s[8:11], s56 offen offset:2048 sc1
    v_cndmask_b32 v179, 0, v195, vcc
    v_cndmask_b32 v180, 0, v196, vcc
    v_cndmask_b32 v181, 0, v197, vcc
    v_cndmask_b32 v182, 0, v198, vcc
    v_cndmask_b32 v183, 0, v199, vcc
    s_add_u32 s57, s46, 8192
    buffer_load_dwordx4 a[84:87], v14, s[8:11], s57 offen offset:2048 sc1
    v_cndmask_b32 v184, 0, v200, vcc
    v_cndmask_b32 v185, 0, v201, vcc
    v_cndmask_b32 v186, 0, v202, vcc
    v_cndmask_b32 v187, 0, v203, vcc
    v_cndmask_b32 v188, 0, v204, vcc
    buffer_load_dwordx4 a[88:91], v14, s[8:11], s56 offen offset:3072 sc1
    v_cndmask_b32 v189, 0, v205, vcc
    v_cndmask_b32 v190, 0, v206, vcc
    v_cndmask_b32 v191, 0, v207, vcc
    buffer_load_dwordx4 a[92:95], v14, s[8:11], s57 offen offset:3072 sc1
    s_waitcnt vmcnt(48)
    ds_read_b64_tr_b16 v[48:49], v12 offset:0
    ds_read_b64_tr_b16 v[50:51], v12 offset:1024
    ds_read_b64_tr_b16 v[52:53], v13 offset:0
    ds_read_b64_tr_b16 v[54:55], v13 offset:1024
    s_waitcnt vmcnt(23) lgkmcnt(2)
    v_mfma_f32_32x32x16_bf16 v[64:79], v[48:51], a[0:3], v[128:143]
    ds_read_b64_tr_b16 v[56:57], v12 offset:2048
    ds_read_b64_tr_b16 v[58:59], v12 offset:3072
    s_add_u32 m0, s44, 24576
    s_nop 0
    buffer_load_dwordx4 v8, s[4:7], s43 offen lds
    s_waitcnt lgkmcnt(2)
    v_mfma_f32_32x32x16_bf16 v[80:95], v[52:55], a[0:3], v[144:159]
    ds_read_b64_tr_b16 v[60:61], v13 offset:2048
    ds_read_b64_tr_b16 v[62:63], v13 offset:3072
    buffer_load_dwordx4 v9, s[4:7], s43 offen offset:1024 lds
    s_waitcnt vmcnt(24)
    v_mfma_f32_32x32x16_bf16 v[96:111], v[48:51], a[4:7], v[160:175]
    buffer_load_dwordx4 v10, s[4:7], s43 offen offset:2048 lds
    v_mfma_f32_32x32x16_bf16 v[112:127], v[52:55], a[4:7], v[176:191]
    buffer_load_dwordx4 v11, s[4:7], s43 offen offset:3072 lds
    s_add_u32 s43, s43, 4096
    s_waitcnt vmcnt(25) lgkmcnt(2)
    v_mfma_f32_32x32x16_bf16 v[64:79], v[56:59], a[8:11], v[64:79]
    s_waitcnt vmcnt(44)
    ds_read_b64_tr_b16 v[48:49], v12 offset:4096
    ds_read_b64_tr_b16 v[50:51], v12 offset:5120
    s_add_u32 s56, s45, 12288
    buffer_load_dwordx4 a[96:99], v14, s[8:11], s56 offen sc1
    s_waitcnt lgkmcnt(2)
    v_mfma_f32_32x32x16_bf16 v[80:95], v[60:63], a[8:11], v[80:95]
    ds_read_b64_tr_b16 v[52:53], v13 offset:4096
    ds_read_b64_tr_b16 v[54:55], v13 offset:5120
    s_add_u32 s57, s46, 12288
    buffer_load_dwordx4 a[100:103], v14, s[8:11], s57 offen sc1
    s_waitcnt vmcnt(26)
    v_mfma_f32_32x32x16_bf16 v[96:111], v[56:59], a[12:15], v[96:111]
    buffer_load_dwordx4 a[104:107], v14, s[8:11], s56 offen offset:1024 sc1
    v_mfma_f32_32x32x16_bf16 v[112:127], v[60:63], a[12:15], v[112:127]
    buffer_load_dwordx4 a[108:111], v14, s[8:11], s57 offen offset:1024 sc1
    s_waitcnt vmcnt(27) lgkmcnt(2)
    v_mfma_f32_32x32x16_bf16 v[64:79], v[48:51], a[16:19], v[64:79]
    ds_read_b64_tr_b16 v[56:57], v12 offset:6144
    ds_read_b64_tr_b16 v[58:59], v12 offset:7168
    s_add_u32 m0, s44, 28672
    s_nop 0
    buffer_load_dwordx4 v8, s[4:7], s43 offen lds
    s_waitcnt lgkmcnt(2)
    v_mfma_f32_32x32x16_bf16 v[80:95], v[52:55], a[16:19], v[80:95]
    ds_read_b64_tr_b16 v[60:61], v13 offset:6144
    ds_read_b64_tr_b16 v[62:63], v13 offset:7168
    buffer_load_dwordx4 v9, s[4:7], s43 offen offset:1024 lds
    s_waitcnt vmcnt(28)
    v_mfma_f32_32x32x16_bf16 v[96:111], v[48:51], a[20:23], v[96:111]
    buffer_load_dwordx4 v10, s[4:7], s43 offen offset:2048 lds
    v_mfma_f32_32x32x16_bf16 v[112:127], v[52:55], a[20:23], v[112:127]
    buffer_load_dwordx4 v11, s[4:7], s43 offen offset:3072 lds
    s_add_u32 s43, s43, 4096
    s_waitcnt vmcnt(29) lgkmcnt(2)
    v_mfma_f32_32x32x16_bf16 v[64:79], v[56:59], a[24:27], v[64:79]
    s_waitcnt vmcnt(48)
    ds_read_b64_tr_b16 v[48:49], v12 offset:8192
    ds_read_b64_tr_b16 v[50:51], v12 offset:9216
    s_add_u32 s56, s45, 12288
    buffer_load_dwordx4 a[112:115], v14, s[8:11], s56 offen offset:2048 sc1
    s_waitcnt lgkmcnt(2)
    v_mfma_f32_32x32x16_bf16 v[80:95], v[60:63], a[24:27], v[80:95]
    ds_read_b64_tr_b16 v[52:53], v13 offset:8192
    ds_read_b64_tr_b16 v[54:55], v13 offset:9216
    s_add_u32 s57, s46, 12288
    buffer_load_dwordx4 a[116:119], v14, s[8:11], s57 offen offset:2048 sc1
    s_waitcnt vmcnt(30)
    v_mfma_f32_32x32x16_bf16 v[96:111], v[56:59], a[28:31], v[96:111]
    buffer_load_dwordx4 a[120:123], v14, s[8:11], s56 offen offset:3072 sc1
    v_mfma_f32_32x32x16_bf16 v[112:127], v[60:63], a[28:31], v[112:127]
    buffer_load_dwordx4 a[124:127], v14, s[8:11], s57 offen offset:3072 sc1
    s_waitcnt vmcnt(31) lgkmcnt(2)
    v_mfma_f32_32x32x16_bf16 v[64:79], v[48:51], a[32:35], v[64:79]
    ds_read_b64_tr_b16 v[56:57], v12 offset:10240
    ds_read_b64_tr_b16 v[58:59], v12 offset:11264
    s_add_u32 m0, s44, 32768
    s_nop 0
    buffer_load_dwordx4 v8, s[4:7], s43 offen lds
    s_waitcnt lgkmcnt(2)
    v_mfma_f32_32x32x16_bf16 v[80:95], v[52:55], a[32:35], v[80:95]
    ds_read_b64_tr_b16 v[60:61], v13 offset:10240
    ds_read_b64_tr_b16 v[62:63], v13 offset:11264
    buffer_load_dwordx4 v9, s[4:7], s43 offen offset:1024 lds
    s_waitcnt vmcnt(32)
    v_mfma_f32_32x32x16_bf16 v[96:111], v[48:51], a[36:39], v[96:111]
    buffer_load_dwordx4 v10, s[4:7], s43 offen offset:2048 lds
    v_mfma_f32_32x32x16_bf16 v[112:127], v[52:55], a[36:39], v[112:127]
    buffer_load_dwordx4 v11, s[4:7], s43 offen offset:3072 lds
    s_add_u32 s43, s43, 4096
    s_waitcnt vmcnt(33) lgkmcnt(2)
    v_mfma_f32_32x32x16_bf16 v[64:79], v[56:59], a[40:43], v[64:79]
    s_waitcnt vmcnt(52)
    ds_read_b64_tr_b16 v[48:49], v12 offset:12288
    ds_read_b64_tr_b16 v[50:51], v12 offset:13312
    s_add_u32 s56, s45, 16384
    buffer_load_dwordx4 a[0:3], v14, s[8:11], s56 offen sc1
    s_waitcnt lgkmcnt(2)
    v_mfma_f32_32x32x16_bf16 v[80:95], v[60:63], a[40:43], v[80:95]
    ds_read_b64_tr_b16 v[52:53], v13 offset:12288
    ds_read_b64_tr_b16 v[54:55], v13 offset:13312
    s_add_u32 s57, s46, 16384
    buffer_load_dwordx4 a[4:7], v14, s[8:11], s57 offen sc1
    s_waitcnt vmcnt(34)
    v_mfma_f32_32x32x16_bf16 v[96:111], v[56:59], a[44:47], v[96:111]
    buffer_load_dwordx4 a[8:11], v14, s[8:11], s56 offen offset:1024 sc1
    v_mfma_f32_32x32x16_bf16 v[112:127], v[60:63], a[44:47], v[112:127]
    buffer_load_dwordx4 a[12:15], v14, s[8:11], s57 offen offset:1024 sc1
    s_waitcnt vmcnt(35) lgkmcnt(2)
    v_mfma_f32_32x32x16_bf16 v[64:79], v[48:51], a[48:51], v[64:79]
    ds_read_b64_tr_b16 v[56:57], v12 offset:14336
    ds_read_b64_tr_b16 v[58:59], v12 offset:15360
    s_add_u32 m0, s44, 36864
    s_nop 0
    buffer_load_dwordx4 v8, s[4:7], s43 offen lds
    s_waitcnt lgkmcnt(2)
    v_mfma_f32_32x32x16_bf16 v[80:95], v[52:55], a[48:51], v[80:95]
    ds_read_b64_tr_b16 v[60:61], v13 offset:14336
    ds_read_b64_tr_b16 v[62:63], v13 offset:15360
    buffer_load_dwordx4 v9, s[4:7], s43 offen offset:1024 lds
    s_waitcnt vmcnt(36)
    v_mfma_f32_32x32x16_bf16 v[96:111], v[48:51], a[52:55], v[96:111]
    buffer_load_dwordx4 v10, s[4:7], s43 offen offset:2048 lds
    v_mfma_f32_32x32x16_bf16 v[112:127], v[52:55], a[52:55], v[112:127]
    buffer_load_dwordx4 v11, s[4:7], s43 offen offset:3072 lds
    s_add_u32 s43, s43, 4096
    s_waitcnt vmcnt(37) lgkmcnt(2)
    v_mfma_f32_32x32x16_bf16 v[64:79], v[56:59], a[56:59], v[64:79]
    s_waitcnt vmcnt(56)
    ds_read_b64_tr_b16 v[48:49], v12 offset:16384
    ds_read_b64_tr_b16 v[50:51], v12 offset:17408
    s_add_u32 s56, s45, 16384
    buffer_load_dwordx4 a[16:19], v14, s[8:11], s56 offen offset:2048 sc1
    s_waitcnt lgkmcnt(2)
    v_mfma_f32_32x32x16_bf16 v[80:95], v[60:63], a[56:59], v[80:95]
    ds_read_b64_tr_b16 v[52:53], v13 offset:16384
    ds_read_b64_tr_b16 v[54:55], v13 offset:17408
    s_add_u32 s57, s46, 16384
    buffer_load_dwordx4 a[20:23], v14, s[8:11], s57 offen offset:2048 sc1
    s_waitcnt vmcnt(38)
    v_mfma_f32_32x32x16_bf16 v[96:111], v[56:59], a[60:63], v[96:111]
    buffer_load_dwordx4 a[24:27], v14, s[8:11], s56 offen offset:3072 sc1
    v_mfma_f32_32x32x16_bf16 v[112:127], v[60:63], a[60:63], v[112:127]
    buffer_load_dwordx4 a[28:31], v14, s[8:11], s57 offen offset:3072 sc1
    s_waitcnt vmcnt(39) lgkmcnt(2)
    v_mfma_f32_32x32x16_bf16 v[64:79], v[48:51], a[64:67], v[64:79]
    ds_read_b64_tr_b16 v[56:57], v12 offset:18432
    ds_read_b64_tr_b16 v[58:59], v12 offset:19456
    s_add_u32 m0, s44, 0
    s_nop 0
    buffer_load_dwordx4 v8, s[4:7], s43 offen lds
    s_waitcnt lgkmcnt(2)
    v_mfma_f32_32x32x16_bf16 v[80:95], v[52:55], a[64:67], v[80:95]
    ds_read_b64_tr_b16 v[60:61], v13 offset:18432
    ds_read_b64_tr_b16 v[62:63], v13 offset:19456
    buffer_load_dwordx4 v9, s[4:7], s43 offen offset:1024 lds
    s_waitcnt vmcnt(40)
    v_mfma_f32_32x32x16_bf16 v[96:111], v[48:51], a[68:71], v[96:111]
    buffer_load_dwordx4 v10, s[4:7], s43 offen offset:2048 lds
    v_mfma_f32_32x32x16_bf16 v[112:127], v[52:55], a[68:71], v[112:127]
    buffer_load_dwordx4 v11, s[4:7], s43 offen offset:3072 lds
    s_add_u32 s43, s43, 4096
    s_waitcnt vmcnt(41) lgkmcnt(2)
    v_mfma_f32_32x32x16_bf16 v[64:79], v[56:59], a[72:75], v[64:79]
    s_waitcnt vmcnt(60)
    ds_read_b64_tr_b16 v[48:49], v12 offset:20480
    ds_read_b64_tr_b16 v[50:51], v12 offset:21504
    s_add_u32 s56, s45, 20480
    buffer_load_dwordx4 a[32:35], v14, s[8:11], s56 offen sc1
    s_waitcnt lgkmcnt(2)
    v_mfma_f32_32x32x16_bf16 v[80:95], v[60:63], a[72:75], v[80:95]
    ds_read_b64_tr_b16 v[52:53], v13 offset:20480
    ds_read_b64_tr_b16 v[54:55], v13 offset:21504
    s_add_u32 s57, s46, 20480
    buffer_load_dwordx4 a[36:39], v14, s[8:11], s57 offen sc1
    s_waitcnt vmcnt(42)
    v_mfma_f32_32x32x16_bf16 v[96:111], v[56:59], a[76:79], v[96:111]
    buffer_load_dwordx4 a[40:43], v14, s[8:11], s56 offen offset:1024 sc1
    v_mfma_f32_32x32x16_bf16 v[112:127], v[60:63], a[76:79], v[112:127]
    buffer_load_dwordx4 a[44:47], v14, s[8:11], s57 offen offset:1024 sc1
    s_waitcnt vmcnt(43) lgkmcnt(2)
    v_mfma_f32_32x32x16_bf16 v[64:79], v[48:51], a[80:83], v[64:79]
    ds_read_b64_tr_b16 v[56:57], v12 offset:22528
    ds_read_b64_tr_b16 v[58:59], v12 offset:23552
    s_add_u32 m0, s44, 4096
    s_nop 0
    buffer_load_dwordx4 v8, s[4:7], s43 offen lds
    s_waitcnt lgkmcnt(2)
    v_mfma_f32_32x32x16_bf16 v[80:95], v[52:55], a[80:83], v[80:95]
    ds_read_b64_tr_b16 v[60:61], v13 offset:22528
    ds_read_b64_tr_b16 v[62:63], v13 offset:23552
    buffer_load_dwordx4 v9, s[4:7], s43 offen offset:1024 lds
    s_waitcnt vmcnt(44)
    v_mfma_f32_32x32x16_bf16 v[96:111], v[48:51], a[84:87], v[96:111]
    buffer_load_dwordx4 v10, s[4:7], s43 offen offset:2048 lds
    v_mfma_f32_32x32x16_bf16 v[112:127], v[52:55], a[84:87], v[112:127]
    buffer_load_dwordx4 v11, s[4:7], s43 offen offset:3072 lds
    s_add_u32 s43, s43, 4096
    s_waitcnt vmcnt(45) lgkmcnt(2)
    v_mfma_f32_32x32x16_bf16 v[64:79], v[56:59], a[88:91], v[64:79]
    s_waitcnt vmcnt(40)
    ds_read_b64_tr_b16 v[48:49], v12 offset:24576
    ds_read_b64_tr_b16 v[50:51], v12 offset:25600
    s_add_u32 s56, s45, 20480
    buffer_load_dwordx4 a[48:51], v14, s[8:11], s56 offen offset:2048 sc1
    s_waitcnt lgkmcnt(2)
    v_mfma_f32_32x32x16_bf16 v[80:95], v[60:63], a[88:91], v[80:95]
    ds_read_b64_tr_b16 v[52:53], v13 offset:24576
    ds_read_b64_tr_b16 v[54:55], v13 offset:25600
    s_add_u32 s57, s46, 20480
    buffer_load_dwordx4 a[52:55], v14, s[8:11], s57 offen offset:2048 sc1
    v_mfma_f32_32x32x16_bf16 v[96:111], v[56:59], a[92:95], v[96:111]
    buffer_load_dwordx4 a[56:59], v14, s[8:11], s56 offen offset:3072 sc1
    v_mfma_f32_32x32x16_bf16 v[112:127], v[60:63], a[92:95], v[112:127]
    buffer_load_dwordx4 a[60:63], v14, s[8:11], s57 offen offset:3072 sc1
    s_waitcnt vmcnt(43) lgkmcnt(2)
    v_mfma_f32_32x32x16_bf16 v[64:79], v[48:51], a[96:99], v[64:79]
    ds_read_b64_tr_b16 v[56:57], v12 offset:26624
    ds_read_b64_tr_b16 v[58:59], v12 offset:27648
    s_add_u32 m0, s44, 8192
    s_nop 0
    buffer_load_dwordx4 v8, s[4:7], s43 offen lds
    s_waitcnt lgkmcnt(2)
    v_mfma_f32_32x32x16_bf16 v[80:95], v[52:55], a[96:99], v[80:95]
    ds_read_b64_tr_b16 v[60:61], v13 offset:26624
    ds_read_b64_tr_b16 v[62:63], v13 offset:27648
    buffer_load_dwordx4 v9, s[4:7], s43 offen offset:1024 lds
    s_waitcnt vmcnt(44)
    v_mfma_f32_32x32x16_bf16 v[96:111], v[48:51], a[100:103], v[96:111]
    buffer_load_dwordx4 v10, s[4:7], s43 offen offset:2048 lds
    v_mfma_f32_32x32x16_bf16 v[112:127], v[52:55], a[100:103], v[112:127]
    buffer_load_dwordx4 v11, s[4:7], s43 offen offset:3072 lds
    s_add_u32 s43, s43, 4096
    s_waitcnt vmcnt(45) lgkmcnt(2)
    v_mfma_f32_32x32x16_bf16 v[64:79], v[56:59], a[104:107], v[64:79]
    s_waitcnt vmcnt(40)
    ds_read_b64_tr_b16 v[48:49], v12 offset:28672
    ds_read_b64_tr_b16 v[50:51], v12 offset:29696
    s_add_u32 s56, s45, 24576
    buffer_load_dwordx4 a[64:67], v14, s[8:11], s56 offen sc1
    s_waitcnt lgkmcnt(2)
    v_mfma_f32_32x32x16_bf16 v[80:95], v[60:63], a[104:107], v[80:95]
    ds_read_b64_tr_b16 v[52:53], v13 offset:28672
    ds_read_b64_tr_b16 v[54:55], v13 offset:29696
    s_add_u32 s57, s46, 24576
    buffer_load_dwordx4 a[68:71], v14, s[8:11], s57 offen sc1
    v_mfma_f32_32x32x16_bf16 v[96:111], v[56:59], a[108:111], v[96:111]
    buffer_load_dwordx4 a[72:75], v14, s[8:11], s56 offen offset:1024 sc1
    v_mfma_f32_32x32x16_bf16 v[112:127], v[60:63], a[108:111], v[112:127]
    buffer_load_dwordx4 a[76:79], v14, s[8:11], s57 offen offset:1024 sc1
    s_waitcnt vmcnt(43) lgkmcnt(2)
    v_mfma_f32_32x32x16_bf16 v[64:79], v[48:51], a[112:115], v[64:79]
    ds_read_b64_tr_b16 v[56:57], v12 offset:30720
    ds_read_b64_tr_b16 v[58:59], v12 offset:31744
    s_add_u32 m0, s44, 12288
    s_nop 0
    buffer_load_dwordx4 v8, s[4:7], s43 offen lds
    s_waitcnt lgkmcnt(2)
    v_mfma_f32_32x32x16_bf16 v[80:95], v[52:55], a[112:115], v[80:95]
    ds_read_b64_tr_b16 v[60:61], v13 offset:30720
    ds_read_b64_tr_b16 v[62:63], v13 offset:31744
    buffer_load_dwordx4 v9, s[4:7], s43 offen offset:1024 lds
    s_waitcnt vmcnt(44)
    v_mfma_f32_32x32x16_bf16 v[96:111], v[48:51], a[116:119], v[96:111]
    buffer_load_dwordx4 v10, s[4:7], s43 offen offset:2048 lds
    v_mfma_f32_32x32x16_bf16 v[112:127], v[52:55], a[116:119], v[112:127]
    buffer_load_dwordx4 v11, s[4:7], s43 offen offset:3072 lds
    s_add_u32 s43, s43, 4096
    s_waitcnt vmcnt(45) lgkmcnt(2)
    v_mfma_f32_32x32x16_bf16 v[64:79], v[56:59], a[120:123], v[64:79]
    s_waitcnt vmcnt(40)
    ds_read_b64_tr_b16 v[48:49], v12 offset:32768
    ds_read_b64_tr_b16 v[50:51], v12 offset:33792
    s_add_u32 s56, s45, 24576
    buffer_load_dwordx4 a[80:83], v14, s[8:11], s56 offen offset:2048 sc1
    s_waitcnt lgkmcnt(2)
    v_mfma_f32_32x32x16_bf16 v[80:95], v[60:63], a[120:123], v[80:95]
    ds_read_b64_tr_b16 v[52:53], v13 offset:32768
    ds_read_b64_tr_b16 v[54:55], v13 offset:33792
    s_add_u32 s57, s46, 24576
    buffer_load_dwordx4 a[84:87], v14, s[8:11], s57 offen offset:2048 sc1
    v_mfma_f32_32x32x16_bf16 v[96:111], v[56:59], a[124:127], v[96:111]
    buffer_load_dwordx4 a[88:91], v14, s[8:11], s56 offen offset:3072 sc1
    v_mfma_f32_32x32x16_bf16 v[112:127], v[60:63], a[124:127], v[112:127]
    buffer_load_dwordx4 a[92:95], v14, s[8:11], s57 offen offset:3072 sc1
    s_waitcnt vmcnt(43) lgkmcnt(2)
    v_mfma_f32_32x32x16_bf16 v[64:79], v[48:51], a[0:3], v[64:79]
    ds_read_b64_tr_b16 v[56:57], v12 offset:34816
    ds_read_b64_tr_b16 v[58:59], v12 offset:35840
    s_waitcnt lgkmcnt(2)
    v_mfma_f32_32x32x16_bf16 v[80:95], v[52:55], a[0:3], v[80:95]
    ds_read_b64_tr_b16 v[60:61], v13 offset:34816
    ds_read_b64_tr_b16 v[62:63], v13 offset:35840
    s_waitcnt vmcnt(42)
    v_mfma_f32_32x32x16_bf16 v[96:111], v[48:51], a[4:7], v[96:111]
    v_mfma_f32_32x32x16_bf16 v[112:127], v[52:55], a[4:7], v[112:127]
    s_waitcnt vmcnt(41) lgkmcnt(2)
    v_mfma_f32_32x32x16_bf16 v[64:79], v[56:59], a[8:11], v[64:79]
    s_waitcnt vmcnt(36)
    ds_read_b64_tr_b16 v[48:49], v12 offset:36864
    ds_read_b64_tr_b16 v[50:51], v12 offset:37888
    s_waitcnt lgkmcnt(2)
    v_mfma_f32_32x32x16_bf16 v[80:95], v[60:63], a[8:11], v[80:95]
    ds_read_b64_tr_b16 v[52:53], v13 offset:36864
    ds_read_b64_tr_b16 v[54:55], v13 offset:37888
    v_mfma_f32_32x32x16_bf16 v[96:111], v[56:59], a[12:15], v[96:111]
    v_mfma_f32_32x32x16_bf16 v[112:127], v[60:63], a[12:15], v[112:127]
    s_waitcnt vmcnt(35) lgkmcnt(2)
    v_mfma_f32_32x32x16_bf16 v[64:79], v[48:51], a[16:19], v[64:79]
    ds_read_b64_tr_b16 v[56:57], v12 offset:38912
    ds_read_b64_tr_b16 v[58:59], v12 offset:39936
    s_waitcnt lgkmcnt(2)
    v_mfma_f32_32x32x16_bf16 v[80:95], v[52:55], a[16:19], v[80:95]
    ds_read_b64_tr_b16 v[60:61], v13 offset:38912
    ds_read_b64_tr_b16 v[62:63], v13 offset:39936
    s_waitcnt vmcnt(34)
    v_mfma_f32_32x32x16_bf16 v[96:111], v[48:51], a[20:23], v[96:111]
    v_mfma_f32_32x32x16_bf16 v[112:127], v[52:55], a[20:23], v[112:127]
    s_waitcnt vmcnt(33) lgkmcnt(2)
    v_mfma_f32_32x32x16_bf16 v[64:79], v[56:59], a[24:27], v[64:79]
    s_waitcnt vmcnt(28)
    ds_read_b64_tr_b16 v[48:49], v12 offset:0
    ds_read_b64_tr_b16 v[50:51], v12 offset:1024
    s_waitcnt lgkmcnt(2)
    v_mfma_f32_32x32x16_bf16 v[80:95], v[60:63], a[24:27], v[80:95]
    ds_read_b64_tr_b16 v[52:53], v13 offset:0
    ds_read_b64_tr_b16 v[54:55], v13 offset:1024
    v_mfma_f32_32x32x16_bf16 v[96:111], v[56:59], a[28:31], v[96:111]
    v_mfma_f32_32x32x16_bf16 v[112:127], v[60:63], a[28:31], v[112:127]
    s_waitcnt vmcnt(27) lgkmcnt(2)
    v_mfma_f32_32x32x16_bf16 v[64:79], v[48:51], a[32:35], v[64:79]
    ds_read_b64_tr_b16 v[56:57], v12 offset:2048
    ds_read_b64_tr_b16 v[58:59], v12 offset:3072
    s_waitcnt lgkmcnt(2)
    v_mfma_f32_32x32x16_bf16 v[80:95], v[52:55], a[32:35], v[80:95]
    ds_read_b64_tr_b16 v[60:61], v13 offset:2048
    ds_read_b64_tr_b16 v[62:63], v13 offset:3072
    s_waitcnt vmcnt(26)
    v_mfma_f32_32x32x16_bf16 v[96:111], v[48:51], a[36:39], v[96:111]
    v_mfma_f32_32x32x16_bf16 v[112:127], v[52:55], a[36:39], v[112:127]
    s_waitcnt vmcnt(25) lgkmcnt(2)
    v_mfma_f32_32x32x16_bf16 v[64:79], v[56:59], a[40:43], v[64:79]
    s_waitcnt vmcnt(20)
    ds_read_b64_tr_b16 v[48:49], v12 offset:4096
    ds_read_b64_tr_b16 v[50:51], v12 offset:5120
    s_waitcnt lgkmcnt(2)
    v_mfma_f32_32x32x16_bf16 v[80:95], v[60:63], a[40:43], v[80:95]
    ds_read_b64_tr_b16 v[52:53], v13 offset:4096
    ds_read_b64_tr_b16 v[54:55], v13 offset:5120
    v_mfma_f32_32x32x16_bf16 v[96:111], v[56:59], a[44:47], v[96:111]
    v_mfma_f32_32x32x16_bf16 v[112:127], v[60:63], a[44:47], v[112:127]
    s_waitcnt vmcnt(19) lgkmcnt(2)
    v_mfma_f32_32x32x16_bf16 v[64:79], v[48:51], a[48:51], v[64:79]
    ds_read_b64_tr_b16 v[56:57], v12 offset:6144
    ds_read_b64_tr_b16 v[58:59], v12 offset:7168
    s_waitcnt lgkmcnt(2)
    v_mfma_f32_32x32x16_bf16 v[80:95], v[52:55], a[48:51], v[80:95]
    ds_read_b64_tr_b16 v[60:61], v13 offset:6144
    ds_read_b64_tr_b16 v[62:63], v13 offset:7168
    s_waitcnt vmcnt(18)
    v_mfma_f32_32x32x16_bf16 v[96:111], v[48:51], a[52:55], v[96:111]
    v_mfma_f32_32x32x16_bf16 v[112:127], v[52:55], a[52:55], v[112:127]
    s_waitcnt vmcnt(17) lgkmcnt(2)
    v_mfma_f32_32x32x16_bf16 v[64:79], v[56:59], a[56:59], v[64:79]
    s_waitcnt vmcnt(12)
    ds_read_b64_tr_b16 v[48:49], v12 offset:8192
    ds_read_b64_tr_b16 v[50:51], v12 offset:9216
    s_waitcnt lgkmcnt(2)
    v_mfma_f32_32x32x16_bf16 v[80:95], v[60:63], a[56:59], v[80:95]
    ds_read_b64_tr_b16 v[52:53], v13 offset:8192
    ds_read_b64_tr_b16 v[54:55], v13 offset:9216
    v_mfma_f32_32x32x16_bf16 v[96:111], v[56:59], a[60:63], v[96:111]
    v_mfma_f32_32x32x16_bf16 v[112:127], v[60:63], a[60:63], v[112:127]
    s_waitcnt vmcnt(11) lgkmcnt(2)
    v_mfma_f32_32x32x16_bf16 v[64:79], v[48:51], a[64:67], v[64:79]
    ds_read_b64_tr_b16 v[56:57], v12 offset:10240
    ds_read_b64_tr_b16 v[58:59], v12 offset:11264
    s_waitcnt lgkmcnt(2)
    v_mfma_f32_32x32x16_bf16 v[80:95], v[52:55], a[64:67], v[80:95]
    ds_read_b64_tr_b16 v[60:61], v13 offset:10240
    ds_read_b64_tr_b16 v[62:63], v13 offset:11264
    s_waitcnt vmcnt(10)
    v_mfma_f32_32x32x16_bf16 v[96:111], v[48:51], a[68:71], v[96:111]
    v_mfma_f32_32x32x16_bf16 v[112:127], v[52:55], a[68:71], v[112:127]
    s_waitcnt vmcnt(9) lgkmcnt(2)
    v_mfma_f32_32x32x16_bf16 v[64:79], v[56:59], a[72:75], v[64:79]
    s_waitcnt vmcnt(4)
    ds_read_b64_tr_b16 v[48:49], v12 offset:12288
    ds_read_b64_tr_b16 v[50:51], v12 offset:13312
    s_waitcnt lgkmcnt(2)
    v_mfma_f32_32x32x16_bf16 v[80:95], v[60:63], a[72:75], v[80:95]
    ds_read_b64_tr_b16 v[52:53], v13 offset:12288
    ds_read_b64_tr_b16 v[54:55], v13 offset:13312
    v_mfma_f32_32x32x16_bf16 v[96:111], v[56:59], a[76:79], v[96:111]
    v_mfma_f32_32x32x16_bf16 v[112:127], v[60:63], a[76:79], v[112:127]
    s_waitcnt vmcnt(3) lgkmcnt(2)
    v_mfma_f32_32x32x16_bf16 v[64:79], v[48:51], a[80:83], v[64:79]
    ds_read_b64_tr_b16 v[56:57], v12 offset:14336
    ds_read_b64_tr_b16 v[58:59], v12 offset:15360
    s_waitcnt lgkmcnt(2)
    v_mfma_f32_32x32x16_bf16 v[80:95], v[52:55], a[80:83], v[80:95]
    ds_read_b64_tr_b16 v[60:61], v13 offset:14336
    ds_read_b64_tr_b16 v[62:63], v13 offset:15360
    s_waitcnt vmcnt(2)
    v_mfma_f32_32x32x16_bf16 v[96:111], v[48:51], a[84:87], v[96:111]
    v_mfma_f32_32x32x16_bf16 v[112:127], v[52:55], a[84:87], v[112:127]
    s_waitcnt vmcnt(1) lgkmcnt(2)
    v_mfma_f32_32x32x16_bf16 v[64:79], v[56:59], a[88:91], v[64:79]
    s_waitcnt lgkmcnt(0)
    v_mfma_f32_32x32x16_bf16 v[80:95], v[60:63], a[88:91], v[80:95]
    s_waitcnt vmcnt(0)
    v_mfma_f32_32x32x16_bf16 v[96:111], v[56:59], a[92:95], v[96:111]
    v_mfma_f32_32x32x16_bf16 v[112:127], v[60:63], a[92:95], v[112:127]
    s_nop 7
    v_and_b32 v3, 31, v2
    v_lshrrev_b32 v4, 5, v2
    v_mul_u32_u24 v6, 272, v3
    v_lshl_add_u32 v6, v4, 4, v6
    v_add_u32 v6, s44, v6
    ds_write_b128 v6, v[64:67] offset:0
    ds_write_b128 v6, v[68:71] offset:32
    ds_write_b128 v6, v[72:75] offset:64
    ds_write_b128 v6, v[76:79] offset:96
    ds_write_b128 v6, v[80:83] offset:128
    ds_write_b128 v6, v[84:87] offset:160
    ds_write_b128 v6, v[88:91] offset:192
    ds_write_b128 v6, v[92:95] offset:224
    ds_write_b128 v6, v[96:99] offset:8704
    ds_write_b128 v6, v[100:103] offset:8736
    ds_write_b128 v6, v[104:107] offset:8768
    ds_write_b128 v6, v[108:111] offset:8800
    ds_write_b128 v6, v[112:115] offset:8832
    ds_write_b128 v6, v[116:119] offset:8864
    ds_write_b128 v6, v[120:123] offset:8896
    ds_write_b128 v6, v[124:127] offset:8928
    v_lshrrev_b32 v3, 3, v2
    v_and_b32 v4, 7, v2
    v_mul_u32_u24 v6, 272, v3
    v_lshl_add_u32 v6, v4, 5, v6
    s_mul_i32 s52, s42, 4352
    v_add_u32 v6, s52, v6
    v_lshlrev_b32 v3, 10, v3
    v_lshl_add_u32 v3, v4, 4, v3
    s_lshl_b32 s52, s40, 16
    s_lshl_b32 s53, s42, 14
    s_add_u32 s52, s52, s53
    s_lshl_b32 s53, s41, 7
    s_add_u32 s52, s52, s53
    s_add_u32 s53, s52, 8192
    s_waitcnt lgkmcnt(0)
    s_barrier
    ds_read_b128 v[64:67], v6 offset:0
    ds_read_b128 v[68:71], v6 offset:16
    ds_read_b128 v[96:99], v6 offset:2176
    ds_read_b128 v[100:103], v6 offset:2192
    v_add_u32 v6, 40960, v6
    ds_read_b128 v[72:75], v6 offset:0
    ds_read_b128 v[76:79], v6 offset:16
    ds_read_b128 v[104:107], v6 offset:2176
    ds_read_b128 v[108:111], v6 offset:2192
    v_add_u32 v6, 40960, v6
    ds_read_b128 v[80:83], v6 offset:0
    ds_read_b128 v[84:87], v6 offset:16
    ds_read_b128 v[112:115], v6 offset:2176
    ds_read_b128 v[116:119], v6 offset:2192
    v_add_u32 v6, 40960, v6
    ds_read_b128 v[88:91], v6 offset:0
    ds_read_b128 v[92:95], v6 offset:16
    ds_read_b128 v[120:123], v6 offset:2176
    ds_read_b128 v[124:127], v6 offset:2192
    s_waitcnt lgkmcnt(11)
    v_pk_add_f32 v[64:65], v[64:65], v[72:73]
    s_waitcnt lgkmcnt(3)
    v_pk_add_f32 v[80:81], v[80:81], v[88:89]
    v_pk_add_f32 v[66:67], v[66:67], v[74:75]
    v_pk_add_f32 v[82:83], v[82:83], v[90:91]
    v_pk_add_f32 v[68:69], v[68:69], v[76:77]
    s_waitcnt lgkmcnt(2)
    v_pk_add_f32 v[84:85], v[84:85], v[92:93]
    v_pk_add_f32 v[70:71], v[70:71], v[78:79]
    v_pk_add_f32 v[86:87], v[86:87], v[94:95]
    v_pk_add_f32 v[64:65], v[64:65], v[80:81]
    v_pk_add_f32 v[66:67], v[66:67], v[82:83]
    v_pk_add_f32 v[68:69], v[68:69], v[84:85]
    v_pk_add_f32 v[70:71], v[70:71], v[86:87]
    v_cvt_pk_bf16_f32 v40, v64, v65
    v_cvt_pk_bf16_f32 v41, v66, v67
    v_cvt_pk_bf16_f32 v42, v68, v69
    v_cvt_pk_bf16_f32 v43, v70, v71
    buffer_store_dwordx4 v[40:43], v3, s[36:39], s52 offen
    v_pk_add_f32 v[96:97], v[96:97], v[104:105]
    s_waitcnt lgkmcnt(1)
    v_pk_add_f32 v[112:113], v[112:113], v[120:121]
    v_pk_add_f32 v[98:99], v[98:99], v[106:107]
    v_pk_add_f32 v[114:115], v[114:115], v[122:123]
    v_pk_add_f32 v[100:101], v[100:101], v[108:109]
    s_waitcnt lgkmcnt(0)
    v_pk_add_f32 v[116:117], v[116:117], v[124:125]
    v_pk_add_f32 v[102:103], v[102:103], v[110:111]
    v_pk_add_f32 v[118:119], v[118:119], v[126:127]
    v_pk_add_f32 v[96:97], v[96:97], v[112:113]
    v_pk_add_f32 v[98:99], v[98:99], v[114:115]
    v_pk_add_f32 v[100:101], v[100:101], v[116:117]
    v_pk_add_f32 v[102:103], v[102:103], v[118:119]
    v_cvt_pk_bf16_f32 v44, v96, v97
    v_cvt_pk_bf16_f32 v45, v98, v99
    v_cvt_pk_bf16_f32 v46, v100, v101
    v_cvt_pk_bf16_f32 v47, v102, v103
    buffer_store_dwordx4 v[44:47], v3, s[36:39], s53 offen
KC_END:
KC_EXIT:
    s_endpgm
KC_SPP:
    s_mov_b32 s50, 262144
KC_SPP_L:
    buffer_load_dword v249, v250, s[24:27], 0 offen sc1
    s_waitcnt vmcnt(0)
    v_cmp_gt_u32 vcc, 1, v249
    s_nop 0
    s_cbranch_vccz KC_SPP_R
    s_sub_u32 s50, s50, 1
    s_cbranch_scc0 KC_SPP_L
    s_branch KC_SPP_R
KC_SP1:
    s_mov_b32 s50, 262144
KC_SP1_L:
    buffer_load_dword v249, v250, s[24:27], 0 offen sc1
    s_waitcnt vmcnt(0)
    v_cmp_gt_u32 vcc, v1, v249
    s_nop 0
    s_cbranch_vccz KC_SP1_R
    s_sub_u32 s50, s50, 1
    s_cbranch_scc0 KC_SP1_L
    s_branch KC_SP1_R
KC_SP2:
    s_mov_b32 s50, 262144
KC_SP2_L:
    buffer_load_dword v249, v250, s[24:27], 0 offen sc1
    s_waitcnt vmcnt(0)
    v_cmp_gt_u32 vcc, 1, v249
    s_nop 0
    s_cbranch_vccz KC_SP2_R
    s_sub_u32 s50, s50, 1
    s_cbranch_scc0 KC_SP2_L
    s_branch KC_SP2_R
CODE_END:
    s_endpgm
.section .rodata,"a"
.p2align 6
.amdhsa_kernel ka_attn_kernel
  .amdhsa_next_free_vgpr 512
  .amdhsa_next_free_sgpr 102
  .amdhsa_accum_offset 256
  .amdhsa_group_segment_fixed_size 0
  .amdhsa_kernarg_size 112
  .amdhsa_user_sgpr_count 2
  .amdhsa_user_sgpr_kernarg_segment_ptr 1
  .amdhsa_system_sgpr_workgroup_id_x 1
  .amdhsa_float_denorm_mode_32 3
.end_amdhsa_kernel
.p2align 6
.amdhsa_kernel kc_tail_kernel
  .amdhsa_next_free_vgpr 512
  .amdhsa_next_free_sgpr 102
  .amdhsa_accum_offset 256
  .amdhsa_group_segment_fixed_size 0
  .amdhsa_kernarg_size 112
  .amdhsa_user_sgpr_count 2
  .amdhsa_user_sgpr_kernarg_segment_ptr 1
  .amdhsa_system_sgpr_workgroup_id_x 1
  .amdhsa_float_denorm_mode_32 3
.end_amdhsa_kernel
```
